```python
import torch

def _softmax(x, axis=-1):
    return torch.softmax(x, dim=axis)
def _gelu(x):
    return torch.nn.functional.gelu(x, approximate="tanh")
def _silu(x):
    return torch.nn.functional.silu(x)
def _sigmoid(x):
    return torch.sigmoid(x)
def _layernorm(x, axis=-1, eps=1e-5):
    m = x.mean(dim=axis, keepdim=True)
    v = x.var(dim=axis, keepdim=True, unbiased=False)
    return (x - m) / torch.sqrt(v + eps)
def _scatter_add(tgt, idx, src, axis=0):
    return tgt.clone().index_add_(axis, idx, src)
def _segment_sum(src, seg, n):
    out = torch.zeros((n,) + src.shape[1:], dtype=src.dtype)
    return out.index_add_(0, seg, src)
def _pad(x, pw):
    flat = tuple(v for pair in reversed(pw) for v in pair)
    return torch.nn.functional.pad(x, flat)

kernel_name = 'gated_mix__linear_attn_block__ssm_conv_s4d__prompt'

def setup_inputs():

    _w = (lambda a: (lambda t: t.to(torch.bfloat16) if t.is_floating_point() else t)(torch.as_tensor(a)))
    def _A_setup():
        B, S, D = 1, 2048, 576
        return {
            "x": _w((lambda *s: torch.randn(*s, dtype=torch.bfloat16) * 0.05)(B, S, D)),
            "wqkv": _w((lambda *s: torch.randn(*s, dtype=torch.bfloat16) * 0.8)(D, 3 * D)),
            "wo": _w((lambda *s: torch.randn(*s, dtype=torch.bfloat16) * 0.05)(D, D)),
        }
    _A_in = _A_setup()

    def _B_setup():
        Bsz, L, D, N = 1, 2048, 576, 128
        return {
            "u": _w((lambda *s: torch.randn(*s, dtype=torch.bfloat16) * 0.05)(Bsz, L, D)),
            "log_A_real": _w((lambda *s: torch.randn(*s, dtype=torch.bfloat16) * 6.4)(D, N) * 0.5),
            "A_imag": _w((lambda *s: torch.randn(*s, dtype=torch.bfloat16) * 0.05)(D, N) * 3.14),
            "C_real": _w((lambda *s: torch.randn(*s, dtype=torch.bfloat16) * 0.2)(D, N) / N ** 0.5),
            "C_imag": _w((lambda *s: torch.randn(*s, dtype=torch.bfloat16) * 0.2)(D, N) / N ** 0.5),
            "log_dt": _w((lambda *s: torch.randn(*s, dtype=torch.bfloat16) * 0.05)(D) * 0.5 - 4.0),
            "D_skip": _w((lambda *s: torch.randn(*s, dtype=torch.bfloat16) * 0.05)(D)),
        }
    _B_in = _B_setup()

    return {
        "A_x": _A_in["x"],
        "A_wqkv": _A_in["wqkv"],
        "A_wo": _A_in["wo"],
        "B_u": _B_in["u"],
        "B_log_A_real": _B_in["log_A_real"],
        "B_A_imag": _B_in["A_imag"],
        "B_C_real": _B_in["C_real"],
        "B_C_imag": _B_in["C_imag"],
        "B_log_dt": _B_in["log_dt"],
        "B_D_skip": _B_in["D_skip"],
        "gate_w": _w((lambda *s: torch.randn(*s, dtype=torch.bfloat16) * 0.05)(576) * 16.0),
    }

def reference(A_x, A_wqkv, A_wo, B_u, B_log_A_real, B_A_imag, B_C_real, B_C_imag, B_log_dt, B_D_skip, gate_w):
    def _A_ref(x, wqkv, wo):
        B, S, D = x.shape
        H = 32; Dh = D // H
        qkv = (lambda x, *d: x.permute(*d))((x @ wqkv).reshape(B, S, 3, H, Dh), 2, 0, 3, 1, 4)
        q, k, v = qkv[0], qkv[1], qkv[2]
        phi = lambda t: torch.where(t > 0, t + 1, torch.exp(t)) + 1e-6
        pq, pk = phi(q), phi(k)
        kv = torch.einsum("bhsd,bhse->bhde", pk, v)
        z = torch.einsum("bhsd->bhd", pk)
        num = torch.einsum("bhqd,bhde->bhqe", pq, kv)
        den = torch.einsum("bhqd,bhd->bhq", pq, z)[..., None] + 1e-6
        o = num / den
        return (lambda x, *d: x.permute(*d))(o, 0, 2, 1, 3).reshape(B, S, D) @ wo

    def _B_ref(u, log_A_real, A_imag, C_real, C_imag, log_dt, D_skip):
        L = u.shape[1]
        dt = torch.exp(log_dt)
        A = -torch.exp(log_A_real) + 1j * A_imag
        C = (C_real + 1j * C_imag) * dt[:, None]
        pos = (lambda x, dt: x.to(dt))(torch.arange(L), log_dt.dtype)
        P = torch.exp((A * dt[:, None])[:, :, None] * pos[None, None, :])
        K = 2.0 * torch.einsum("dn,dnl->dl", C, P).real
        L2 = 2 * L
        u_t = (lambda x, *d: x.permute(*d))(u, 0, 2, 1)
        Kf = (lambda x, *a, **k: torch.fft.rfft(x.float(), *a, **k))(K, L2)
        Uf = (lambda x, *a, **k: torch.fft.rfft(x.float(), *a, **k))(u_t, L2)
        y = (lambda x, *a, **k: torch.fft.irfft(x, *a, **k).to(torch.bfloat16))(Uf * Kf[None, :, :], L2)[:, :, :L]
        y = (lambda x, *d: x.permute(*d))(y, 0, 2, 1)
        return y + u * D_skip[None, None, :]

    x = A_x
    g = _sigmoid((x * gate_w).sum(-1, keepdims=True))
    a = _A_ref(x, A_wqkv, A_wo)
    b = _B_ref(x, B_log_A_real, B_A_imag, B_C_real, B_C_imag, B_log_dt, B_D_skip)
    return g * a + (1 - g) * b
```

```asm
; @launch kernel=gated_mix__linear_attn_block__ssm_conv_s4d__prompt_kernel grid=(256,1,1) block=(512,1,1) lds=163840
.amdgcn_target "amdgcn-amd-amdhsa--gfx950"
.text
.globl gated_mix__linear_attn_block__ssm_conv_s4d__prompt_kernel
.p2align 12
.type gated_mix__linear_attn_block__ssm_conv_s4d__prompt_kernel,@function
gated_mix__linear_attn_block__ssm_conv_s4d__prompt_kernel:
    s_load_dwordx16 s[4:19], s[0:1], 0
    s_load_dwordx8 s[20:27], s[0:1], 64
    s_load_dwordx4 s[28:31], s[0:1], 96
    v_lshrrev_b32 v2, 6, v0
    v_and_b32 v1, 63, v0
    s_cmp_ge_u32 s2, 256
    s_cbranch_scc1 k_end
    v_readfirstlane_b32 s44, v2
    s_nop 0
    s_cmp_lg_u32 s44, 3
    s_nop 1
    s_cbranch_scc1 k_nocp
    s_getpc_b64 s[46:47]
k_pc:
    s_bfe_u32 s45, s2, 0x30003
    s_lshl_b32 s45, s45, 13
    v_lshl_add_u32 v2, v1, 7, s45
    v_min_u32 v2, k_end-k_pc, v2
    global_load_dword v255, v2, s[46:47]
k_nocp:
    s_cmp_ge_u32 s2, 128
    s_cbranch_scc1 k_ssm
    s_lshr_b32 s48, s2, 3
    s_and_b32 s47, s48, 3
    s_lshr_b32 s48, s48, 2
    s_and_b32 s45, s2, 6
    s_lshl1_add_u32 s45, s45, s47
    s_and_b32 s46, s2, 1
    s_lshl2_add_u32 s46, s46, s48
    s_lshl4_add_u32 s55, s46, s45
    s_cmp_lt_u32 s44, 4
    s_cbranch_scc1 g_comp
    s_setprio 3
    s_sub_u32 s44, s44, 4
    v_lshrrev_b32 v2, 3, v1
    v_mul_u32_u24 v2, 1152, v2
    v_and_b32 v3, 7, v1
    v_lshrrev_b32 v12, 4, v1
    v_xor_b32 v3, v3, v12
    v_lshl_add_u32 v4, v3, 4, v2
    v_xor_b32 v5, 64, v4
    v_add_u32 v6, 16384, v4
    v_add_u32 v7, 24576, v5
    v_add_u32 v5, 8192, v5
    s_mov_b32 s47, 0x5556
    v_add_u32 v3, 0, v1
    v_lshrrev_b32 v12, 2, v3
    v_mul_u32_u24 v13, s47, v12
    v_lshrrev_b32 v13, 16, v13
    v_mul_u32_u24 v14, 12, v13
    v_sub_u32 v14, v3, v14
    v_lshrrev_b32 v15, 2, v13
    v_and_b32 v15, 2, v15
    v_xor_b32 v14, v14, v15
    v_mul_u32_u24 v13, 3456, v13
    v_lshl_add_u32 v8, v14, 4, v13
    v_add_u32 v3, 64, v1
    v_lshrrev_b32 v12, 2, v3
    v_mul_u32_u24 v13, s47, v12
    v_lshrrev_b32 v13, 16, v13
    v_mul_u32_u24 v14, 12, v13
    v_sub_u32 v14, v3, v14
    v_lshrrev_b32 v15, 2, v13
    v_and_b32 v15, 2, v15
    v_xor_b32 v14, v14, v15
    v_mul_u32_u24 v13, 3456, v13
    v_lshl_add_u32 v9, v14, 4, v13
    v_subrev_u32 v9, 1024, v9
    v_add_u32 v3, 128, v1
    v_lshrrev_b32 v12, 2, v3
    v_mul_u32_u24 v13, s47, v12
    v_lshrrev_b32 v13, 16, v13
    v_mul_u32_u24 v14, 12, v13
    v_sub_u32 v14, v3, v14
    v_lshrrev_b32 v15, 2, v13
    v_and_b32 v15, 2, v15
    v_xor_b32 v14, v14, v15
    v_mul_u32_u24 v13, 3456, v13
    v_lshl_add_u32 v10, v14, 4, v13
    v_subrev_u32 v10, 2048, v10
    s_lshl2_add_u32 s47, s45, s44
    s_mul_i32 s51, s47, 36864
    s_mul_i32 s52, s46, 144
    s_and_b32 s52, s52, 0xffc0
    s_mul_i32 s47, s44, 55296
    s_add_u32 s52, s52, s47
    s_lshl_b32 s53, s44, 12
    s_mul_i32 s54, s44, 3072
    s_add_u32 s64, s51, 0
    s_add_u32 s65, s52, 0
    s_waitcnt lgkmcnt(0)
    s_mov_b32 s32, s4
    s_and_b32 s33, s5, 0xffff
    s_mov_b32 s34, 0x240000
    s_mov_b32 s35, 0x20000
    s_mov_b32 s36, s6
    s_and_b32 s37, s7, 0xffff
    s_mov_b32 s38, 0x1e6000
    s_mov_b32 s39, 0x20000
    s_add_u32 s48, s65, 1152
    s_add_u32 m0, s54, 16384
    s_add_u32 s47, s65, 2304
    buffer_load_dwordx4 v8, s[36:39], s48 offen offset:0 lds
    buffer_load_dwordx4 v9, s[36:39], s48 offen offset:1024 lds
    buffer_load_dwordx4 v10, s[36:39], s48 offen offset:2048 lds
    s_add_u32 m0, s54, 28672
    s_nop 0
    buffer_load_dwordx4 v8, s[36:39], s47 offen offset:0 lds
    buffer_load_dwordx4 v9, s[36:39], s47 offen offset:1024 lds
    buffer_load_dwordx4 v10, s[36:39], s47 offen offset:2048 lds
    s_add_u32 m0, s53, 0
    s_nop 0
    buffer_load_dwordx4 v4, s[32:35], s64 offen offset:0 lds
    buffer_load_dwordx4 v5, s[32:35], s64 offen offset:1024 lds
    buffer_load_dwordx4 v6, s[32:35], s64 offen offset:2048 lds
    buffer_load_dwordx4 v7, s[32:35], s64 offen offset:3072 lds
    s_add_u32 s64, s51, 128
    s_add_u32 s65, s52, 221184
    s_branch g_l2
k_ssm:
    s_sub_u32 s3, s2, 128
    s_and_b32 s58, s3, 7
    s_lshl_b32 s47, s58, 6
    s_lshr_b32 s59, s3, 3
    s_lshr_b32 s45, s59, 2
    s_lshl_b32 s45, s45, 5
    s_and_b32 s48, s59, 2
    s_mul_i32 s48, s48, 5
    s_add_u32 s45, s45, s48
    s_add_u32 s45, s45, s47
    s_and_b32 s55, s59, 1
    s_add_u32 s52, s45, s55
    s_add_u32 s52, s52, 4
    s_mul_i32 s46, s55, 6
    s_add_u32 s45, s45, s46
    s_cmp_lt_u32 s59, 11
    s_cselect_b32 s48, -12, 8
    s_add_u32 s47, s47, s48
    s_lshl3_add_u32 s48, s58, 456
    s_cmp_lt_u32 s59, 14
    s_cselect_b32 s47, s47, s48
    s_cselect_b32 s48, 1, s55
    s_lshl2_add_u32 s51, s59, s47
    s_cmp_lt_u32 s59, 8
    s_cselect_b32 s54, 1, 0
    s_cselect_b32 s51, s45, s51
    s_cselect_b32 s55, s55, s48
    s_and_b32 s45, s44, 3
    s_lshr_b32 s46, s44, 2
    s_add_u32 s53, s51, s45
    s_add_u32 s48, s44, 1
    s_and_b32 s48, s48, 6
    s_cselect_b32 s64, 0, s54
    s_lshr_b32 s49, s44, 1
    s_xor_b32 s49, s49, s46
    s_and_b32 s68, s54, s49
    s_cmp_lg_u32 s64, 0
    s_cselect_b32 s49, s52, s53
    s_lshl1_add_u32 s47, s49, s46
    s_lshl_b32 s47, s47, 7
    v_lshl_add_u32 v2, v1, 1, s47
    s_lshl_b32 s48, s49, 1
    v_mov_b32 v3, s48
    s_waitcnt lgkmcnt(0)
    global_load_ushort v32, v2, s[12:13]
    global_load_ushort v33, v2, s[14:15]
    global_load_ushort v34, v2, s[16:17]
    global_load_ushort v35, v2, s[18:19]
    global_load_ushort v36, v3, s[20:21]
    global_load_ushort v26, v3, s[22:23]
    s_cmp_eq_u32 s64, 0
    s_cbranch_scc1 ssm_no5p
    s_lshl1_add_u32 s47, s53, s46
    s_lshl_b32 s47, s47, 7
    v_lshl_add_u32 v2, v1, 1, s47
    s_lshl_b32 s48, s53, 1
    v_mov_b32 v3, s48
    global_load_ushort v38, v2, s[12:13]
    global_load_ushort v39, v2, s[14:15]
    global_load_ushort v40, v2, s[16:17]
    global_load_ushort v41, v2, s[18:19]
    global_load_ushort v42, v3, s[20:21]
    global_load_ushort v25, v3, s[22:23]
ssm_no5p:
    s_xor_b32 s47, s44, 6
    s_or_b32 s47, s3, s47
    s_cbranch_scc1 ssm_notag
    s_memrealtime s[48:49]
    v_mov_b32 v2, 0
    s_waitcnt lgkmcnt(0)
    s_max_u32 s48, s48, 1
    v_mov_b32 v28, s48
    s_mov_b64 exec, 1
    global_store_dword v2, v28, s[28:29] sc1
    s_mov_b64 exec, -1
ssm_notag:
    s_mov_b32 s32, s4
    s_and_b32 s33, s5, 0xffff
    s_mov_b32 s34, 0x240000
    s_mov_b32 s35, 0x20000
    s_mov_b32 s36, s6
    s_and_b32 s37, s7, 0xffff
    s_mov_b32 s38, 0x1e6000
    s_mov_b32 s39, 0x20000
    s_mov_b32 s40, s30
    s_and_b32 s41, s31, 0xffff
    s_mov_b32 s42, 0x6e0000
    s_mov_b32 s43, 0x20000
    v_mul_u32_u24 v2, 103, v1
    v_lshrrev_b32 v2, 9, v2
    v_mul_u32_u24 v3, 5, v2
    v_sub_u32 v3, v1, v3
    v_lshlrev_b32 v3, 7, v3
    v_mul_u32_u24 v17, 3456, v2
    v_add_u32 v17, v17, v3
    v_lshrrev_b32 v16, 1, v2
    v_add_u32 v16, v16, v2
    v_mul_u32_u24 v16, 1152, v16
    v_add_u32 v16, v16, v3
    v_lshrrev_b32 v2, 1, v1
    v_mul_u32_u24 v2, 1152, v2
    v_and_b32 v3, 1, v1
    v_lshl_add_u32 v15, v3, 7, v2
    s_and_b32 s60, s58, 1
    s_mul_i32 s60, s60, 576
    s_mul_i32 s62, s59, 13824
    s_add_u32 s62, s62, s60
    s_lshr_b32 s47, s58, 1
    s_lshl4_add_u32 s47, s47, s59
    s_mul_i32 s63, s47, 36864
    s_barrier
    s_cmp_eq_u32 s44, 0
    s_cbranch_scc1 ssm_pfA_0
    s_cmp_eq_u32 s44, 1
    s_cbranch_scc1 ssm_pfA_1
    s_cmp_eq_u32 s44, 7
    s_cbranch_scc1 ssm_pfA_7
    s_cmp_eq_u32 s44, 6
    s_cbranch_scc1 ssm_pfA_6
    s_branch ssm_pfAe
ssm_pfA_0:
    buffer_load_dword v255, v15, s[32:35], s63 offen offset:0
    s_branch ssm_pfAe
ssm_pfA_1:
    s_add_u32 s47, s62, 221184
    s_mov_b32 exec_hi, 0xff
    buffer_load_dword v255, v16, s[36:39], s47 offen offset:1152
    s_branch ssm_pfAe
ssm_pfA_7:
    v_lshlrev_b32 v2, 7, v1
    s_mov_b64 exec, 0x1ff
    global_load_dword v255, v2, s[24:25]
    s_branch ssm_pfAe
ssm_pfA_6:
    s_add_u32 s47, s62, 442368
    s_mov_b32 exec_hi, 0xff
    buffer_load_dword v255, v16, s[36:39], s47 offen offset:1152
ssm_pfAe:
    s_mov_b64 exec, -1
    v_mov_b32 v112, 0
    v_mov_b32 v113, 0
    v_mov_b32 v114, 0
    v_mov_b32 v115, 0
    v_lshrrev_b32 v2, 5, v0
    v_and_b32 v3, 31, v0
    v_mul_u32_u24 v2, 4512, v2
    v_lshl_add_u32 v2, v3, 4, v2
    v_add_u32 v2, 69632, v2
    s_mov_b32 exec_lo, 0x3ffffff
    s_mov_b32 exec_hi, 0x3ffffff
    ds_write_b128 v2, v[112:115] offset:4096
    s_mov_b32 exec_lo, -1
    s_mov_b32 exec_hi, 0xff
    v_lshrrev_b32 v2, 3, v1
    v_and_b32 v3, 7, v1
    v_mul_u32_u24 v2, 4224, v2
    v_lshl_add_u32 v2, v3, 4, v2
    v_add_u32 v2, 141824, v2
    ds_write_b128 v2, v[112:115]
    s_mov_b64 exec, -1
    v_and_b32 v116, 15, v1
    v_lshrrev_b32 v117, 4, v1
    v_lshlrev_b32 v10, 4, v1
    v_lshlrev_b32 v11, 3, v1
    v_mov_b32 v27, 0
    s_mul_i32 s47, s44, 8704
    s_mov_b32 m0, s47
    v_lshl_add_u32 v2, v117, 4, s47
    s_movk_i32 s48, 272
    v_mad_u32_u24 v4, v116, s48, v2
    v_lshlrev_b32 v3, 2, v116
    s_mov_b32 s49, 0x40322210
    v_bfe_u32 v3, s49, v3, 4
    v_lshrrev_b32 v21, 3, v116
    v_lshl_add_u32 v3, v21, 2, v3
    v_mad_u32_u24 v5, v3, s48, v2
    v_lshrrev_b32 v21, 2, v116
    v_and_b32 v22, 3, v116
    v_min_u32 v3, 2, v22
    v_lshl_add_u32 v3, v21, 1, v3
    v_add_u32 v3, 24, v3
    v_and_b32 v3, 31, v3
    v_mad_u32_u24 v6, v3, s48, v2
    v_mad_u32_u24 v3, v21, 3, v22
    v_min_u32 v3, 8, v3
    v_mad_u32_u24 v7, v3, s48, v2
    v_lshrrev_b32 v3, 5, v1
    v_lshlrev_b32 v3, 8, v3
    v_lshl_add_u32 v3, v116, 4, v3
    v_and_b32 v2, 1, v117
    v_lshl_add_u32 v18, v2, 3, v3
    v_lshl_add_u32 v19, v117, 9, v10
    v_lshlrev_b32 v21, 7, v21
    v_lshlrev_b32 v2, 4, v117
    v_sub_u32 v2, v2, v21
    v_mul_u32_u24 v3, 4512, v22
    s_mul_i32 s47, s45, 18048
    s_lshl_b32 s48, s46, 8
    s_sub_u32 s47, s47, s48
    s_add_u32 s47, s47, 70032
    v_add3_u32 v8, s47, v3, v2
    v_mul_u32_u24 v3, 8864, v22
    s_lshl_b32 s49, s44, 7
    s_sub_u32 s47, 21264, s49
    v_add3_u32 v23, s47, v3, v2
    s_mul_i32 s65, s45, 4224
    s_add_u32 s65, s65, 141952
    s_sub_u32 s47, s65, s48
    s_add_u32 s47, s47, 136
    v_lshlrev_b32 v3, 3, v116
    v_lshl_add_u32 v3, v117, 4, v3
    v_add_u32 v9, s47, v3
    s_sub_u32 s47, 159368, s49
    v_add_u32 v24, s47, v3
    s_mov_b32 s47, 4608
    v_mul_lo_u32 v13, s47, v0
    v_add_u32 v14, 4608, v13
    s_lshl_b32 s61, s51, 1
    s_lshl_b32 s47, s55, 2
    s_sub_u32 s61, s61, s47
    s_mov_b32 s56, 0x80008000
    s_mov_b32 s57, 0x80008000
    v_lshlrev_b32 v12, 3, v0
    v_sub_u32 v12, 73728, v12
    s_mov_b32 s66, 0x05040100
    s_mov_b32 s67, 0x07060302
    s_mov_b32 s12, s8
    s_and_b32 s13, s9, 0xffff
    s_mov_b32 s14, 0xa2000
    s_mov_b32 s15, 0x20000
    s_mov_b32 s69, 0
    s_cmp_eq_u32 s44, 2
    s_cbranch_scc1 ssm_pfB_2
    s_cmp_eq_u32 s44, 3
    s_cbranch_scc1 ssm_pfB_3
    s_cmp_eq_u32 s44, 4
    s_cbranch_scc1 ssm_pfB_4
    s_cmp_eq_u32 s44, 5
    s_cbranch_scc1 ssm_pfB_5
    s_branch ssm_pfBe
ssm_pfB_2:
    buffer_load_dword v255, v15, s[32:35], s63 offen offset:256
    s_branch ssm_pfBe
ssm_pfB_3:
    s_add_u32 s47, s62, 663552
    s_mov_b32 exec_hi, 0xff
    buffer_load_dword v255, v16, s[36:39], s47 offen offset:1152
    s_branch ssm_pfBe
ssm_pfB_4:
    s_add_u32 s47, s62, 884736
    s_mov_b32 exec_hi, 0xff
    buffer_load_dword v255, v16, s[36:39], s47 offen offset:1152
    s_branch ssm_pfBe
ssm_pfB_5:
    buffer_load_dword v255, v15, s[32:35], s63 offen offset:512
ssm_pfBe:
    s_mov_b64 exec, -1
    s_cmp_eq_u32 s64, 0
    s_cbranch_scc1 ssm_lp
    s_setprio 2
ssm_lp:
    s_waitcnt vmcnt(1)
    global_load_dword v28, v27, s[28:29] sc1
    s_cmp_eq_u32 s44, 4
    s_cbranch_scc1 ssm_pfC_4
    s_cmp_eq_u32 s44, 5
    s_cbranch_scc1 ssm_pfC_5
    s_cmp_eq_u32 s44, 6
    s_cbranch_scc1 ssm_pfC_6
    s_cmp_eq_u32 s44, 7
    s_cbranch_scc1 ssm_pfC_7
    s_branch ssm_pfCe
ssm_pfC_4:
    s_add_u32 s47, s62, 1105920
    s_mov_b32 exec_hi, 0xff
    buffer_load_dword v255, v16, s[36:39], s47 offen offset:1152
    s_branch ssm_pfCe
ssm_pfC_5:
    buffer_load_dword v255, v15, s[32:35], s63 offen offset:768
    s_branch ssm_pfCe
ssm_pfC_6:
    s_add_u32 s47, s62, 1327104
    s_mov_b32 exec_hi, 0xff
    buffer_load_dword v255, v16, s[36:39], s47 offen offset:1152
    s_branch ssm_pfCe
ssm_pfC_7:
    s_add_u32 s47, s62, 1548288
    s_mov_b32 exec_hi, 0xff
    buffer_load_dword v255, v16, s[36:39], s47 offen offset:1152
ssm_pfCe:
    s_mov_b64 exec, -1
ssm_kt:
    v_lshlrev_b32 v32, 16, v32
    v_lshlrev_b32 v33, 16, v33
    v_lshlrev_b32 v34, 16, v34
    v_lshlrev_b32 v35, 16, v35
    v_lshlrev_b32 v36, 16, v36
    v_mul_f32 v36, 0x3fb8aa3b, v36
    v_mul_f32 v32, 0x3fb8aa3b, v32
    v_max_f32 v21, abs(v34), abs(v35)
    v_exp_f32 v36, v36
    v_exp_f32 v32, v32
    v_max_f32_dpp v21, v21, v21 row_ror:1 row_mask:0xf bank_mask:0xf
    v_cvt_pk_bf16_f32 v36, v36, v32
    v_mov_b32 v130, 0x3c00
    v_max_f32_dpp v21, v21, v21 row_ror:2 row_mask:0xf bank_mask:0xf
    v_and_b32 v32, 0xffff0000, v36
    v_lshlrev_b32 v36, 16, v36
    v_max_f32_dpp v21, v21, v21 row_ror:4 row_mask:0xf bank_mask:0xf
    v_mul_f32 v32, v32, v36
    v_mul_f32 v33, v33, v36
    v_max_f32_dpp v21, v21, v21 row_ror:8 row_mask:0xf bank_mask:0xf
    v_mul_f32 v32, 0xbfb8aa3b, v32
    v_mul_f32 v33, 0x3e22f983, v33
    v_mov_b32 v22, v21
    v_mul_f32 v124, 0x43000000, v32
    v_mul_f32 v125, 0x43000000, v33
    v_permlane16_swap_b32 v21, v22
    v_fract_f32 v123, v33
    v_fract_f32 v125, v125
    v_max_f32 v21, v21, v22
    v_exp_f32 v122, v32
    v_mov_b32 v22, v21
    v_exp_f32 v124, v124
    v_cos_f32 v76, v125
    v_permlane32_swap_b32 v21, v22
    v_sin_f32 v77, v125
    v_max_f32 v21, v21, v22
    v_cos_f32 v66, v123
    v_frexp_exp_i32_f32 v21, v21
    v_sin_f32 v67, v123
    v_sub_u32 v22, 0, v21
    v_add_u32 v21, 1, v21
    ds_write_addtid_b32 v130 offset:0
    v_pk_mul_f32 v[76:77], v[76:77], v[124:125] op_sel:[0,0] op_sel_hi:[1,0]
    v_pk_mul_f32 v[66:67], v[66:67], v[122:123] op_sel:[0,0] op_sel_hi:[1,0]
    v_ldexp_f32 v34, v34, v22
    v_ldexp_f32 v35, v35, v22
    v_ldexp_f32 v20, v36, v21
    v_pk_mul_f32 v[122:123], v[66:67], v[66:67] op_sel:[0,0] op_sel_hi:[0,1]
    v_pk_mul_f32 v[124:125], v[76:77], v[76:77] op_sel:[0,0] op_sel_hi:[0,1]
    v_pk_mul_f32 v[126:127], v[34:35], v[76:77] op_sel:[0,0] op_sel_hi:[0,1]
    v_pk_mul_f32 v[128:129], v[34:35], v[66:67] op_sel:[0,0] op_sel_hi:[0,1]
    v_pk_fma_f32 v[68:69], v[66:67], v[66:67], v[122:123] op_sel:[1,1,0] op_sel_hi:[1,0,1] neg_lo:[0,1,0]
    v_pk_fma_f32 v[78:79], v[76:77], v[76:77], v[124:125] op_sel:[1,1,0] op_sel_hi:[1,0,1] neg_lo:[0,1,0]
    v_pk_fma_f32 v[90:91], v[34:35], v[76:77], v[126:127] op_sel:[1,1,0] op_sel_hi:[1,0,1] neg_lo:[0,1,0]
    v_pk_fma_f32 v[82:83], v[34:35], v[66:67], v[128:129] op_sel:[1,1,0] op_sel_hi:[1,0,1] neg_lo:[0,1,0]
    v_cvt_pk_f16_f32 v131, v34, -v35
    v_cvt_pk_f16_f32 v132, v90, -v91
    v_cvt_pk_f16_f32 v133, v82, -v83
    ds_write_addtid_b32 v131 offset:4352
    ds_write_addtid_b32 v132 offset:6528
    ds_write_addtid_b32 v133 offset:4624
    v_pk_mul_f32 v[122:123], v[68:69], v[68:69] op_sel:[0,0] op_sel_hi:[0,1]
    v_pk_mul_f32 v[124:125], v[34:35], v[78:79] op_sel:[0,0] op_sel_hi:[0,1]
    v_pk_mul_f32 v[126:127], v[90:91], v[66:67] op_sel:[0,0] op_sel_hi:[0,1]
    v_pk_mul_f32 v[128:129], v[82:83], v[66:67] op_sel:[0,0] op_sel_hi:[0,1]
    v_pk_fma_f32 v[70:71], v[68:69], v[68:69], v[122:123] op_sel:[1,1,0] op_sel_hi:[1,0,1] neg_lo:[0,1,0]
    v_pk_fma_f32 v[92:93], v[34:35], v[78:79], v[124:125] op_sel:[1,1,0] op_sel_hi:[1,0,1] neg_lo:[0,1,0]
    v_pk_fma_f32 v[84:85], v[90:91], v[66:67], v[126:127] op_sel:[1,1,0] op_sel_hi:[1,0,1] neg_lo:[0,1,0]
    v_pk_fma_f32 v[82:83], v[82:83], v[66:67], v[128:129] op_sel:[1,1,0] op_sel_hi:[1,0,1] neg_lo:[0,1,0]
    s_cmp_eq_u32 s44, 1
    s_cbranch_scc1 ssm_pf2_1
    s_cmp_eq_u32 s44, 3
    s_cbranch_scc1 ssm_pf2_3
    s_branch ssm_pf2e
ssm_pf2_1:
    s_add_u32 s47, s62, 1769472
    s_mov_b32 exec_hi, 0xff
    buffer_load_dword v255, v16, s[36:39], s47 offen offset:1152
    s_branch ssm_pf2e
ssm_pf2_3:
    buffer_load_dword v255, v15, s[32:35], s63 offen offset:896
ssm_pf2e:
    s_mov_b64 exec, -1
    v_cvt_pk_f16_f32 v134, v84, -v85
    v_cvt_pk_f16_f32 v135, v82, -v83
    ds_write_addtid_b32 v134 offset:6800
    ds_write_addtid_b32 v135 offset:4896
    v_pk_mul_f32 v[122:123], v[70:71], v[70:71] op_sel:[0,0] op_sel_hi:[0,1]
    v_pk_mul_f32 v[124:125], v[90:91], v[78:79] op_sel:[0,0] op_sel_hi:[0,1]
    v_pk_mul_f32 v[126:127], v[84:85], v[66:67] op_sel:[0,0] op_sel_hi:[0,1]
    v_pk_mul_f32 v[128:129], v[82:83], v[66:67] op_sel:[0,0] op_sel_hi:[0,1]
    v_pk_fma_f32 v[72:73], v[70:71], v[70:71], v[122:123] op_sel:[1,1,0] op_sel_hi:[1,0,1] neg_lo:[0,1,0]
    v_pk_fma_f32 v[94:95], v[90:91], v[78:79], v[124:125] op_sel:[1,1,0] op_sel_hi:[1,0,1] neg_lo:[0,1,0]
    v_pk_fma_f32 v[84:85], v[84:85], v[66:67], v[126:127] op_sel:[1,1,0] op_sel_hi:[1,0,1] neg_lo:[0,1,0]
    v_pk_fma_f32 v[82:83], v[82:83], v[66:67], v[128:129] op_sel:[1,1,0] op_sel_hi:[1,0,1] neg_lo:[0,1,0]
    v_cvt_pk_f16_f32 v136, v84, -v85
    v_cvt_pk_f16_f32 v137, v82, -v83
    v_cvt_pk_f16_f32 v130, v72, v73
    ds_write_addtid_b32 v136 offset:7072
    ds_write_addtid_b32 v137 offset:5168
    ds_write_addtid_b32 v130 offset:272
    v_pk_mul_f32 v[122:123], v[72:73], v[72:73] op_sel:[0,0] op_sel_hi:[0,1]
    v_pk_mul_f32 v[124:125], v[92:93], v[78:79] op_sel:[0,0] op_sel_hi:[0,1]
    v_pk_mul_f32 v[126:127], v[84:85], v[66:67] op_sel:[0,0] op_sel_hi:[0,1]
    v_pk_mul_f32 v[128:129], v[82:83], v[66:67] op_sel:[0,0] op_sel_hi:[0,1]
    v_pk_fma_f32 v[74:75], v[72:73], v[72:73], v[122:123] op_sel:[1,1,0] op_sel_hi:[1,0,1] neg_lo:[0,1,0]
    v_pk_fma_f32 v[96:97], v[92:93], v[78:79], v[124:125] op_sel:[1,1,0] op_sel_hi:[1,0,1] neg_lo:[0,1,0]
    v_pk_fma_f32 v[84:85], v[84:85], v[66:67], v[126:127] op_sel:[1,1,0] op_sel_hi:[1,0,1] neg_lo:[0,1,0]
    v_pk_fma_f32 v[82:83], v[82:83], v[66:67], v[128:129] op_sel:[1,1,0] op_sel_hi:[1,0,1] neg_lo:[0,1,0]
    v_cvt_pk_f16_f32 v131, v84, -v85
    v_cvt_pk_f16_f32 v132, v82, -v83
    v_cvt_pk_f16_f32 v133, v74, v75
    ds_write_addtid_b32 v131 offset:7344
    ds_write_addtid_b32 v132 offset:5440
    ds_write_addtid_b32 v133 offset:544
    v_pk_mul_f32 v[122:123], v[72:73], v[74:75] op_sel:[0,0] op_sel_hi:[0,1]
    v_pk_mul_f32 v[124:125], v[74:75], v[74:75] op_sel:[0,0] op_sel_hi:[0,1]
    v_pk_mul_f32 v[126:127], v[84:85], v[66:67] op_sel:[0,0] op_sel_hi:[0,1]
    v_pk_mul_f32 v[128:129], v[82:83], v[66:67] op_sel:[0,0] op_sel_hi:[0,1]
    v_pk_fma_f32 v[88:89], v[72:73], v[74:75], v[122:123] op_sel:[1,1,0] op_sel_hi:[1,0,1] neg_lo:[0,1,0]
    v_pk_fma_f32 v[86:87], v[74:75], v[74:75], v[124:125] op_sel:[1,1,0] op_sel_hi:[1,0,1] neg_lo:[0,1,0]
    v_pk_fma_f32 v[84:85], v[84:85], v[66:67], v[126:127] op_sel:[1,1,0] op_sel_hi:[1,0,1] neg_lo:[0,1,0]
    v_pk_fma_f32 v[82:83], v[82:83], v[66:67], v[128:129] op_sel:[1,1,0] op_sel_hi:[1,0,1] neg_lo:[0,1,0]
    v_cvt_pk_f16_f32 v134, v84, -v85
    v_cvt_pk_f16_f32 v135, v82, -v83
    v_cvt_pk_f16_f32 v136, v88, v89
    v_cvt_pk_f16_f32 v137, v86, v87
    ds_write_addtid_b32 v134 offset:7616
    ds_write_addtid_b32 v135 offset:5712
    ds_write_addtid_b32 v136 offset:816
    ds_write_addtid_b32 v137 offset:1088
    v_pk_mul_f32 v[122:123], v[88:89], v[74:75] op_sel:[0,0] op_sel_hi:[0,1]
    v_pk_mul_f32 v[124:125], v[86:87], v[74:75] op_sel:[0,0] op_sel_hi:[0,1]
    v_pk_mul_f32 v[126:127], v[84:85], v[66:67] op_sel:[0,0] op_sel_hi:[0,1]
    v_pk_mul_f32 v[128:129], v[82:83], v[66:67] op_sel:[0,0] op_sel_hi:[0,1]
    v_pk_fma_f32 v[88:89], v[88:89], v[74:75], v[122:123] op_sel:[1,1,0] op_sel_hi:[1,0,1] neg_lo:[0,1,0]
    v_pk_fma_f32 v[86:87], v[86:87], v[74:75], v[124:125] op_sel:[1,1,0] op_sel_hi:[1,0,1] neg_lo:[0,1,0]
    v_pk_fma_f32 v[84:85], v[84:85], v[66:67], v[126:127] op_sel:[1,1,0] op_sel_hi:[1,0,1] neg_lo:[0,1,0]
    v_pk_fma_f32 v[82:83], v[82:83], v[66:67], v[128:129] op_sel:[1,1,0] op_sel_hi:[1,0,1] neg_lo:[0,1,0]
    v_cvt_pk_f16_f32 v130, v84, -v85
    v_cvt_pk_f16_f32 v131, v82, -v83
    v_cvt_pk_f16_f32 v132, v88, v89
    v_cvt_pk_f16_f32 v133, v86, v87
    ds_write_addtid_b32 v130 offset:7888
    ds_write_addtid_b32 v131 offset:5984
    ds_write_addtid_b32 v132 offset:1360
    ds_write_addtid_b32 v133 offset:1632
    v_pk_mul_f32 v[122:123], v[88:89], v[74:75] op_sel:[0,0] op_sel_hi:[0,1]
    v_pk_mul_f32 v[124:125], v[86:87], v[74:75] op_sel:[0,0] op_sel_hi:[0,1]
    v_pk_mul_f32 v[126:127], v[84:85], v[66:67] op_sel:[0,0] op_sel_hi:[0,1]
    v_pk_mul_f32 v[128:129], v[82:83], v[66:67] op_sel:[0,0] op_sel_hi:[0,1]
    v_pk_fma_f32 v[88:89], v[88:89], v[74:75], v[122:123] op_sel:[1,1,0] op_sel_hi:[1,0,1] neg_lo:[0,1,0]
    v_pk_fma_f32 v[86:87], v[86:87], v[74:75], v[124:125] op_sel:[1,1,0] op_sel_hi:[1,0,1] neg_lo:[0,1,0]
    v_pk_fma_f32 v[84:85], v[84:85], v[66:67], v[126:127] op_sel:[1,1,0] op_sel_hi:[1,0,1] neg_lo:[0,1,0]
    v_pk_fma_f32 v[82:83], v[82:83], v[66:67], v[128:129] op_sel:[1,1,0] op_sel_hi:[1,0,1] neg_lo:[0,1,0]
    v_cvt_pk_f16_f32 v134, v84, -v85
    v_cvt_pk_f16_f32 v135, v82, -v83
    v_cvt_pk_f16_f32 v136, v88, v89
    v_cvt_pk_f16_f32 v137, v86, v87
    ds_write_addtid_b32 v134 offset:8160
    ds_write_addtid_b32 v135 offset:6256
    ds_write_addtid_b32 v136 offset:1904
    ds_write_addtid_b32 v137 offset:2176
    v_pk_mul_f32 v[122:123], v[84:85], v[66:67] op_sel:[0,0] op_sel_hi:[0,1]
    v_pk_mul_f32 v[124:125], v[88:89], v[74:75] op_sel:[0,0] op_sel_hi:[0,1]
    v_pk_mul_f32 v[126:127], v[86:87], v[74:75] op_sel:[0,0] op_sel_hi:[0,1]
    v_pk_mul_f32 v[128:129], v[94:95], v[78:79] op_sel:[0,0] op_sel_hi:[0,1]
    v_pk_fma_f32 v[84:85], v[84:85], v[66:67], v[122:123] op_sel:[1,1,0] op_sel_hi:[1,0,1] neg_lo:[0,1,0]
    v_pk_fma_f32 v[88:89], v[88:89], v[74:75], v[124:125] op_sel:[1,1,0] op_sel_hi:[1,0,1] neg_lo:[0,1,0]
    v_pk_fma_f32 v[86:87], v[86:87], v[74:75], v[126:127] op_sel:[1,1,0] op_sel_hi:[1,0,1] neg_lo:[0,1,0]
    v_pk_fma_f32 v[98:99], v[94:95], v[78:79], v[128:129] op_sel:[1,1,0] op_sel_hi:[1,0,1] neg_lo:[0,1,0]
    v_cvt_pk_f16_f32 v130, v84, -v85
    v_cvt_pk_f16_f32 v131, v88, v89
    v_cvt_pk_f16_f32 v132, v86, v87
    ds_write_addtid_b32 v130 offset:8432
    ds_write_addtid_b32 v131 offset:2448
    ds_write_addtid_b32 v132 offset:2720
    ds_read_b128 v[188:191], v4 offset:4352
    ds_read_b128 v[192:195], v4 offset:4416
    ds_read_b128 v[196:199], v4 offset:4480
    ds_read_b128 v[200:203], v4 offset:4544
    v_pk_mul_f32 v[122:123], v[88:89], v[74:75] op_sel:[0,0] op_sel_hi:[0,1]
    v_pk_mul_f32 v[124:125], v[86:87], v[74:75] op_sel:[0,0] op_sel_hi:[0,1]
    v_pk_mul_f32 v[126:127], v[96:97], v[78:79] op_sel:[0,0] op_sel_hi:[0,1]
    v_pk_mul_f32 v[128:129], v[98:99], v[78:79] op_sel:[0,0] op_sel_hi:[0,1]
    v_pk_fma_f32 v[88:89], v[88:89], v[74:75], v[122:123] op_sel:[1,1,0] op_sel_hi:[1,0,1] neg_lo:[0,1,0]
    v_pk_fma_f32 v[86:87], v[86:87], v[74:75], v[124:125] op_sel:[1,1,0] op_sel_hi:[1,0,1] neg_lo:[0,1,0]
    v_pk_fma_f32 v[100:101], v[96:97], v[78:79], v[126:127] op_sel:[1,1,0] op_sel_hi:[1,0,1] neg_lo:[0,1,0]
    v_pk_fma_f32 v[102:103], v[98:99], v[78:79], v[128:129] op_sel:[1,1,0] op_sel_hi:[1,0,1] neg_lo:[0,1,0]
    v_cvt_pk_f16_f32 v133, v92, -v93
    v_cvt_pk_f16_f32 v134, v94, -v95
    v_cvt_pk_f16_f32 v135, v96, -v97
    v_cvt_pk_f16_f32 v136, v98, -v99
    v_cvt_pk_f16_f32 v137, v88, v89
    v_cvt_pk_f16_f32 v130, v86, v87
    ds_write_addtid_b32 v133 offset:4352
    ds_write_addtid_b32 v134 offset:5440
    ds_write_addtid_b32 v135 offset:6528
    ds_write_addtid_b32 v136 offset:7072
    ds_write_addtid_b32 v137 offset:2992
    ds_write_addtid_b32 v130 offset:3264
    v_pk_mul_f32 v[122:123], v[88:89], v[74:75] op_sel:[0,0] op_sel_hi:[0,1]
    v_pk_mul_f32 v[124:125], v[86:87], v[74:75] op_sel:[0,0] op_sel_hi:[0,1]
    v_pk_mul_f32 v[126:127], v[92:93], v[68:69] op_sel:[0,0] op_sel_hi:[0,1]
    v_pk_mul_f32 v[128:129], v[94:95], v[68:69] op_sel:[0,0] op_sel_hi:[0,1]
    v_pk_fma_f32 v[88:89], v[88:89], v[74:75], v[122:123] op_sel:[1,1,0] op_sel_hi:[1,0,1] neg_lo:[0,1,0]
    v_pk_fma_f32 v[86:87], v[86:87], v[74:75], v[124:125] op_sel:[1,1,0] op_sel_hi:[1,0,1] neg_lo:[0,1,0]
    v_pk_fma_f32 v[82:83], v[92:93], v[68:69], v[126:127] op_sel:[1,1,0] op_sel_hi:[1,0,1] neg_lo:[0,1,0]
    v_pk_fma_f32 v[84:85], v[94:95], v[68:69], v[128:129] op_sel:[1,1,0] op_sel_hi:[1,0,1] neg_lo:[0,1,0]
    v_cvt_pk_f16_f32 v131, v82, -v83
    v_cvt_pk_f16_f32 v132, v84, -v85
    v_cvt_pk_f16_f32 v133, v100, -v101
    v_cvt_pk_f16_f32 v134, v102, -v103
    v_cvt_pk_f16_f32 v135, v88, v89
    v_cvt_pk_f16_f32 v136, v86, v87
    ds_write_addtid_b32 v131 offset:4624
    ds_write_addtid_b32 v132 offset:5712
    ds_write_addtid_b32 v133 offset:7616
    ds_write_addtid_b32 v134 offset:8160
    ds_write_addtid_b32 v135 offset:3536
    ds_write_addtid_b32 v136 offset:3808
    v_pk_mul_f32 v[122:123], v[88:89], v[74:75] op_sel:[0,0] op_sel_hi:[0,1]
    v_pk_mul_f32 v[124:125], v[78:79], v[78:79] op_sel:[0,0] op_sel_hi:[0,1]
    v_pk_mul_f32 v[126:127], v[92:93], v[70:71] op_sel:[0,0] op_sel_hi:[0,1]
    v_pk_mul_f32 v[128:129], v[94:95], v[70:71] op_sel:[0,0] op_sel_hi:[0,1]
    v_pk_fma_f32 v[88:89], v[88:89], v[74:75], v[122:123] op_sel:[1,1,0] op_sel_hi:[1,0,1] neg_lo:[0,1,0]
    v_pk_fma_f32 v[80:81], v[78:79], v[78:79], v[124:125] op_sel:[1,1,0] op_sel_hi:[1,0,1] neg_lo:[0,1,0]
    v_pk_fma_f32 v[82:83], v[92:93], v[70:71], v[126:127] op_sel:[1,1,0] op_sel_hi:[1,0,1] neg_lo:[0,1,0]
    v_pk_fma_f32 v[84:85], v[94:95], v[70:71], v[128:129] op_sel:[1,1,0] op_sel_hi:[1,0,1] neg_lo:[0,1,0]
    v_cvt_pk_f16_f32 v137, v82, -v83
    v_cvt_pk_f16_f32 v130, v84, -v85
    v_cvt_pk_f16_f32 v131, v88, v89
    ds_write_addtid_b32 v137 offset:4896
    ds_write_addtid_b32 v130 offset:5984
    ds_write_addtid_b32 v131 offset:4080
    ds_read_b128 v[172:175], v4 offset:0
    ds_read_b128 v[176:179], v4 offset:64
    ds_read_b128 v[180:183], v4 offset:128
    ds_read_b128 v[184:187], v4 offset:192
    v_pk_mul_f32 v[122:123], v[82:83], v[68:69] op_sel:[0,0] op_sel_hi:[0,1]
    v_pk_mul_f32 v[124:125], v[84:85], v[68:69] op_sel:[0,0] op_sel_hi:[0,1]
    v_pk_mul_f32 v[126:127], v[96:97], v[80:81] op_sel:[0,0] op_sel_hi:[0,1]
    v_pk_mul_f32 v[128:129], v[98:99], v[80:81] op_sel:[0,0] op_sel_hi:[0,1]
    v_pk_fma_f32 v[82:83], v[82:83], v[68:69], v[122:123] op_sel:[1,1,0] op_sel_hi:[1,0,1] neg_lo:[0,1,0]
    v_pk_fma_f32 v[84:85], v[84:85], v[68:69], v[124:125] op_sel:[1,1,0] op_sel_hi:[1,0,1] neg_lo:[0,1,0]
    v_pk_fma_f32 v[104:105], v[96:97], v[80:81], v[126:127] op_sel:[1,1,0] op_sel_hi:[1,0,1] neg_lo:[0,1,0]
    v_pk_fma_f32 v[106:107], v[98:99], v[80:81], v[128:129] op_sel:[1,1,0] op_sel_hi:[1,0,1] neg_lo:[0,1,0]
    v_cvt_pk_f16_f32 v132, v82, -v83
    v_cvt_pk_f16_f32 v133, v84, -v85
    v_cvt_pk_f16_f32 v134, v104, -v105
    v_cvt_pk_f16_f32 v135, v106, -v107
    ds_write_addtid_b32 v132 offset:5168
    ds_write_addtid_b32 v133 offset:6256
    ds_write_addtid_b32 v134 offset:0
    ds_write_addtid_b32 v135 offset:272
    ds_read_b128 v[204:207], v5 offset:4352
    ds_read_b128 v[208:211], v5 offset:4416
    ds_read_b128 v[212:215], v5 offset:4480
    ds_read_b128 v[216:219], v5 offset:4544
    v_pk_mul_f32 v[122:123], v[96:97], v[70:71] op_sel:[0,0] op_sel_hi:[0,1]
    v_pk_mul_f32 v[124:125], v[98:99], v[70:71] op_sel:[0,0] op_sel_hi:[0,1]
    v_pk_mul_f32 v[126:127], v[100:101], v[80:81] op_sel:[0,0] op_sel_hi:[0,1]
    v_pk_mul_f32 v[128:129], v[102:103], v[80:81] op_sel:[0,0] op_sel_hi:[0,1]
    v_pk_fma_f32 v[96:97], v[96:97], v[70:71], v[122:123] op_sel:[1,1,0] op_sel_hi:[1,0,1] neg_lo:[0,1,0]
    v_pk_fma_f32 v[98:99], v[98:99], v[70:71], v[124:125] op_sel:[1,1,0] op_sel_hi:[1,0,1] neg_lo:[0,1,0]
    v_pk_fma_f32 v[108:109], v[100:101], v[80:81], v[126:127] op_sel:[1,1,0] op_sel_hi:[1,0,1] neg_lo:[0,1,0]
    v_pk_fma_f32 v[110:111], v[102:103], v[80:81], v[128:129] op_sel:[1,1,0] op_sel_hi:[1,0,1] neg_lo:[0,1,0]
    s_cmp_eq_u32 s44, 4
    s_cbranch_scc1 ssm_pf13_4
    s_cmp_eq_u32 s44, 5
    s_cbranch_scc1 ssm_pf13_5
    s_cmp_eq_u32 s44, 6
    s_cbranch_scc1 ssm_pf13_6
    s_branch ssm_pf13e
ssm_pf13_4:
    s_mul_i32 s47, s59, 124416
    s_add_u32 s47, s47, s60
    s_add_u32 s47, s47, 0
    s_mov_b32 exec_hi, 0xfffffff
    buffer_load_dword v255, v17, s[36:39], s47 offen
    s_branch ssm_pf13e
ssm_pf13_5:
    s_mul_i32 s47, s59, 124416
    s_add_u32 s47, s47, s60
    s_add_u32 s47, s47, 41472
    s_mov_b32 exec_hi, 0xfffffff
    buffer_load_dword v255, v17, s[36:39], s47 offen
    s_branch ssm_pf13e
ssm_pf13_6:
    s_mul_i32 s47, s59, 124416
    s_add_u32 s47, s47, s60
    s_add_u32 s47, s47, 82944
    s_mov_b32 exec_hi, 0xfffffff
    buffer_load_dword v255, v17, s[36:39], s47 offen
ssm_pf13e:
    s_mov_b64 exec, -1
    v_cvt_pk_f16_f32 v136, v96, -v97
    v_cvt_pk_f16_f32 v137, v98, -v99
    v_cvt_pk_f16_f32 v130, v108, -v109
    v_cvt_pk_f16_f32 v131, v110, -v111
    ds_write_addtid_b32 v136 offset:6800
    ds_write_addtid_b32 v137 offset:7344
    ds_write_addtid_b32 v130 offset:544
    ds_write_addtid_b32 v131 offset:816
    v_pk_mul_f32 v[122:123], v[100:101], v[70:71] op_sel:[0,0] op_sel_hi:[0,1]
    v_pk_mul_f32 v[124:125], v[102:103], v[70:71] op_sel:[0,0] op_sel_hi:[0,1]
    v_pk_mul_f32 v[126:127], v[104:105], v[80:81] op_sel:[0,0] op_sel_hi:[0,1]
    v_pk_mul_f32 v[128:129], v[106:107], v[80:81] op_sel:[0,0] op_sel_hi:[0,1]
    v_pk_fma_f32 v[100:101], v[100:101], v[70:71], v[122:123] op_sel:[1,1,0] op_sel_hi:[1,0,1] neg_lo:[0,1,0]
    v_pk_fma_f32 v[102:103], v[102:103], v[70:71], v[124:125] op_sel:[1,1,0] op_sel_hi:[1,0,1] neg_lo:[0,1,0]
    v_pk_fma_f32 v[112:113], v[104:105], v[80:81], v[126:127] op_sel:[1,1,0] op_sel_hi:[1,0,1] neg_lo:[0,1,0]
    v_pk_fma_f32 v[114:115], v[106:107], v[80:81], v[128:129] op_sel:[1,1,0] op_sel_hi:[1,0,1] neg_lo:[0,1,0]
    v_cvt_pk_f16_f32 v132, v100, -v101
    v_cvt_pk_f16_f32 v133, v102, -v103
    v_cvt_pk_f16_f32 v134, v112, -v113
    v_cvt_pk_f16_f32 v135, v114, -v115
    ds_write_addtid_b32 v132 offset:7888
    ds_write_addtid_b32 v133 offset:8432
    ds_write_addtid_b32 v134 offset:1088
    ds_write_addtid_b32 v135 offset:1360
    ds_read_b128 v[220:223], v6 offset:0
    ds_read_b128 v[224:227], v6 offset:64
    ds_read_b128 v[228:231], v6 offset:128
    ds_read_b128 v[232:235], v6 offset:192
    v_pk_mul_f32 v[122:123], v[108:109], v[80:81] op_sel:[0,0] op_sel_hi:[0,1]
    v_pk_mul_f32 v[124:125], v[110:111], v[80:81] op_sel:[0,0] op_sel_hi:[0,1]
    v_pk_mul_f32 v[126:127], v[112:113], v[80:81] op_sel:[0,0] op_sel_hi:[0,1]
    v_pk_fma_f32 v[116:117], v[108:109], v[80:81], v[122:123] op_sel:[1,1,0] op_sel_hi:[1,0,1] neg_lo:[0,1,0]
    v_pk_fma_f32 v[118:119], v[110:111], v[80:81], v[124:125] op_sel:[1,1,0] op_sel_hi:[1,0,1] neg_lo:[0,1,0]
    v_pk_fma_f32 v[120:121], v[112:113], v[80:81], v[126:127] op_sel:[1,1,0] op_sel_hi:[1,0,1] neg_lo:[0,1,0]
    v_cvt_pk_f16_f32 v136, v116, -v117
    v_cvt_pk_f16_f32 v137, v118, -v119
    v_cvt_pk_f16_f32 v130, v120, -v121
    ds_write_addtid_b32 v136 offset:1632
    ds_write_addtid_b32 v137 offset:1904
    ds_write_addtid_b32 v130 offset:2176
    ds_read_b128 v[236:239], v7 offset:0
    ds_read_b128 v[240:243], v7 offset:64
    ds_read_b128 v[244:247], v7 offset:128
    ds_read_b128 v[248:251], v7 offset:192
    s_waitcnt lgkmcnt(7)
    v_mfma_f32_16x16x32_f16 v[140:143], v[188:191], v[172:175], 0
    v_mfma_f32_16x16x32_f16 v[144:147], v[204:207], v[172:175], 0
    v_mfma_f32_16x16x32_f16 v[148:151], v[220:223], v[172:175], 0
    v_mfma_f32_16x16x32_f16 v[140:143], v[192:195], v[176:179], v[140:143]
    v_mfma_f32_16x16x32_f16 v[144:147], v[208:211], v[176:179], v[144:147]
    v_mfma_f32_16x16x32_f16 v[148:151], v[224:227], v[176:179], v[148:151]
    v_mfma_f32_16x16x32_f16 v[140:143], v[196:199], v[180:183], v[140:143]
    v_mfma_f32_16x16x32_f16 v[144:147], v[212:215], v[180:183], v[144:147]
    v_mfma_f32_16x16x32_f16 v[148:151], v[228:231], v[180:183], v[148:151]
    v_mfma_f32_16x16x32_f16 v[140:143], v[200:203], v[184:187], v[140:143]
    v_mfma_f32_16x16x32_f16 v[144:147], v[216:219], v[184:187], v[144:147]
    v_mfma_f32_16x16x32_f16 v[148:151], v[232:235], v[184:187], v[148:151]
    s_waitcnt lgkmcnt(0)
    v_mfma_f32_16x16x32_f16 v[152:155], v[236:239], v[172:175], 0
    v_mfma_f32_16x16x32_f16 v[152:155], v[240:243], v[176:179], v[152:155]
    v_mfma_f32_16x16x32_f16 v[152:155], v[244:247], v[180:183], v[152:155]
    v_mfma_f32_16x16x32_f16 v[152:155], v[248:251], v[184:187], v[152:155]
    s_cmp_lg_u32 s69, 0
    s_cbranch_scc1 ssm_kd
    s_cmp_lg_u32 s46, 0
    s_nop 3
    s_cbranch_scc1 ssm_nu1
    s_and_b32 s47, s59, 3
    s_cmp_eq_u32 s47, 1
    s_cbranch_scc1 ssm_ura1
    s_cmp_eq_u32 s47, 2
    s_cbranch_scc1 ssm_ura2
    s_cmp_eq_u32 s47, 3
    s_cbranch_scc1 ssm_ura3
ssm_ura0:
    buffer_load_dwordx3 v[44:46], v13, s[32:35], s61 offen offset:0
    buffer_load_dwordx3 v[48:50], v13, s[32:35], s61 offen offset:1152
    buffer_load_dwordx3 v[52:54], v13, s[32:35], s61 offen offset:2304
    buffer_load_dwordx3 v[56:58], v13, s[32:35], s61 offen offset:3456
    s_branch ssm_urae
ssm_ura1:
    buffer_load_dwordx3 v[48:50], v13, s[32:35], s61 offen offset:1152
    buffer_load_dwordx3 v[52:54], v13, s[32:35], s61 offen offset:2304
    buffer_load_dwordx3 v[56:58], v13, s[32:35], s61 offen offset:3456
    buffer_load_dwordx3 v[44:46], v13, s[32:35], s61 offen offset:0
    s_branch ssm_urae
ssm_ura2:
    buffer_load_dwordx3 v[52:54], v13, s[32:35], s61 offen offset:2304
    buffer_load_dwordx3 v[56:58], v13, s[32:35], s61 offen offset:3456
    buffer_load_dwordx3 v[44:46], v13, s[32:35], s61 offen offset:0
    buffer_load_dwordx3 v[48:50], v13, s[32:35], s61 offen offset:1152
    s_branch ssm_urae
ssm_ura3:
    buffer_load_dwordx3 v[56:58], v13, s[32:35], s61 offen offset:3456
    buffer_load_dwordx3 v[44:46], v13, s[32:35], s61 offen offset:0
    buffer_load_dwordx3 v[48:50], v13, s[32:35], s61 offen offset:1152
    buffer_load_dwordx3 v[52:54], v13, s[32:35], s61 offen offset:2304
ssm_urae:
    s_mov_b64 exec, s[56:57]
    buffer_load_dwordx3 v[60:62], v14, s[32:35], s61 offen
    s_mov_b64 exec, -1
ssm_nu1:
    s_cmp_eq_u32 s64, 0
    s_cbranch_scc1 ssm_kd1
    v_mul_f32 v156, v20, v140
    v_mul_f32 v157, v20, v141
    v_mul_f32 v158, v20, v142
    v_mul_f32 v159, v20, v143
    v_mul_f32 v160, v20, v144
    v_mul_f32 v161, v20, v145
    v_mul_f32 v162, v20, v146
    v_mul_f32 v163, v20, v147
    v_mul_f32 v164, v20, v148
    v_mul_f32 v165, v20, v149
    v_mul_f32 v166, v20, v150
    v_mul_f32 v167, v20, v151
    v_mul_f32 v168, v20, v152
    v_mul_f32 v169, v20, v153
    v_mul_f32 v170, v20, v154
    v_mul_f32 v171, v20, v155
    v_mov_b32 v32, v38
    v_mov_b32 v33, v39
    v_mov_b32 v34, v40
    v_mov_b32 v35, v41
    v_mov_b32 v36, v42
    s_mov_b32 s69, 1
    s_branch ssm_kt
ssm_kd1:
    v_mov_b32 v25, v26
ssm_kd:
    s_nop 7
    v_mul_f32 v140, v20, v140
    v_mul_f32 v141, v20, v141
    v_mul_f32 v142, v20, v142
    v_mul_f32 v143, v20, v143
    v_mul_f32 v144, v20, v144
    v_mul_f32 v145, v20, v145
    v_mul_f32 v146, v20, v146
    v_mul_f32 v147, v20, v147
    v_mul_f32 v148, v20, v148
    v_mul_f32 v149, v20, v149
    v_mul_f32 v150, v20, v150
    v_mul_f32 v151, v20, v151
    v_mul_f32 v152, v20, v152
    v_mul_f32 v153, v20, v153
    v_mul_f32 v154, v20, v154
    v_mul_f32 v155, v20, v155
    v_add_u32 v2, m0, v10
    s_cmp_eq_u32 s46, 1
    s_cbranch_scc1 ssm_e1
    ds_write_b128 v2, v[152:155]
    ds_write_b128 v2, v[168:171] offset:1024
    s_cmp_lg_u32 s54, 0
    s_cbranch_scc1 ssm_e2
    s_and_b32 s47, s3, 6
    s_bfe_u32 s48, s3, 0x20003
    s_lshl1_add_u32 s47, s47, s48
    s_and_b32 s48, s3, 1
    s_lshl1_add_u32 s56, s47, s48
    s_bfe_u32 s57, s3, 0x10005
    s_add_u32 s57, s57, 4
    s_mov_b32 s12, s8
    s_and_b32 s13, s9, 0xffff
    s_mov_b32 s14, 0xa2000
    s_mov_b32 s15, 0x20000
    s_mov_b32 s48, 0x5556
    v_add_u32 v220, 0, v1
    v_lshrrev_b32 v221, 2, v220
    v_mul_u32_u24 v222, s48, v221
    v_lshrrev_b32 v222, 16, v222
    v_mul_u32_u24 v223, 12, v222
    v_sub_u32 v223, v220, v223
    v_lshrrev_b32 v224, 1, v222
    v_and_b32 v224, 2, v224
    v_xor_b32 v223, v223, v224
    v_mul_u32_u24 v222, 1152, v222
    v_lshl_add_u32 v244, v223, 4, v222
    v_add_u32 v220, 64, v1
    v_lshrrev_b32 v221, 2, v220
    v_mul_u32_u24 v222, s48, v221
    v_lshrrev_b32 v222, 16, v222
    v_mul_u32_u24 v223, 12, v222
    v_sub_u32 v223, v220, v223
    v_lshrrev_b32 v224, 1, v222
    v_and_b32 v224, 2, v224
    v_xor_b32 v223, v223, v224
    v_mul_u32_u24 v222, 1152, v222
    v_lshl_add_u32 v245, v223, 4, v222
    v_subrev_u32 v245, 1024, v245
    v_add_u32 v220, 128, v1
    v_lshrrev_b32 v221, 2, v220
    v_mul_u32_u24 v222, s48, v221
    v_lshrrev_b32 v222, 16, v222
    v_mul_u32_u24 v223, 12, v222
    v_sub_u32 v223, v220, v223
    v_lshrrev_b32 v224, 1, v222
    v_and_b32 v224, 2, v224
    v_xor_b32 v223, v223, v224
    v_mul_u32_u24 v222, 1152, v222
    v_lshl_add_u32 v246, v223, 4, v222
    v_subrev_u32 v246, 2048, v246
    s_and_b32 s48, s57, 0
    s_mul_i32 s48, s48, 18
    s_add_u32 s48, s48, s44
    s_mul_i32 s59, s48, 18432
    s_mul_i32 s48, s57, 192
    s_add_u32 s59, s59, s48
    s_mul_i32 s60, s44, 3072
    s_branch ssm_e2
ssm_e1:
    ds_write_b128 v2, v[140:143] offset:0
    ds_write_b128 v2, v[144:147] offset:1024
    ds_write_b128 v2, v[148:151] offset:2048
    s_cmp_eq_u32 s64, 0
    s_cbranch_scc1 ssm_e2
    ds_write_b128 v2, v[156:159] offset:4096
    ds_write_b128 v2, v[160:163] offset:5120
    ds_write_b128 v2, v[164:167] offset:6144
ssm_e2:
    s_waitcnt lgkmcnt(0)
    s_barrier
    s_xor_b32 s47, s44, 4
    s_mul_i32 s47, s47, 8704
    v_add_u32 v2, s47, v10
    ds_read_b128 v[172:175], v2 offset:0
    ds_read_b128 v[176:179], v2 offset:1024
    ds_read_b128 v[180:183], v2 offset:2048
    s_mul_i32 s47, s46, 64000
    s_sub_u32 s47, 65024, s47
    v_add_u32 v2, s47, v10
    ds_read_b128 v[184:187], v2 offset:0
    ds_read_b128 v[188:191], v2 offset:1024
    ds_read_b128 v[192:195], v2 offset:2048
    s_waitcnt lgkmcnt(0)
    s_cmp_eq_u32 s46, 1
    s_cbranch_scc1 ssm_x1
    v_pk_add_f32 v[140:141], v[140:141], v[172:173]
    v_pk_add_f32 v[142:143], v[142:143], v[174:175]
    v_pk_add_f32 v[144:145], v[144:145], v[176:177]
    v_pk_add_f32 v[146:147], v[146:147], v[178:179]
    v_pk_add_f32 v[148:149], v[148:149], v[180:181]
    v_pk_add_f32 v[150:151], v[150:151], v[182:183]
    v_lshlrev_b32 v25, 16, v25
    v_add_u32 v2, s65, v18
    v_add_u32 v3, s65, v10
    s_mov_b64 exec, 1
    v_add_f32 v140, v140, v25
    s_mov_b64 exec, -1
    v_mov_b32_dpp v146, v146 row_shl:1 row_mask:0xa bank_mask:0xf
    v_mov_b32_dpp v151, v148 row_shl:1 row_mask:0xf bank_mask:0xf
    v_cvt_pk_bf16_f32 v204, v140, v141
    v_cvt_pk_bf16_f32 v205, v142, v143
    v_mov_b32_dpp v146, v147 row_shr:15 row_mask:0xa bank_mask:0xf
    v_mov_b32_dpp v151, v150 row_shr:15 row_mask:0xf bank_mask:0xf
    ds_write_b64 v2, v[204:205]
    v_cvt_pk_bf16_f32 v206, v144, v144
    v_cvt_pk_bf16_f32 v208, v148, v148
    v_cvt_pk_bf16_f32 v209, v148, v149
    v_cvt_pk_bf16_f32 v210, v149, v149
    v_cvt_pk_bf16_f32 v207, v145, v146
    v_cvt_pk_bf16_f32 v211, v151, v151
    ds_write_b64 v2, v[206:207] offset:512
    ds_write_b128 v3, v[208:211] offset:1024
    s_cmp_eq_u32 s64, 0
    s_cbranch_scc1 ssm_x2
    v_pk_add_f32 v[156:157], v[156:157], v[184:185]
    v_pk_add_f32 v[158:159], v[158:159], v[186:187]
    v_pk_add_f32 v[160:161], v[160:161], v[188:189]
    v_pk_add_f32 v[162:163], v[162:163], v[190:191]
    v_pk_add_f32 v[164:165], v[164:165], v[192:193]
    v_pk_add_f32 v[166:167], v[166:167], v[194:195]
    v_lshlrev_b32 v26, 16, v26
    v_add_u32 v2, 158848, v18
    v_add_u32 v3, 158848, v10
    s_mov_b64 exec, 1
    v_add_f32 v156, v156, v26
    s_mov_b64 exec, -1
    v_mov_b32_dpp v162, v162 row_shl:1 row_mask:0xa bank_mask:0xf
    v_mov_b32_dpp v167, v164 row_shl:1 row_mask:0xf bank_mask:0xf
    v_cvt_pk_bf16_f32 v204, v156, v157
    v_cvt_pk_bf16_f32 v205, v158, v159
    v_mov_b32_dpp v162, v163 row_shr:15 row_mask:0xa bank_mask:0xf
    v_mov_b32_dpp v167, v166 row_shr:15 row_mask:0xf bank_mask:0xf
    ds_write_b64 v2, v[204:205]
    v_cvt_pk_bf16_f32 v206, v160, v160
    v_cvt_pk_bf16_f32 v208, v164, v164
    v_cvt_pk_bf16_f32 v209, v164, v165
    v_cvt_pk_bf16_f32 v210, v165, v165
    v_cvt_pk_bf16_f32 v207, v161, v162
    v_cvt_pk_bf16_f32 v211, v167, v167
    ds_write_b64 v2, v[206:207] offset:512
    ds_write_b128 v3, v[208:211] offset:1024
    v_mov_b32 v112, 0
    v_mov_b32 v113, 0
    v_mov_b32 v114, 0
    v_mov_b32 v115, 0
    v_lshrrev_b32 v2, 5, v1
    v_and_b32 v3, 31, v1
    v_mul_u32_u24 v2, 8864, v2
    v_lshl_add_u32 v2, v3, 4, v2
    s_mov_b32 exec_lo, 0x3ffffff
    s_mov_b32 exec_hi, 0x3ffffff
    ds_write_b128 v2, v[112:115] offset:24576
    ds_write_b128 v2, v[112:115] offset:42304
    s_mov_b64 exec, -1
    s_branch ssm_x2
ssm_x1:
    v_pk_add_f32 v[152:153], v[152:153], v[172:173]
    v_pk_add_f32 v[154:155], v[154:155], v[174:175]
    v_add_u32 v2, s65, v19
    s_mov_b32 vcc_lo, 0x55555555
    s_mov_b32 vcc_hi, 0x55555555
    v_mov_b32_dpp v216, v152 row_shl:1 row_mask:0xf bank_mask:0xf
    v_mov_b32_dpp v217, v153 row_shl:1 row_mask:0xf bank_mask:0xf
    v_mov_b32_dpp v218, v154 row_shl:1 row_mask:0xf bank_mask:0xf
    v_mov_b32_dpp v216, v153 row_shr:15 row_mask:0xf bank_mask:0xf
    v_mov_b32_dpp v217, v154 row_shr:15 row_mask:0xf bank_mask:0xf
    v_mov_b32_dpp v218, v155 row_shr:15 row_mask:0xf bank_mask:0xf
    v_cvt_pk_bf16_f32 v204, v152, v152
    v_cndmask_b32 v152, v216, v152, vcc
    v_cvt_pk_bf16_f32 v207, v216, v216
    v_mov_b32 v205, v204
    v_cvt_pk_bf16_f32 v206, v152, v216
    v_cvt_pk_bf16_f32 v208, v153, v153
    v_cndmask_b32 v153, v217, v153, vcc
    v_cvt_pk_bf16_f32 v211, v217, v217
    v_mov_b32 v209, v208
    v_cvt_pk_bf16_f32 v210, v153, v217
    v_cvt_pk_bf16_f32 v212, v154, v154
    v_cndmask_b32 v154, v218, v154, vcc
    v_cvt_pk_bf16_f32 v215, v218, v218
    v_mov_b32 v213, v212
    v_cvt_pk_bf16_f32 v214, v154, v218
    s_mov_b32 exec_hi, 0xffff
    ds_write_b128 v2, v[204:207] offset:2048
    ds_write_b128 v2, v[208:211] offset:2304
    s_mov_b32 exec_hi, 0
    ds_write_b128 v2, v[212:215] offset:2560
    s_mov_b64 exec, -1
    s_cmp_eq_u32 s64, 0
    s_cbranch_scc1 ssm_x2
    v_pk_add_f32 v[168:169], v[168:169], v[184:185]
    v_pk_add_f32 v[170:171], v[170:171], v[186:187]
    v_add_u32 v2, 158848, v19
    s_mov_b32 vcc_lo, 0x55555555
    s_mov_b32 vcc_hi, 0x55555555
    v_mov_b32_dpp v216, v168 row_shl:1 row_mask:0xf bank_mask:0xf
    v_mov_b32_dpp v217, v169 row_shl:1 row_mask:0xf bank_mask:0xf
    v_mov_b32_dpp v218, v170 row_shl:1 row_mask:0xf bank_mask:0xf
    v_mov_b32_dpp v216, v169 row_shr:15 row_mask:0xf bank_mask:0xf
    v_mov_b32_dpp v217, v170 row_shr:15 row_mask:0xf bank_mask:0xf
    v_mov_b32_dpp v218, v171 row_shr:15 row_mask:0xf bank_mask:0xf
    v_cvt_pk_bf16_f32 v204, v168, v168
    v_cndmask_b32 v168, v216, v168, vcc
    v_cvt_pk_bf16_f32 v207, v216, v216
    v_mov_b32 v205, v204
    v_cvt_pk_bf16_f32 v206, v168, v216
    v_cvt_pk_bf16_f32 v208, v169, v169
    v_cndmask_b32 v169, v217, v169, vcc
    v_cvt_pk_bf16_f32 v211, v217, v217
    v_mov_b32 v209, v208
    v_cvt_pk_bf16_f32 v210, v169, v217
    v_cvt_pk_bf16_f32 v212, v170, v170
    v_cndmask_b32 v170, v218, v170, vcc
    v_cvt_pk_bf16_f32 v215, v218, v218
    v_mov_b32 v213, v212
    v_cvt_pk_bf16_f32 v214, v170, v218
    s_mov_b32 exec_hi, 0xffff
    ds_write_b128 v2, v[204:207] offset:2048
    ds_write_b128 v2, v[208:211] offset:2304
    s_mov_b32 exec_hi, 0
    ds_write_b128 v2, v[212:215] offset:2560
    s_mov_b64 exec, -1
ssm_x2:
    s_setprio 0
    s_cmp_eq_u32 s46, 0
    s_cbranch_scc1 ssm_c1
    s_setprio 1
    s_branch ssm_x3a
ssm_c1:
    s_waitcnt vmcnt(0)
    s_mov_b32 s50, 0
ssm_tga:
    v_cmp_ne_u32 vcc, 0, v28
    s_nop 3
    s_cbranch_vccnz ssm_tha
    global_load_dword v28, v27, s[28:29] sc1
    s_add_u32 s50, s50, 1
    s_cmp_lt_u32 s50, 32768
    s_waitcnt vmcnt(0)
    s_cbranch_scc1 ssm_tga
ssm_tha:
    v_mov_b32_dpp v60, v44 row_shl:1 row_mask:0xf bank_mask:0xf
    v_mov_b32_dpp v61, v45 row_shl:1 row_mask:0xf bank_mask:0xf
    v_mov_b32_dpp v62, v46 row_shl:1 row_mask:0xf bank_mask:0xf
    s_cmp_eq_u32 s55, 0
    s_cbranch_scc1 ssm_nrota
    v_lshrrev_b32 v47, 16, v44
    v_mov_b32 v44, v45
    v_mov_b32 v45, v46
    v_mov_b32 v46, v47
    v_lshrrev_b32 v51, 16, v48
    v_mov_b32 v48, v49
    v_mov_b32 v49, v50
    v_mov_b32 v50, v51
    v_lshrrev_b32 v55, 16, v52
    v_mov_b32 v52, v53
    v_mov_b32 v53, v54
    v_mov_b32 v54, v55
    v_lshrrev_b32 v59, 16, v56
    v_mov_b32 v56, v57
    v_mov_b32 v57, v58
    v_mov_b32 v58, v59
    v_lshrrev_b32 v63, 16, v60
    v_mov_b32 v60, v61
    v_mov_b32 v61, v62
    v_mov_b32 v62, v63
ssm_nrota:
    v_perm_b32 v96, v56, v60, s66
    v_perm_b32 v97, v48, v52, s66
    v_perm_b32 v98, v52, v56, s66
    v_perm_b32 v99, v44, v48, s66
    v_add_u32 v3, 4512, v12
    v_add_u32 v21, 9024, v12
    ds_write_b64 v12, v[96:97] offset:0
    ds_write_b64 v12, v[98:99] offset:13544
    ds_write2_b32 v3, v98, v99 offset0:1 offset1:2
    ds_write2_b32 v21, v96, v97 offset0:1 offset1:2
    v_perm_b32 v100, v56, v60, s67
    v_perm_b32 v101, v48, v52, s67
    v_perm_b32 v102, v52, v56, s67
    v_perm_b32 v103, v44, v48, s67
    v_add_u32 v3, 22560, v12
    v_add_u32 v21, 27072, v12
    ds_write_b64 v12, v[100:101] offset:18048
    ds_write_b64 v12, v[102:103] offset:31592
    ds_write2_b32 v3, v102, v103 offset0:1 offset1:2
    ds_write2_b32 v21, v100, v101 offset0:1 offset1:2
    v_perm_b32 v104, v57, v61, s66
    v_perm_b32 v105, v49, v53, s66
    v_perm_b32 v106, v53, v57, s66
    v_perm_b32 v107, v45, v49, s66
    v_add_u32 v3, 40608, v12
    v_add_u32 v21, 45120, v12
    ds_write_b64 v12, v[104:105] offset:36096
    ds_write_b64 v12, v[106:107] offset:49640
    ds_write2_b32 v3, v106, v107 offset0:1 offset1:2
    ds_write2_b32 v21, v104, v105 offset0:1 offset1:2
    v_perm_b32 v108, v57, v61, s67
    v_perm_b32 v109, v49, v53, s67
    v_perm_b32 v110, v53, v57, s67
    v_perm_b32 v111, v45, v49, s67
    v_add_u32 v3, 58656, v12
    v_add_u32 v21, 63168, v12
    v_add_u32 v2, 54144, v12
    ds_write_b64 v2, v[108:109]
    ds_write_b64 v2, v[110:111] offset:13544
    ds_write2_b32 v3, v110, v111 offset0:1 offset1:2
    ds_write2_b32 v21, v108, v109 offset0:1 offset1:2
    s_cmp_lg_u32 s44, 0
    s_cbranch_scc1 ssm_nou0
    s_mov_b64 exec, 1
    v_mov_b32 v2, 73736
    ds_write_b16_d16_hi v2, v99
    ds_write_b16_d16_hi v2, v99 offset:9028
    v_mov_b32 v2, 91784
    ds_write_b16_d16_hi v2, v103
    ds_write_b16_d16_hi v2, v103 offset:9028
    v_mov_b32 v2, 109832
    ds_write_b16_d16_hi v2, v107
    ds_write_b16_d16_hi v2, v107 offset:9028
    v_mov_b32 v2, 127880
    ds_write_b16_d16_hi v2, v111
    ds_write_b16_d16_hi v2, v111 offset:9028
    s_mov_b64 exec, -1
ssm_nou0:
    s_cmp_eq_u32 s54, 0
    s_cbranch_scc1 ssm_x3a
    v_perm_b32 v96, v58, v62, s66
    v_perm_b32 v97, v50, v54, s66
    v_perm_b32 v98, v54, v58, s66
    v_perm_b32 v99, v46, v50, s66
    v_subrev_u32 v3, 40288, v12
    v_subrev_u32 v21, 31424, v12
    v_subrev_u32 v2, 49152, v12
    ds_write_b64 v2, v[96:97]
    ds_write_b64 v2, v[98:99] offset:26600
    ds_write2_b32 v3, v98, v99 offset0:1 offset1:2
    ds_write2_b32 v21, v96, v97 offset0:1 offset1:2
    s_cmp_lg_u32 s44, 0
    s_cbranch_scc1 ssm_x3a
    s_mov_b64 exec, 1
    v_mov_b32 v2, 24584
    ds_write_b16_d16_hi v2, v99
    ds_write_b16_d16_hi v2, v99 offset:17732
    s_mov_b64 exec, -1
ssm_x3a:
    s_waitcnt lgkmcnt(0)
    s_barrier
    s_waitcnt lgkmcnt(0)
    ds_read_b128 v[112:115], v8 offset:4032
    ds_read_b64 v[128:129], v9 offset:192
    ds_read_b64 v[130:131], v9 offset:200
    ds_read_b128 v[116:119], v8 offset:3520
    ds_read_b64 v[132:133], v9 offset:704
    ds_read_b64 v[134:135], v9 offset:712
    ds_read_b128 v[120:123], v8 offset:3008
    ds_read_b64 v[136:137], v9 offset:1216
    ds_read_b64 v[138:139], v9 offset:1224
    ds_read_b128 v[124:127], v8 offset:2496
    ds_read_b64 v[140:141], v9 offset:1728
    ds_read_b64 v[142:143], v9 offset:1736
    s_waitcnt lgkmcnt(9)
    v_mfma_f32_16x16x32_bf16 v[64:67], v[112:115], v[128:131], 0
    ds_read_b64 v[160:161], v9 offset:2240
    s_waitcnt lgkmcnt(9)
    v_mfma_f32_16x16x32_bf16 v[68:71], v[116:119], v[128:131], 0
    ds_read_b64 v[162:163], v9 offset:2248
    s_cmp_eq_u32 s46, 0
    s_cbranch_scc1 ssm_h2
    s_and_b32 s47, s59, 3
    s_cmp_eq_u32 s47, 1
    s_cbranch_scc1 ssm_urb21
    s_cmp_eq_u32 s47, 2
    s_cbranch_scc1 ssm_urb22
    s_cmp_eq_u32 s47, 3
    s_cbranch_scc1 ssm_urb23
ssm_urb20:
    buffer_load_dwordx3 v[44:46], v13, s[32:35], s61 offen offset:0
    s_branch ssm_urb2e
ssm_urb21:
    buffer_load_dwordx3 v[48:50], v13, s[32:35], s61 offen offset:1152
    s_branch ssm_urb2e
ssm_urb22:
    buffer_load_dwordx3 v[52:54], v13, s[32:35], s61 offen offset:2304
    s_branch ssm_urb2e
ssm_urb23:
    buffer_load_dwordx3 v[56:58], v13, s[32:35], s61 offen offset:3456
ssm_urb2e:
ssm_h2:
    s_waitcnt lgkmcnt(8)
    v_mfma_f32_16x16x32_bf16 v[68:71], v[112:115], v[132:135], v[68:71]
    ds_read_b64 v[164:165], v9 offset:2752
    v_mfma_f32_16x16x32_bf16 v[72:75], v[116:119], v[132:135], 0
    ds_read_b64 v[166:167], v9 offset:2760
    s_waitcnt lgkmcnt(9)
    v_mfma_f32_16x16x32_bf16 v[72:75], v[120:123], v[128:131], v[72:75]
    ds_read_b64 v[168:169], v9 offset:3264
    v_mfma_f32_16x16x32_bf16 v[76:79], v[120:123], v[132:135], 0
    ds_read_b64 v[170:171], v9 offset:3272
    s_waitcnt lgkmcnt(9)
    v_mfma_f32_16x16x32_bf16 v[72:75], v[112:115], v[136:139], v[72:75]
    ds_read_b64 v[172:173], v9 offset:3776
    v_mfma_f32_16x16x32_bf16 v[76:79], v[116:119], v[136:139], v[76:79]
    ds_read_b64 v[174:175], v9 offset:3784
    v_mfma_f32_16x16x32_bf16 v[80:83], v[120:123], v[136:139], 0
    ds_read_b128 v[176:179], v8 offset:3968
    s_waitcnt lgkmcnt(11)
    v_mfma_f32_16x16x32_bf16 v[76:79], v[124:127], v[128:131], v[76:79]
    ds_read_b64 v[192:193], v9 offset:128
    v_mfma_f32_16x16x32_bf16 v[80:83], v[124:127], v[132:135], v[80:83]
    ds_read_b64 v[194:195], v9 offset:136
    v_mfma_f32_16x16x32_bf16 v[84:87], v[124:127], v[136:139], 0
    ds_read_b128 v[180:183], v8 offset:3456
    s_waitcnt lgkmcnt(12)
    v_mfma_f32_16x16x32_bf16 v[76:79], v[112:115], v[140:143], v[76:79]
    ds_read_b64 v[196:197], v9 offset:640
    v_mfma_f32_16x16x32_bf16 v[80:83], v[116:119], v[140:143], v[80:83]
    ds_read_b64 v[198:199], v9 offset:648
    s_cmp_eq_u32 s46, 0
    s_cbranch_scc1 ssm_h14
    s_and_b32 s47, s59, 3
    s_cmp_eq_u32 s47, 1
    s_cbranch_scc1 ssm_urb141
    s_cmp_eq_u32 s47, 2
    s_cbranch_scc1 ssm_urb142
    s_cmp_eq_u32 s47, 3
    s_cbranch_scc1 ssm_urb143
ssm_urb140:
    buffer_load_dwordx3 v[48:50], v13, s[32:35], s61 offen offset:1152
    s_branch ssm_urb14e
ssm_urb141:
    buffer_load_dwordx3 v[52:54], v13, s[32:35], s61 offen offset:2304
    s_branch ssm_urb14e
ssm_urb142:
    buffer_load_dwordx3 v[56:58], v13, s[32:35], s61 offen offset:3456
    s_branch ssm_urb14e
ssm_urb143:
    buffer_load_dwordx3 v[44:46], v13, s[32:35], s61 offen offset:0
ssm_urb14e:
ssm_h14:
    v_mfma_f32_16x16x32_bf16 v[84:87], v[120:123], v[140:143], v[84:87]
    ds_read_b128 v[184:187], v8 offset:2944
    v_mfma_f32_16x16x32_bf16 v[88:91], v[124:127], v[140:143], 0
    s_waitcnt lgkmcnt(13)
    v_mfma_f32_16x16x32_bf16 v[80:83], v[112:115], v[160:163], v[80:83]
    ds_read_b64 v[200:201], v9 offset:1152
    v_mfma_f32_16x16x32_bf16 v[84:87], v[116:119], v[160:163], v[84:87]
    ds_read_b64 v[202:203], v9 offset:1160
    v_mfma_f32_16x16x32_bf16 v[88:91], v[120:123], v[160:163], v[88:91]
    v_mfma_f32_16x16x32_bf16 v[92:95], v[124:127], v[160:163], 0
    s_waitcnt lgkmcnt(13)
    v_mfma_f32_16x16x32_bf16 v[84:87], v[112:115], v[164:167], v[84:87]
    ds_read_b128 v[188:191], v8 offset:2432
    v_mfma_f32_16x16x32_bf16 v[88:91], v[116:119], v[164:167], v[88:91]
    ds_read_b64 v[204:205], v9 offset:1664
    v_mfma_f32_16x16x32_bf16 v[92:95], v[120:123], v[164:167], v[92:95]
    s_waitcnt lgkmcnt(13)
    v_mfma_f32_16x16x32_bf16 v[88:91], v[112:115], v[168:171], v[88:91]
    ds_read_b64 v[206:207], v9 offset:1672
    v_mfma_f32_16x16x32_bf16 v[92:95], v[116:119], v[168:171], v[92:95]
    ds_read_b64 v[224:225], v9 offset:2176
    s_waitcnt lgkmcnt(13)
    v_mfma_f32_16x16x32_bf16 v[92:95], v[112:115], v[172:175], v[92:95]
    ds_read_b64 v[226:227], v9 offset:2184
    s_cmp_eq_u32 s46, 0
    s_cbranch_scc1 ssm_h26
    s_and_b32 s47, s59, 3
    s_cmp_eq_u32 s47, 1
    s_cbranch_scc1 ssm_urb261
    s_cmp_eq_u32 s47, 2
    s_cbranch_scc1 ssm_urb262
    s_cmp_eq_u32 s47, 3
    s_cbranch_scc1 ssm_urb263
ssm_urb260:
    buffer_load_dwordx3 v[52:54], v13, s[32:35], s61 offen offset:2304
    s_branch ssm_urb26e
ssm_urb261:
    buffer_load_dwordx3 v[56:58], v13, s[32:35], s61 offen offset:3456
    s_branch ssm_urb26e
ssm_urb262:
    buffer_load_dwordx3 v[44:46], v13, s[32:35], s61 offen offset:0
    s_branch ssm_urb26e
ssm_urb263:
    buffer_load_dwordx3 v[48:50], v13, s[32:35], s61 offen offset:1152
ssm_urb26e:
ssm_h26:
    s_waitcnt lgkmcnt(11)
    v_mfma_f32_16x16x32_bf16 v[64:67], v[176:179], v[192:195], v[64:67]
    ds_read_b64 v[228:229], v9 offset:2688
    s_waitcnt lgkmcnt(11)
    v_mfma_f32_16x16x32_bf16 v[68:71], v[180:183], v[192:195], v[68:71]
    ds_read_b64 v[230:231], v9 offset:2696
    s_waitcnt lgkmcnt(10)
    v_mfma_f32_16x16x32_bf16 v[68:71], v[176:179], v[196:199], v[68:71]
    ds_read_b64 v[232:233], v9 offset:3200
    v_mfma_f32_16x16x32_bf16 v[72:75], v[180:183], v[196:199], v[72:75]
    ds_read_b64 v[234:235], v9 offset:3208
    s_waitcnt lgkmcnt(11)
    v_mfma_f32_16x16x32_bf16 v[72:75], v[184:187], v[192:195], v[72:75]
    ds_read_b64 v[236:237], v9 offset:3712
    v_mfma_f32_16x16x32_bf16 v[76:79], v[184:187], v[196:199], v[76:79]
    ds_read_b64 v[238:239], v9 offset:3720
    s_waitcnt lgkmcnt(11)
    v_mfma_f32_16x16x32_bf16 v[72:75], v[176:179], v[200:203], v[72:75]
    ds_read_b128 v[112:115], v8 offset:3904
    v_mfma_f32_16x16x32_bf16 v[76:79], v[180:183], v[200:203], v[76:79]
    ds_read_b64 v[144:145], v9 offset:64
    v_mfma_f32_16x16x32_bf16 v[80:83], v[184:187], v[200:203], v[80:83]
    ds_read_b64 v[146:147], v9 offset:72
    s_waitcnt lgkmcnt(13)
    v_mfma_f32_16x16x32_bf16 v[76:79], v[188:191], v[192:195], v[76:79]
    ds_read_b128 v[116:119], v8 offset:3392
    v_mfma_f32_16x16x32_bf16 v[80:83], v[188:191], v[196:199], v[80:83]
    ds_read_b64 v[148:149], v9 offset:576
    v_mfma_f32_16x16x32_bf16 v[84:87], v[188:191], v[200:203], v[84:87]
    s_cmp_eq_u32 s46, 0
    s_cbranch_scc1 ssm_h38
    s_and_b32 s47, s59, 3
    s_cmp_eq_u32 s47, 1
    s_cbranch_scc1 ssm_urb381
    s_cmp_eq_u32 s47, 2
    s_cbranch_scc1 ssm_urb382
    s_cmp_eq_u32 s47, 3
    s_cbranch_scc1 ssm_urb383
ssm_urb380:
    buffer_load_dwordx3 v[56:58], v13, s[32:35], s61 offen offset:3456
    s_branch ssm_urb38e
ssm_urb381:
    buffer_load_dwordx3 v[44:46], v13, s[32:35], s61 offen offset:0
    s_branch ssm_urb38e
ssm_urb382:
    buffer_load_dwordx3 v[48:50], v13, s[32:35], s61 offen offset:1152
    s_branch ssm_urb38e
ssm_urb383:
    buffer_load_dwordx3 v[52:54], v13, s[32:35], s61 offen offset:2304
ssm_urb38e:
ssm_h38:
    s_waitcnt lgkmcnt(13)
    v_mfma_f32_16x16x32_bf16 v[76:79], v[176:179], v[204:207], v[76:79]
    ds_read_b64 v[150:151], v9 offset:584
    v_mfma_f32_16x16x32_bf16 v[80:83], v[180:183], v[204:207], v[80:83]
    ds_read_b128 v[120:123], v8 offset:2880
    v_mfma_f32_16x16x32_bf16 v[84:87], v[184:187], v[204:207], v[84:87]
    v_mfma_f32_16x16x32_bf16 v[88:91], v[188:191], v[204:207], v[88:91]
    s_waitcnt lgkmcnt(13)
    v_mfma_f32_16x16x32_bf16 v[80:83], v[176:179], v[224:227], v[80:83]
    ds_read_b64 v[152:153], v9 offset:1088
    v_mfma_f32_16x16x32_bf16 v[84:87], v[180:183], v[224:227], v[84:87]
    ds_read_b64 v[154:155], v9 offset:1096
    v_mfma_f32_16x16x32_bf16 v[88:91], v[184:187], v[224:227], v[88:91]
    v_mfma_f32_16x16x32_bf16 v[92:95], v[188:191], v[224:227], v[92:95]
    s_waitcnt lgkmcnt(13)
    v_mfma_f32_16x16x32_bf16 v[84:87], v[176:179], v[228:231], v[84:87]
    ds_read_b128 v[124:127], v8 offset:2368
    v_mfma_f32_16x16x32_bf16 v[88:91], v[180:183], v[228:231], v[88:91]
    ds_read_b64 v[156:157], v9 offset:1600
    v_mfma_f32_16x16x32_bf16 v[92:95], v[184:187], v[228:231], v[92:95]
    s_waitcnt lgkmcnt(13)
    v_mfma_f32_16x16x32_bf16 v[88:91], v[176:179], v[232:235], v[88:91]
    ds_read_b64 v[158:159], v9 offset:1608
    s_cmp_eq_u32 s46, 0
    s_cbranch_scc1 ssm_h50
    s_mov_b64 exec, s[56:57]
    buffer_load_dwordx3 v[60:62], v14, s[32:35], s61 offen
    s_mov_b64 exec, -1
ssm_h50:
    v_mfma_f32_16x16x32_bf16 v[92:95], v[180:183], v[232:235], v[92:95]
    ds_read_b64 v[160:161], v9 offset:2112
    s_waitcnt lgkmcnt(13)
    v_mfma_f32_16x16x32_bf16 v[92:95], v[176:179], v[236:239], v[92:95]
    ds_read_b64 v[162:163], v9 offset:2120
    s_waitcnt lgkmcnt(11)
    v_mfma_f32_16x16x32_bf16 v[64:67], v[112:115], v[144:147], v[64:67]
    ds_read_b64 v[164:165], v9 offset:2624
    s_waitcnt lgkmcnt(11)
    v_mfma_f32_16x16x32_bf16 v[68:71], v[116:119], v[144:147], v[68:71]
    ds_read_b64 v[166:167], v9 offset:2632
    s_waitcnt lgkmcnt(10)
    v_mfma_f32_16x16x32_bf16 v[68:71], v[112:115], v[148:151], v[68:71]
    ds_read_b64 v[168:169], v9 offset:3136
    v_mfma_f32_16x16x32_bf16 v[72:75], v[116:119], v[148:151], v[72:75]
    ds_read_b64 v[170:171], v9 offset:3144
    s_waitcnt lgkmcnt(11)
    v_mfma_f32_16x16x32_bf16 v[72:75], v[120:123], v[144:147], v[72:75]
    ds_read_b64 v[172:173], v9 offset:3648
    v_mfma_f32_16x16x32_bf16 v[76:79], v[120:123], v[148:151], v[76:79]
    ds_read_b64 v[174:175], v9 offset:3656
    s_waitcnt lgkmcnt(11)
    v_mfma_f32_16x16x32_bf16 v[72:75], v[112:115], v[152:155], v[72:75]
    ds_read_b128 v[176:179], v8 offset:3840
    v_mfma_f32_16x16x32_bf16 v[76:79], v[116:119], v[152:155], v[76:79]
    ds_read_b64 v[208:209], v9 offset:0
    v_mfma_f32_16x16x32_bf16 v[80:83], v[120:123], v[152:155], v[80:83]
    ds_read_b64 v[210:211], v9 offset:8
    s_waitcnt lgkmcnt(13)
    v_mfma_f32_16x16x32_bf16 v[76:79], v[124:127], v[144:147], v[76:79]
    ds_read_b128 v[180:183], v8 offset:3328
    v_mfma_f32_16x16x32_bf16 v[80:83], v[124:127], v[148:151], v[80:83]
    ds_read_b64 v[212:213], v9 offset:512
    v_mfma_f32_16x16x32_bf16 v[84:87], v[124:127], v[152:155], v[84:87]
    s_waitcnt lgkmcnt(13)
    v_mfma_f32_16x16x32_bf16 v[76:79], v[112:115], v[156:159], v[76:79]
    ds_read_b64 v[214:215], v9 offset:520
    v_mfma_f32_16x16x32_bf16 v[80:83], v[116:119], v[156:159], v[80:83]
    ds_read_b128 v[184:187], v8 offset:2816
    s_cmp_eq_u32 s44, 4
    s_cbranch_scc1 ssm_pfM_4
    s_cmp_eq_u32 s44, 5
    s_cbranch_scc1 ssm_pfM_5
    s_cmp_eq_u32 s44, 6
    s_cbranch_scc1 ssm_pfM_6
    s_cmp_eq_u32 s44, 7
    s_cbranch_scc1 ssm_pfM_7
    s_branch ssm_pfMe
ssm_pfM_4:
    s_mul_i32 s47, s59, 41472
    s_add_u32 s47, s47, 0
    v_lshlrev_b32 v2, 7, v1
    s_mov_b32 exec_hi, 0x3fffff
    buffer_load_dword v255, v2, s[12:15], s47 offen
    s_branch ssm_pfMe
ssm_pfM_5:
    s_mul_i32 s47, s59, 41472
    s_add_u32 s47, s47, 6912
    v_lshlrev_b32 v2, 7, v1
    s_mov_b32 exec_hi, 0x3fffff
    buffer_load_dword v255, v2, s[12:15], s47 offen
    s_branch ssm_pfMe
ssm_pfM_6:
    s_mul_i32 s47, s59, 41472
    s_add_u32 s47, s47, 13824
    v_lshlrev_b32 v2, 7, v1
    s_mov_b32 exec_hi, 0x3fffff
    buffer_load_dword v255, v2, s[12:15], s47 offen
    s_branch ssm_pfMe
ssm_pfM_7:
    s_mul_i32 s47, s59, 41472
    s_add_u32 s47, s47, 20736
    v_lshlrev_b32 v2, 7, v1
    s_mov_b32 exec_hi, 0x3fffff
    buffer_load_dword v255, v2, s[12:15], s47 offen
ssm_pfMe:
    s_mov_b64 exec, -1
    v_mfma_f32_16x16x32_bf16 v[84:87], v[120:123], v[156:159], v[84:87]
    v_mfma_f32_16x16x32_bf16 v[88:91], v[124:127], v[156:159], v[88:91]
    s_waitcnt lgkmcnt(13)
    v_mfma_f32_16x16x32_bf16 v[80:83], v[112:115], v[160:163], v[80:83]
    ds_read_b64 v[216:217], v9 offset:1024
    v_mfma_f32_16x16x32_bf16 v[84:87], v[116:119], v[160:163], v[84:87]
    ds_read_b64 v[218:219], v9 offset:1032
    v_mfma_f32_16x16x32_bf16 v[88:91], v[120:123], v[160:163], v[88:91]
    v_mfma_f32_16x16x32_bf16 v[92:95], v[124:127], v[160:163], v[92:95]
    s_waitcnt lgkmcnt(13)
    v_mfma_f32_16x16x32_bf16 v[84:87], v[112:115], v[164:167], v[84:87]
    ds_read_b128 v[188:191], v8 offset:2304
    v_mfma_f32_16x16x32_bf16 v[88:91], v[116:119], v[164:167], v[88:91]
    ds_read_b64 v[220:221], v9 offset:1536
    v_mfma_f32_16x16x32_bf16 v[92:95], v[120:123], v[164:167], v[92:95]
    s_waitcnt lgkmcnt(13)
    v_mfma_f32_16x16x32_bf16 v[88:91], v[112:115], v[168:171], v[88:91]
    ds_read_b64 v[222:223], v9 offset:1544
    v_mfma_f32_16x16x32_bf16 v[92:95], v[116:119], v[168:171], v[92:95]
    ds_read_b64 v[224:225], v9 offset:2048
    s_waitcnt lgkmcnt(13)
    v_mfma_f32_16x16x32_bf16 v[92:95], v[112:115], v[172:175], v[92:95]
    ds_read_b64 v[226:227], v9 offset:2056
    s_waitcnt lgkmcnt(11)
    v_mfma_f32_16x16x32_bf16 v[64:67], v[176:179], v[208:211], v[64:67]
    ds_read_b64 v[228:229], v9 offset:2560
    s_waitcnt lgkmcnt(11)
    v_mfma_f32_16x16x32_bf16 v[68:71], v[180:183], v[208:211], v[68:71]
    ds_read_b64 v[230:231], v9 offset:2568
    s_cmp_eq_u32 s44, 4
    s_cbranch_scc1 ssm_pfN_4
    s_cmp_eq_u32 s44, 5
    s_cbranch_scc1 ssm_pfN_5
    s_cmp_eq_u32 s44, 6
    s_cbranch_scc1 ssm_pfN_6
    s_cmp_eq_u32 s44, 7
    s_cbranch_scc1 ssm_pfN_7
    s_branch ssm_pfNe
ssm_pfN_4:
    s_mul_i32 s47, s59, 41472
    s_add_u32 s47, s47, 27648
    v_lshlrev_b32 v2, 7, v1
    s_mov_b32 exec_hi, 0x3fffff
    buffer_load_dword v255, v2, s[12:15], s47 offen
    s_branch ssm_pfNe
ssm_pfN_5:
    s_mul_i32 s47, s59, 41472
    s_add_u32 s47, s47, 34560
    v_lshlrev_b32 v2, 7, v1
    s_mov_b32 exec_hi, 0x3fffff
    buffer_load_dword v255, v2, s[12:15], s47 offen
    s_branch ssm_pfNe
ssm_pfN_6:
    s_mul_i32 s47, s59, 41472
    s_add_u32 s47, s47, 34560
    v_lshlrev_b32 v2, 7, v1
    s_mov_b32 exec_hi, 0x3fffff
    buffer_load_dword v255, v2, s[12:15], s47 offen
    s_branch ssm_pfNe
ssm_pfN_7:
    s_mul_i32 s47, s59, 41472
    s_add_u32 s47, s47, 34560
    v_lshlrev_b32 v2, 7, v1
    s_mov_b32 exec_hi, 0x3fffff
    buffer_load_dword v255, v2, s[12:15], s47 offen
ssm_pfNe:
    s_mov_b64 exec, -1
    s_waitcnt lgkmcnt(10)
    v_mfma_f32_16x16x32_bf16 v[68:71], v[176:179], v[212:215], v[68:71]
    ds_read_b64 v[232:233], v9 offset:3072
    v_mfma_f32_16x16x32_bf16 v[72:75], v[180:183], v[212:215], v[72:75]
    ds_read_b64 v[234:235], v9 offset:3080
    s_waitcnt lgkmcnt(11)
    v_mfma_f32_16x16x32_bf16 v[72:75], v[184:187], v[208:211], v[72:75]
    ds_read_b64 v[236:237], v9 offset:3584
    v_mfma_f32_16x16x32_bf16 v[76:79], v[184:187], v[212:215], v[76:79]
    ds_read_b64 v[238:239], v9 offset:3592
    s_waitcnt lgkmcnt(11)
    v_mfma_f32_16x16x32_bf16 v[72:75], v[176:179], v[216:219], v[72:75]
    v_mfma_f32_16x16x32_bf16 v[76:79], v[180:183], v[216:219], v[76:79]
    v_mfma_f32_16x16x32_bf16 v[80:83], v[184:187], v[216:219], v[80:83]
    s_waitcnt lgkmcnt(10)
    v_mfma_f32_16x16x32_bf16 v[76:79], v[188:191], v[208:211], v[76:79]
    v_mfma_f32_16x16x32_bf16 v[80:83], v[188:191], v[212:215], v[80:83]
    v_mfma_f32_16x16x32_bf16 v[84:87], v[188:191], v[216:219], v[84:87]
    s_waitcnt lgkmcnt(8)
    v_mfma_f32_16x16x32_bf16 v[76:79], v[176:179], v[220:223], v[76:79]
    v_mfma_f32_16x16x32_bf16 v[80:83], v[180:183], v[220:223], v[80:83]
    v_mfma_f32_16x16x32_bf16 v[84:87], v[184:187], v[220:223], v[84:87]
    v_mfma_f32_16x16x32_bf16 v[88:91], v[188:191], v[220:223], v[88:91]
    s_waitcnt lgkmcnt(6)
    v_mfma_f32_16x16x32_bf16 v[80:83], v[176:179], v[224:227], v[80:83]
    v_mfma_f32_16x16x32_bf16 v[84:87], v[180:183], v[224:227], v[84:87]
    v_mfma_f32_16x16x32_bf16 v[88:91], v[184:187], v[224:227], v[88:91]
    v_mfma_f32_16x16x32_bf16 v[92:95], v[188:191], v[224:227], v[92:95]
    s_waitcnt lgkmcnt(4)
    v_mfma_f32_16x16x32_bf16 v[84:87], v[176:179], v[228:231], v[84:87]
    v_mfma_f32_16x16x32_bf16 v[88:91], v[180:183], v[228:231], v[88:91]
    v_mfma_f32_16x16x32_bf16 v[92:95], v[184:187], v[228:231], v[92:95]
    s_waitcnt lgkmcnt(2)
    v_mfma_f32_16x16x32_bf16 v[88:91], v[176:179], v[232:235], v[88:91]
    v_mfma_f32_16x16x32_bf16 v[92:95], v[180:183], v[232:235], v[92:95]
    s_waitcnt lgkmcnt(0)
    v_mfma_f32_16x16x32_bf16 v[92:95], v[176:179], v[236:239], v[92:95]
    s_add_u32 s47, s45, 4
    s_cmp_lt_u32 s45, 2
    s_cselect_b32 s47, s45, s47
    s_mul_i32 s47, s47, 8704
    s_lshl_b32 s48, s45, 13
    s_add_u32 s48, s48, 36864
    s_cmp_eq_u32 s54, 0
    s_cselect_b32 s47, s48, s47
    v_add_u32 v243, s47, v10
    v_lshlrev_b32 v241, 2, v1
    s_cmp_eq_u32 s46, 0
    s_cbranch_scc1 ssm_x3b
    ds_write_b128 v243, v[64:67] offset:0
    ds_write_b128 v243, v[68:71] offset:1024
    ds_write_b128 v243, v[72:75] offset:2048
    ds_write_b128 v243, v[76:79] offset:3072
    s_waitcnt vmcnt(2)
    s_mov_b32 s50, 0
ssm_tgb:
    v_cmp_ne_u32 vcc, 0, v28
    s_nop 3
    s_cbranch_vccnz ssm_thb
    global_load_dword v28, v27, s[28:29] sc1
    s_add_u32 s50, s50, 1
    s_cmp_lt_u32 s50, 32768
    s_waitcnt vmcnt(0)
    s_cbranch_scc1 ssm_tgb
ssm_thb:
    v_mov_b32_dpp v60, v44 row_shl:1 row_mask:0xf bank_mask:0xf
    v_mov_b32_dpp v61, v45 row_shl:1 row_mask:0xf bank_mask:0xf
    v_mov_b32_dpp v62, v46 row_shl:1 row_mask:0xf bank_mask:0xf
    s_cmp_eq_u32 s55, 0
    s_cbranch_scc1 ssm_nrotb
    v_lshrrev_b32 v47, 16, v44
    v_mov_b32 v44, v45
    v_mov_b32 v45, v46
    v_mov_b32 v46, v47
    v_lshrrev_b32 v51, 16, v48
    v_mov_b32 v48, v49
    v_mov_b32 v49, v50
    v_mov_b32 v50, v51
    v_lshrrev_b32 v55, 16, v52
    v_mov_b32 v52, v53
    v_mov_b32 v53, v54
    v_mov_b32 v54, v55
    v_lshrrev_b32 v59, 16, v56
    v_mov_b32 v56, v57
    v_mov_b32 v57, v58
    v_mov_b32 v58, v59
    v_lshrrev_b32 v63, 16, v60
    v_mov_b32 v60, v61
    v_mov_b32 v61, v62
    v_mov_b32 v62, v63
ssm_nrotb:
    v_perm_b32 v96, v56, v60, s66
    v_perm_b32 v97, v48, v52, s66
    v_perm_b32 v98, v52, v56, s66
    v_perm_b32 v99, v44, v48, s66
    v_add_u32 v3, 4512, v12
    v_add_u32 v21, 9024, v12
    ds_write_b64 v12, v[96:97] offset:0
    ds_write_b64 v12, v[98:99] offset:13544
    ds_write2_b32 v3, v98, v99 offset0:1 offset1:2
    ds_write2_b32 v21, v96, v97 offset0:1 offset1:2
    v_perm_b32 v100, v56, v60, s67
    v_perm_b32 v101, v48, v52, s67
    v_perm_b32 v102, v52, v56, s67
    v_perm_b32 v103, v44, v48, s67
    v_add_u32 v3, 22560, v12
    v_add_u32 v21, 27072, v12
    ds_write_b64 v12, v[100:101] offset:18048
    ds_write_b64 v12, v[102:103] offset:31592
    ds_write2_b32 v3, v102, v103 offset0:1 offset1:2
    ds_write2_b32 v21, v100, v101 offset0:1 offset1:2
    v_perm_b32 v104, v57, v61, s66
    v_perm_b32 v105, v49, v53, s66
    v_perm_b32 v106, v53, v57, s66
    v_perm_b32 v107, v45, v49, s66
    v_add_u32 v3, 40608, v12
    v_add_u32 v21, 45120, v12
    ds_write_b64 v12, v[104:105] offset:36096
    ds_write_b64 v12, v[106:107] offset:49640
    ds_write2_b32 v3, v106, v107 offset0:1 offset1:2
    ds_write2_b32 v21, v104, v105 offset0:1 offset1:2
    v_perm_b32 v108, v57, v61, s67
    v_perm_b32 v109, v49, v53, s67
    v_perm_b32 v110, v53, v57, s67
    v_perm_b32 v111, v45, v49, s67
    v_add_u32 v3, 58656, v12
    v_add_u32 v21, 63168, v12
    v_add_u32 v2, 54144, v12
    ds_write_b64 v2, v[108:109]
    ds_write_b64 v2, v[110:111] offset:13544
    ds_write2_b32 v3, v110, v111 offset0:1 offset1:2
    ds_write2_b32 v21, v108, v109 offset0:1 offset1:2
    s_cmp_eq_u32 s54, 0
    s_cbranch_scc1 ssm_x3b
    v_perm_b32 v96, v58, v62, s66
    v_perm_b32 v97, v50, v54, s66
    v_perm_b32 v98, v54, v58, s66
    v_perm_b32 v99, v46, v50, s66
    v_subrev_u32 v3, 40288, v12
    v_subrev_u32 v21, 31424, v12
    v_subrev_u32 v2, 49152, v12
    ds_write_b64 v2, v[96:97]
    ds_write_b64 v2, v[98:99] offset:26600
    ds_write2_b32 v3, v98, v99 offset0:1 offset1:2
    ds_write2_b32 v21, v96, v97 offset0:1 offset1:2
ssm_x3b:
    s_setprio 0
    s_cmp_eq_u32 s68, 0
    s_cbranch_scc1 ssm_np
    s_setprio 1
ssm_np:
    s_waitcnt lgkmcnt(0)
    s_barrier
    s_cmp_lg_u32 s46, 0
    s_cbranch_scc1 ssm_f0
    ds_read_b128 v[112:115], v243 offset:0
    ds_read_b128 v[116:119], v243 offset:1024
    ds_read_b128 v[120:123], v243 offset:2048
    ds_read_b128 v[124:127], v243 offset:3072
    s_mul_i32 s47, s53, 4224
    s_add_u32 s47, s47, 0x280000
    s_mul_i32 s48, s53, 640
    s_add_u32 s48, s48, 0x680000
    s_mov_b32 vcc_lo, 0xaaaaaaaa
    s_mov_b32 vcc_hi, 0xaaaaaaaa
    s_mov_b32 s20, 0xcccccccc
    s_mov_b32 s21, 0xcccccccc
    s_waitcnt lgkmcnt(0)
    v_add_f32 v112, v112, v64
    v_add_f32 v113, v113, v65
    v_add_f32 v114, v114, v66
    v_add_f32 v115, v115, v67
    v_cvt_pk_bf16_f32 v160, v112, v113
    v_cvt_pk_bf16_f32 v161, v114, v115
    buffer_store_dwordx2 v[160:161], v11, s[40:43], s47 offen offset:0 sc1
    v_xor_b32 v168, v160, v161
    v_add_f32 v116, v116, v68
    v_add_f32 v117, v117, v69
    v_add_f32 v118, v118, v70
    v_add_f32 v119, v119, v71
    v_cvt_pk_bf16_f32 v162, v116, v117
    v_cvt_pk_bf16_f32 v163, v118, v119
    buffer_store_dwordx2 v[162:163], v11, s[40:43], s47 offen offset:512 sc1
    v_xor_b32 v169, v162, v163
    v_add_f32 v120, v120, v72
    v_add_f32 v121, v121, v73
    v_add_f32 v122, v122, v74
    v_add_f32 v123, v123, v75
    v_cvt_pk_bf16_f32 v164, v120, v121
    v_cvt_pk_bf16_f32 v165, v122, v123
    buffer_store_dwordx2 v[164:165], v11, s[40:43], s47 offen offset:1024 sc1
    v_xor_b32 v170, v164, v165
    v_add_f32 v124, v124, v76
    v_add_f32 v125, v125, v77
    v_add_f32 v126, v126, v78
    v_add_f32 v127, v127, v79
    v_cvt_pk_bf16_f32 v166, v124, v125
    v_cvt_pk_bf16_f32 v167, v126, v127
    buffer_store_dwordx2 v[166:167], v11, s[40:43], s47 offen offset:1536 sc1
    v_xor_b32 v171, v166, v167
    v_xor_b32_dpp v168, v168, v168 quad_perm:[1,0,3,2] row_mask:0xf bank_mask:0xf
    v_xor_b32_dpp v169, v169, v169 quad_perm:[1,0,3,2] row_mask:0xf bank_mask:0xf
    v_xor_b32_dpp v170, v170, v170 quad_perm:[1,0,3,2] row_mask:0xf bank_mask:0xf
    v_xor_b32_dpp v171, v171, v171 quad_perm:[1,0,3,2] row_mask:0xf bank_mask:0xf
    v_cndmask_b32 v168, v168, v169, vcc
    v_cndmask_b32 v170, v170, v171, vcc
    s_nop 0
    v_xor_b32_dpp v168, v168, v168 quad_perm:[2,3,0,1] row_mask:0xf bank_mask:0xf
    v_xor_b32_dpp v170, v170, v170 quad_perm:[2,3,0,1] row_mask:0xf bank_mask:0xf
    v_cndmask_b32 v168, v168, v170, s[20:21]
    v_xor_b32 v168, v168, v28
    buffer_store_dword v168, v241, s[40:43], s48 offen sc1
ssm_f0:
    s_waitcnt lgkmcnt(0)
    ds_read_b128 v[112:115], v8 offset:1984
    ds_read_b128 v[116:119], v8 offset:1472
    ds_read_b128 v[120:123], v8 offset:960
    ds_read_b128 v[124:127], v8 offset:448
    ds_read_b128 v[176:179], v8 offset:1920
    ds_read_b128 v[180:183], v8 offset:1408
    ds_read_b128 v[184:187], v8 offset:896
    ds_read_b128 v[188:191], v8 offset:384
    ds_read_b128 v[160:163], v8 offset:1856
    ds_read_b128 v[164:167], v8 offset:1344
    ds_read_b128 v[168:171], v8 offset:832
    ds_read_b128 v[172:175], v8 offset:320
    s_waitcnt lgkmcnt(11)
    v_mfma_f32_16x16x32_bf16 v[80:83], v[112:115], v[128:131], v[80:83]
    ds_read_b128 v[224:227], v8 offset:1792
    v_mfma_f32_16x16x32_bf16 v[84:87], v[112:115], v[132:135], v[84:87]
    ds_read_b128 v[228:231], v8 offset:1280
    v_mfma_f32_16x16x32_bf16 v[88:91], v[112:115], v[136:139], v[88:91]
    ds_read_b128 v[232:235], v8 offset:768
    v_mfma_f32_16x16x32_bf16 v[92:95], v[112:115], v[140:143], v[92:95]
    ds_read_b128 v[236:239], v8 offset:256
    s_waitcnt lgkmcnt(14)
    v_mfma_f32_16x16x32_bf16 v[84:87], v[116:119], v[128:131], v[84:87]
    v_mfma_f32_16x16x32_bf16 v[88:91], v[116:119], v[132:135], v[88:91]
    v_mfma_f32_16x16x32_bf16 v[92:95], v[116:119], v[136:139], v[92:95]
    s_waitcnt lgkmcnt(13)
    v_mfma_f32_16x16x32_bf16 v[88:91], v[120:123], v[128:131], v[88:91]
    v_mfma_f32_16x16x32_bf16 v[92:95], v[120:123], v[132:135], v[92:95]
    s_waitcnt lgkmcnt(12)
    v_mfma_f32_16x16x32_bf16 v[92:95], v[124:127], v[128:131], v[92:95]
    s_waitcnt lgkmcnt(11)
    v_mfma_f32_16x16x32_bf16 v[80:83], v[176:179], v[192:195], v[80:83]
    v_mfma_f32_16x16x32_bf16 v[84:87], v[176:179], v[196:199], v[84:87]
    v_mfma_f32_16x16x32_bf16 v[88:91], v[176:179], v[200:203], v[88:91]
    v_mfma_f32_16x16x32_bf16 v[92:95], v[176:179], v[204:207], v[92:95]
    s_waitcnt lgkmcnt(10)
    v_mfma_f32_16x16x32_bf16 v[84:87], v[180:183], v[192:195], v[84:87]
    v_mfma_f32_16x16x32_bf16 v[88:91], v[180:183], v[196:199], v[88:91]
    v_mfma_f32_16x16x32_bf16 v[92:95], v[180:183], v[200:203], v[92:95]
    s_waitcnt lgkmcnt(9)
    v_mfma_f32_16x16x32_bf16 v[88:91], v[184:187], v[192:195], v[88:91]
    v_mfma_f32_16x16x32_bf16 v[92:95], v[184:187], v[196:199], v[92:95]
    s_waitcnt lgkmcnt(8)
    v_mfma_f32_16x16x32_bf16 v[92:95], v[188:191], v[192:195], v[92:95]
    s_waitcnt lgkmcnt(7)
    v_mfma_f32_16x16x32_bf16 v[80:83], v[160:163], v[144:147], v[80:83]
    v_mfma_f32_16x16x32_bf16 v[84:87], v[160:163], v[148:151], v[84:87]
    v_mfma_f32_16x16x32_bf16 v[88:91], v[160:163], v[152:155], v[88:91]
    v_mfma_f32_16x16x32_bf16 v[92:95], v[160:163], v[156:159], v[92:95]
    s_waitcnt lgkmcnt(6)
    v_mfma_f32_16x16x32_bf16 v[84:87], v[164:167], v[144:147], v[84:87]
    v_mfma_f32_16x16x32_bf16 v[88:91], v[164:167], v[148:151], v[88:91]
    v_mfma_f32_16x16x32_bf16 v[92:95], v[164:167], v[152:155], v[92:95]
    s_waitcnt lgkmcnt(5)
    v_mfma_f32_16x16x32_bf16 v[88:91], v[168:171], v[144:147], v[88:91]
    v_mfma_f32_16x16x32_bf16 v[92:95], v[168:171], v[148:151], v[92:95]
    s_waitcnt lgkmcnt(4)
    v_mfma_f32_16x16x32_bf16 v[92:95], v[172:175], v[144:147], v[92:95]
    s_waitcnt lgkmcnt(3)
    v_mfma_f32_16x16x32_bf16 v[80:83], v[224:227], v[208:211], v[80:83]
    v_mfma_f32_16x16x32_bf16 v[84:87], v[224:227], v[212:215], v[84:87]
    v_mfma_f32_16x16x32_bf16 v[88:91], v[224:227], v[216:219], v[88:91]
    v_mfma_f32_16x16x32_bf16 v[92:95], v[224:227], v[220:223], v[92:95]
    s_waitcnt lgkmcnt(2)
    v_mfma_f32_16x16x32_bf16 v[84:87], v[228:231], v[208:211], v[84:87]
    v_mfma_f32_16x16x32_bf16 v[88:91], v[228:231], v[212:215], v[88:91]
    v_mfma_f32_16x16x32_bf16 v[92:95], v[228:231], v[216:219], v[92:95]
    s_waitcnt lgkmcnt(1)
    v_mfma_f32_16x16x32_bf16 v[88:91], v[232:235], v[208:211], v[88:91]
    v_mfma_f32_16x16x32_bf16 v[92:95], v[232:235], v[212:215], v[92:95]
    s_waitcnt lgkmcnt(0)
    v_mfma_f32_16x16x32_bf16 v[92:95], v[236:239], v[208:211], v[92:95]
    s_cmp_eq_u32 s46, 1
    s_nop 5
    s_cbranch_scc1 ssm_red2
    ds_write_b128 v243, v[80:83] offset:4096
    ds_write_b128 v243, v[84:87] offset:5120
    ds_write_b128 v243, v[88:91] offset:6144
    ds_write_b128 v243, v[92:95] offset:7168
    s_cmp_lg_u32 s54, 0
    s_cbranch_scc1 ssm_red2
    s_add_u32 m0, s60, 0
    s_add_u32 s49, s59, 0
    buffer_load_dwordx4 v244, s[12:15], s49 offen offset:0 lds
    buffer_load_dwordx4 v245, s[12:15], s49 offen offset:1024 lds
    buffer_load_dwordx4 v246, s[12:15], s49 offen offset:2048 lds
    s_add_u32 m0, s60, 12288
    s_add_u32 s49, s59, 73728
    buffer_load_dwordx4 v244, s[12:15], s49 offen offset:0 lds
    buffer_load_dwordx4 v245, s[12:15], s49 offen offset:1024 lds
    buffer_load_dwordx4 v246, s[12:15], s49 offen offset:2048 lds
    s_add_u32 m0, s60, 24576
    s_add_u32 s49, s59, 147456
    buffer_load_dwordx4 v244, s[12:15], s49 offen offset:0 lds
    buffer_load_dwordx4 v245, s[12:15], s49 offen offset:1024 lds
    buffer_load_dwordx4 v246, s[12:15], s49 offen offset:2048 lds
ssm_red2:
    s_cmp_eq_u32 s68, 0
    s_cbranch_scc1 ssm_c5
    s_waitcnt lgkmcnt(0)
    ds_read_b128 v[112:115], v23 offset:3904
    ds_read_b64 v[144:145], v24 offset:64
    ds_read_b64 v[146:147], v24 offset:72
    ds_read_b128 v[116:119], v23 offset:3392
    ds_read_b64 v[148:149], v24 offset:576
    ds_read_b64 v[150:151], v24 offset:584
    ds_read_b128 v[120:123], v23 offset:2880
    ds_read_b64 v[152:153], v24 offset:1088
    ds_read_b64 v[154:155], v24 offset:1096
    ds_read_b128 v[124:127], v23 offset:2368
    ds_read_b64 v[156:157], v24 offset:1600
    ds_read_b64 v[158:159], v24 offset:1608
    s_waitcnt lgkmcnt(9)
    v_mfma_f32_16x16x32_bf16 v[32:35], v[112:115], v[144:147], 0
    ds_read_b128 v[128:131], v23 offset:1856
    s_waitcnt lgkmcnt(9)
    v_mfma_f32_16x16x32_bf16 v[36:39], v[116:119], v[144:147], 0
    ds_read_b64 v[160:161], v24 offset:2112
    s_waitcnt lgkmcnt(8)
    v_mfma_f32_16x16x32_bf16 v[36:39], v[112:115], v[148:151], v[36:39]
    ds_read_b64 v[162:163], v24 offset:2120
    v_mfma_f32_16x16x32_bf16 v[40:43], v[116:119], v[148:151], 0
    ds_read_b128 v[132:135], v23 offset:1344
    s_waitcnt lgkmcnt(9)
    v_mfma_f32_16x16x32_bf16 v[40:43], v[120:123], v[144:147], v[40:43]
    ds_read_b64 v[164:165], v24 offset:2624
    v_mfma_f32_16x16x32_bf16 v[44:47], v[120:123], v[148:151], 0
    ds_read_b64 v[166:167], v24 offset:2632
    s_waitcnt lgkmcnt(9)
    v_mfma_f32_16x16x32_bf16 v[40:43], v[112:115], v[152:155], v[40:43]
    ds_read_b128 v[136:139], v23 offset:832
    v_mfma_f32_16x16x32_bf16 v[44:47], v[116:119], v[152:155], v[44:47]
    ds_read_b64 v[168:169], v24 offset:3136
    v_mfma_f32_16x16x32_bf16 v[48:51], v[120:123], v[152:155], 0
    ds_read_b64 v[170:171], v24 offset:3144
    s_waitcnt lgkmcnt(11)
    v_mfma_f32_16x16x32_bf16 v[44:47], v[124:127], v[144:147], v[44:47]
    ds_read_b128 v[140:143], v23 offset:320
    v_mfma_f32_16x16x32_bf16 v[48:51], v[124:127], v[148:151], v[48:51]
    ds_read_b64 v[172:173], v24 offset:3648
    v_mfma_f32_16x16x32_bf16 v[52:55], v[124:127], v[152:155], 0
    ds_read_b64 v[174:175], v24 offset:3656
    s_waitcnt lgkmcnt(12)
    v_mfma_f32_16x16x32_bf16 v[44:47], v[112:115], v[156:159], v[44:47]
    ds_read_b128 v[176:179], v23 offset:3840
    v_mfma_f32_16x16x32_bf16 v[48:51], v[116:119], v[156:159], v[48:51]
    ds_read_b64 v[208:209], v24 offset:0
    v_mfma_f32_16x16x32_bf16 v[52:55], v[120:123], v[156:159], v[52:55]
    ds_read_b64 v[210:211], v24 offset:8
    v_mfma_f32_16x16x32_bf16 v[56:59], v[124:127], v[156:159], 0
    s_waitcnt lgkmcnt(14)
    v_mfma_f32_16x16x32_bf16 v[48:51], v[128:131], v[144:147], v[48:51]
    ds_read_b128 v[180:183], v23 offset:3328
    v_mfma_f32_16x16x32_bf16 v[52:55], v[128:131], v[148:151], v[52:55]
    v_mfma_f32_16x16x32_bf16 v[56:59], v[128:131], v[152:155], v[56:59]
    v_mfma_f32_16x16x32_bf16 v[60:63], v[128:131], v[156:159], 0
    s_waitcnt lgkmcnt(13)
    v_mfma_f32_16x16x32_bf16 v[48:51], v[112:115], v[160:163], v[48:51]
    ds_read_b64 v[212:213], v24 offset:512
    v_mfma_f32_16x16x32_bf16 v[52:55], v[116:119], v[160:163], v[52:55]
    ds_read_b64 v[214:215], v24 offset:520
    v_mfma_f32_16x16x32_bf16 v[56:59], v[120:123], v[160:163], v[56:59]
    v_mfma_f32_16x16x32_bf16 v[60:63], v[124:127], v[160:163], v[60:63]
    s_waitcnt lgkmcnt(14)
    v_mfma_f32_16x16x32_bf16 v[52:55], v[132:135], v[144:147], v[52:55]
    ds_read_b128 v[184:187], v23 offset:2816
    v_mfma_f32_16x16x32_bf16 v[56:59], v[132:135], v[148:151], v[56:59]
    v_mfma_f32_16x16x32_bf16 v[60:63], v[132:135], v[152:155], v[60:63]
    s_waitcnt lgkmcnt(13)
    v_mfma_f32_16x16x32_bf16 v[52:55], v[112:115], v[164:167], v[52:55]
    ds_read_b64 v[216:217], v24 offset:1024
    v_mfma_f32_16x16x32_bf16 v[56:59], v[116:119], v[164:167], v[56:59]
    ds_read_b64 v[218:219], v24 offset:1032
    v_mfma_f32_16x16x32_bf16 v[60:63], v[120:123], v[164:167], v[60:63]
    s_waitcnt lgkmcnt(14)
    v_mfma_f32_16x16x32_bf16 v[56:59], v[136:139], v[144:147], v[56:59]
    ds_read_b128 v[188:191], v23 offset:2304
    v_mfma_f32_16x16x32_bf16 v[60:63], v[136:139], v[148:151], v[60:63]
    s_waitcnt lgkmcnt(13)
    v_mfma_f32_16x16x32_bf16 v[56:59], v[112:115], v[168:171], v[56:59]
    ds_read_b64 v[220:221], v24 offset:1536
    v_mfma_f32_16x16x32_bf16 v[60:63], v[116:119], v[168:171], v[60:63]
    ds_read_b64 v[222:223], v24 offset:1544
    s_waitcnt lgkmcnt(14)
    v_mfma_f32_16x16x32_bf16 v[60:63], v[140:143], v[144:147], v[60:63]
    ds_read_b128 v[192:195], v23 offset:1792
    s_waitcnt lgkmcnt(13)
    v_mfma_f32_16x16x32_bf16 v[60:63], v[112:115], v[172:175], v[60:63]
    ds_read_b64 v[224:225], v24 offset:2048
    s_waitcnt lgkmcnt(11)
    v_mfma_f32_16x16x32_bf16 v[32:35], v[176:179], v[208:211], v[32:35]
    ds_read_b64 v[226:227], v24 offset:2056
    s_waitcnt lgkmcnt(11)
    v_mfma_f32_16x16x32_bf16 v[36:39], v[180:183], v[208:211], v[36:39]
    ds_read_b128 v[196:199], v23 offset:1280
    s_waitcnt lgkmcnt(10)
    v_mfma_f32_16x16x32_bf16 v[36:39], v[176:179], v[212:215], v[36:39]
    ds_read_b64 v[228:229], v24 offset:2560
    v_mfma_f32_16x16x32_bf16 v[40:43], v[180:183], v[212:215], v[40:43]
    ds_read_b64 v[230:231], v24 offset:2568
    s_waitcnt lgkmcnt(11)
    v_mfma_f32_16x16x32_bf16 v[40:43], v[184:187], v[208:211], v[40:43]
    ds_read_b128 v[200:203], v23 offset:768
    v_mfma_f32_16x16x32_bf16 v[44:47], v[184:187], v[212:215], v[44:47]
    ds_read_b64 v[232:233], v24 offset:3072
    s_waitcnt lgkmcnt(11)
    v_mfma_f32_16x16x32_bf16 v[40:43], v[176:179], v[216:219], v[40:43]
    ds_read_b64 v[234:235], v24 offset:3080
    v_mfma_f32_16x16x32_bf16 v[44:47], v[180:183], v[216:219], v[44:47]
    ds_read_b128 v[204:207], v23 offset:256
    v_mfma_f32_16x16x32_bf16 v[48:51], v[184:187], v[216:219], v[48:51]
    ds_read_b64 v[236:237], v24 offset:3584
    s_waitcnt lgkmcnt(13)
    v_mfma_f32_16x16x32_bf16 v[44:47], v[188:191], v[208:211], v[44:47]
    ds_read_b64 v[238:239], v24 offset:3592
    v_mfma_f32_16x16x32_bf16 v[48:51], v[188:191], v[212:215], v[48:51]
    v_mfma_f32_16x16x32_bf16 v[52:55], v[188:191], v[216:219], v[52:55]
    s_waitcnt lgkmcnt(12)
    v_mfma_f32_16x16x32_bf16 v[44:47], v[176:179], v[220:223], v[44:47]
    v_mfma_f32_16x16x32_bf16 v[48:51], v[180:183], v[220:223], v[48:51]
    v_mfma_f32_16x16x32_bf16 v[52:55], v[184:187], v[220:223], v[52:55]
    v_mfma_f32_16x16x32_bf16 v[56:59], v[188:191], v[220:223], v[56:59]
    s_waitcnt lgkmcnt(11)
    v_mfma_f32_16x16x32_bf16 v[48:51], v[192:195], v[208:211], v[48:51]
    v_mfma_f32_16x16x32_bf16 v[52:55], v[192:195], v[212:215], v[52:55]
    v_mfma_f32_16x16x32_bf16 v[56:59], v[192:195], v[216:219], v[56:59]
    v_mfma_f32_16x16x32_bf16 v[60:63], v[192:195], v[220:223], v[60:63]
    s_waitcnt lgkmcnt(9)
    v_mfma_f32_16x16x32_bf16 v[48:51], v[176:179], v[224:227], v[48:51]
    v_mfma_f32_16x16x32_bf16 v[52:55], v[180:183], v[224:227], v[52:55]
    v_mfma_f32_16x16x32_bf16 v[56:59], v[184:187], v[224:227], v[56:59]
    v_mfma_f32_16x16x32_bf16 v[60:63], v[188:191], v[224:227], v[60:63]
    s_waitcnt lgkmcnt(8)
    v_mfma_f32_16x16x32_bf16 v[52:55], v[196:199], v[208:211], v[52:55]
    v_mfma_f32_16x16x32_bf16 v[56:59], v[196:199], v[212:215], v[56:59]
    v_mfma_f32_16x16x32_bf16 v[60:63], v[196:199], v[216:219], v[60:63]
    s_waitcnt lgkmcnt(6)
    v_mfma_f32_16x16x32_bf16 v[52:55], v[176:179], v[228:231], v[52:55]
    v_mfma_f32_16x16x32_bf16 v[56:59], v[180:183], v[228:231], v[56:59]
    v_mfma_f32_16x16x32_bf16 v[60:63], v[184:187], v[228:231], v[60:63]
    s_waitcnt lgkmcnt(5)
    v_mfma_f32_16x16x32_bf16 v[56:59], v[200:203], v[208:211], v[56:59]
    v_mfma_f32_16x16x32_bf16 v[60:63], v[200:203], v[212:215], v[60:63]
    s_waitcnt lgkmcnt(3)
    v_mfma_f32_16x16x32_bf16 v[56:59], v[176:179], v[232:235], v[56:59]
    v_mfma_f32_16x16x32_bf16 v[60:63], v[180:183], v[232:235], v[60:63]
    s_waitcnt lgkmcnt(2)
    v_mfma_f32_16x16x32_bf16 v[60:63], v[204:207], v[208:211], v[60:63]
    s_waitcnt lgkmcnt(0)
    v_mfma_f32_16x16x32_bf16 v[60:63], v[176:179], v[236:239], v[60:63]
    s_mul_i32 s47, s44, 18048
    s_add_u32 s47, s47, 35984
    v_add_u32 v2, s47, v10
    ds_write_b128 v2, v[32:35] offset:0
    ds_write_b128 v2, v[36:39] offset:1024
    ds_write_b128 v2, v[40:43] offset:4512
    ds_write_b128 v2, v[44:47] offset:5536
    ds_write_b128 v2, v[48:51] offset:9024
    ds_write_b128 v2, v[52:55] offset:10048
    ds_write_b128 v2, v[56:59] offset:13536
    ds_write_b128 v2, v[60:63] offset:14560
ssm_c5:
    s_cmp_lg_u32 s54, s46
    s_cselect_b32 s50, s54, 0
    s_cmp_eq_u32 s50, 0
    s_cbranch_scc1 ssm_c6
    s_lshl_b32 s48, s45, 8
    s_add_u32 s47, s48, 72080
    v_lshrrev_b32 v3, 5, v1
    v_mul_u32_u24 v2, 2464, v3
    v_lshrrev_b32 v3, 4, v1
    v_mul_u32_u24 v240, 768, v3
    v_add3_u32 v2, s47, v2, v10
    v_add_u32 v2, v2, v240
    v_mul_u32_u24 v3, 384, v3
    v_add_u32 v3, v3, v11
    s_lshl_b32 s49, s45, 7
    s_mul_i32 s47, s52, 4224
    s_add_u32 s47, s47, s49
    s_add_u32 s47, s47, 0x280000
    s_lshl_b32 s49, s45, 6
    s_mul_i32 s48, s52, 640
    s_add_u32 s48, s48, s49
    s_add_u32 s48, s48, 0x680000
    v_and_b32 v240, 3, v1
    v_and_b32 v242, 48, v241
    v_lshl_add_u32 v240, v240, 6, v242
    s_waitcnt lgkmcnt(0)
    s_barrier
    ds_read_b128 v[144:147], v2 offset:0
    ds_read_b128 v[148:151], v2 offset:18048
    ds_read_b128 v[152:155], v2 offset:36096
    ds_read_b128 v[156:159], v2 offset:54144
    ds_read_b128 v[160:163], v2 offset:9024
    ds_read_b128 v[164:167], v2 offset:27072
    ds_read_b128 v[168:171], v2 offset:45120
    ds_read_b128 v[172:175], v2 offset:63168
    s_waitcnt lgkmcnt(6)
    v_pk_add_f32 v[144:145], v[144:145], v[148:149]
    v_pk_add_f32 v[146:147], v[146:147], v[150:151]
    s_waitcnt lgkmcnt(5)
    v_pk_add_f32 v[144:145], v[144:145], v[152:153]
    v_pk_add_f32 v[146:147], v[146:147], v[154:155]
    s_waitcnt lgkmcnt(4)
    v_pk_add_f32 v[144:145], v[144:145], v[156:157]
    v_pk_add_f32 v[146:147], v[146:147], v[158:159]
    v_cvt_pk_bf16_f32 v176, v144, v145
    v_cvt_pk_bf16_f32 v177, v146, v147
    buffer_store_dwordx2 v[176:177], v3, s[40:43], s47 offen offset:0 sc1
    v_xor_b32 v178, v176, v177
    s_waitcnt lgkmcnt(2)
    v_pk_add_f32 v[160:161], v[160:161], v[164:165]
    v_pk_add_f32 v[162:163], v[162:163], v[166:167]
    s_waitcnt lgkmcnt(1)
    v_pk_add_f32 v[160:161], v[160:161], v[168:169]
    v_pk_add_f32 v[162:163], v[162:163], v[170:171]
    s_waitcnt lgkmcnt(0)
    v_pk_add_f32 v[160:161], v[160:161], v[172:173]
    v_pk_add_f32 v[162:163], v[162:163], v[174:175]
    v_cvt_pk_bf16_f32 v180, v160, v161
    v_cvt_pk_bf16_f32 v181, v162, v163
    buffer_store_dwordx2 v[180:181], v3, s[40:43], s47 offen offset:2048 sc1
    v_xor_b32 v182, v180, v181
    v_xor_b32_dpp v178, v178, v178 quad_perm:[1,0,3,2] row_mask:0xf bank_mask:0xf
    s_nop 0
    v_xor_b32_dpp v182, v182, v182 quad_perm:[1,0,3,2] row_mask:0xf bank_mask:0xf
    v_xor_b32_dpp v178, v178, v178 quad_perm:[2,3,0,1] row_mask:0xf bank_mask:0xf
    s_nop 0
    v_xor_b32_dpp v182, v182, v182 quad_perm:[2,3,0,1] row_mask:0xf bank_mask:0xf
    v_xor_b32 v178, v178, v28
    ds_bpermute_b32 v178, v240, v178
    v_xor_b32 v182, v182, v28
    ds_bpermute_b32 v182, v240, v182
    s_mov_b64 exec, 0xffff
    s_waitcnt lgkmcnt(1)
    buffer_store_dword v178, v241, s[40:43], s48 offen offset:0 sc1
    s_waitcnt lgkmcnt(0)
    buffer_store_dword v182, v241, s[40:43], s48 offen offset:256 sc1
    s_mov_b64 exec, -1
    s_branch ssm_fin
ssm_c6:
    s_waitcnt lgkmcnt(0)
    s_barrier
    s_cmp_lg_u32 s46, 0
    s_cbranch_scc1 ssm_r6
    s_cmp_lg_u32 s54, 0
    s_cbranch_scc1 ssm_r7
    s_add_u32 m0, s60, 73728
    s_cmp_ge_u32 s59, 221184
    s_cselect_b32 s49, -3, 6
    s_mul_i32 s49, s49, 73728
    s_add_u32 s49, s49, s59
    buffer_load_dwordx4 v244, s[12:15], s49 offen offset:0 lds
    buffer_load_dwordx4 v245, s[12:15], s49 offen offset:1024 lds
    buffer_load_dwordx4 v246, s[12:15], s49 offen offset:2048 lds
    s_add_u32 m0, s60, 86016
    s_cmp_ge_u32 s59, 147456
    s_cselect_b32 s49, -2, 7
    s_mul_i32 s49, s49, 73728
    s_add_u32 s49, s49, s59
    buffer_load_dwordx4 v244, s[12:15], s49 offen offset:0 lds
    buffer_load_dwordx4 v245, s[12:15], s49 offen offset:1024 lds
    buffer_load_dwordx4 v246, s[12:15], s49 offen offset:2048 lds
    s_add_u32 m0, s60, 98304
    s_cmp_ge_u32 s59, 73728
    s_cselect_b32 s49, -1, 8
    s_mul_i32 s49, s49, 73728
    s_add_u32 s49, s49, s59
    buffer_load_dwordx4 v244, s[12:15], s49 offen offset:0 lds
    buffer_load_dwordx4 v245, s[12:15], s49 offen offset:1024 lds
    buffer_load_dwordx4 v246, s[12:15], s49 offen offset:2048 lds
    s_branch ssm_r7
ssm_r6:
    ds_read_b128 v[112:115], v243 offset:4096
    ds_read_b128 v[116:119], v243 offset:5120
    ds_read_b128 v[120:123], v243 offset:6144
    ds_read_b128 v[124:127], v243 offset:7168
    s_mul_i32 s47, s53, 4224
    s_add_u32 s47, s47, 0x280800
    s_mul_i32 s48, s53, 640
    s_add_u32 s48, s48, 0x680100
    s_mov_b32 vcc_lo, 0xaaaaaaaa
    s_mov_b32 vcc_hi, 0xaaaaaaaa
    s_mov_b32 s20, 0xcccccccc
    s_mov_b32 s21, 0xcccccccc
    s_waitcnt lgkmcnt(0)
    v_pk_add_f32 v[112:113], v[112:113], v[80:81]
    v_pk_add_f32 v[114:115], v[114:115], v[82:83]
    v_cvt_pk_bf16_f32 v160, v112, v113
    v_cvt_pk_bf16_f32 v161, v114, v115
    buffer_store_dwordx2 v[160:161], v11, s[40:43], s47 offen offset:0 sc1
    v_xor_b32 v168, v160, v161
    v_pk_add_f32 v[116:117], v[116:117], v[84:85]
    v_pk_add_f32 v[118:119], v[118:119], v[86:87]
    v_cvt_pk_bf16_f32 v162, v116, v117
    v_cvt_pk_bf16_f32 v163, v118, v119
    buffer_store_dwordx2 v[162:163], v11, s[40:43], s47 offen offset:512 sc1
    v_xor_b32 v169, v162, v163
    v_pk_add_f32 v[120:121], v[120:121], v[88:89]
    v_pk_add_f32 v[122:123], v[122:123], v[90:91]
    v_cvt_pk_bf16_f32 v164, v120, v121
    v_cvt_pk_bf16_f32 v165, v122, v123
    buffer_store_dwordx2 v[164:165], v11, s[40:43], s47 offen offset:1024 sc1
    v_xor_b32 v170, v164, v165
    v_pk_add_f32 v[124:125], v[124:125], v[92:93]
    v_pk_add_f32 v[126:127], v[126:127], v[94:95]
    v_cvt_pk_bf16_f32 v166, v124, v125
    v_cvt_pk_bf16_f32 v167, v126, v127
    buffer_store_dwordx2 v[166:167], v11, s[40:43], s47 offen offset:1536 sc1
    v_xor_b32 v171, v166, v167
    v_xor_b32_dpp v168, v168, v168 quad_perm:[1,0,3,2] row_mask:0xf bank_mask:0xf
    v_xor_b32_dpp v169, v169, v169 quad_perm:[1,0,3,2] row_mask:0xf bank_mask:0xf
    v_xor_b32_dpp v170, v170, v170 quad_perm:[1,0,3,2] row_mask:0xf bank_mask:0xf
    v_xor_b32_dpp v171, v171, v171 quad_perm:[1,0,3,2] row_mask:0xf bank_mask:0xf
    v_cndmask_b32 v168, v168, v169, vcc
    v_cndmask_b32 v170, v170, v171, vcc
    s_nop 0
    v_xor_b32_dpp v168, v168, v168 quad_perm:[2,3,0,1] row_mask:0xf bank_mask:0xf
    v_xor_b32_dpp v170, v170, v170 quad_perm:[2,3,0,1] row_mask:0xf bank_mask:0xf
    v_cndmask_b32 v168, v168, v170, s[20:21]
    v_xor_b32 v168, v168, v28
    buffer_store_dword v168, v241, s[40:43], s48 offen sc1
ssm_r7:
ssm_fin:
    s_setprio 0
    s_cmp_lt_u32 s3, 64
    s_cbranch_scc1 s_fin
    s_and_b32 s47, s3, 6
    s_bfe_u32 s48, s3, 0x20003
    s_lshl1_add_u32 s47, s47, s48
    s_and_b32 s48, s3, 1
    s_lshl1_add_u32 s56, s47, s48
    s_bfe_u32 s57, s3, 0x10005
    s_add_u32 s57, s57, 4
    s_lshr_b32 s55, s44, 2
    s_xor_b32 s55, s55, 0
    s_and_b32 s44, s44, 3
    s_lshl2_add_u32 s61, s56, s44
    s_mov_b32 s16, s26
    s_and_b32 s17, s27, 0xffff
    s_mov_b32 s18, 0x240000
    s_mov_b32 s19, 0x20000
    s_lshl2_add_u32 s48, s57, s44
    s_mul_i32 s69, s48, 101376
    s_lshl_b32 s49, s56, 7
    s_add_u32 s69, s69, s49
    s_add_u32 s69, s69, 0x280000
    s_mul_i32 s67, s44, 3072
    s_add_u32 s67, s67, 122880
    s_mul_i32 s62, s61, 20480
    s_lshr_b32 s68, s61, 1
    s_lshl_b32 s68, s68, 10
    s_add_u32 s68, s68, 0x4e0000
    s_mul_i32 s63, s61, 18432
    s_mul_i32 s48, s57, 192
    s_add_u32 s63, s63, s48
    s_mul_i32 s49, s55, 55296
    v_lshrrev_b32 v216, 2, v1
    v_and_b32 v217, 3, v1
    v_lshl_add_u32 v217, v217, 3, s49
    v_mul_u32_u24 v216, 192, v216
    v_add_u32 v216, v216, v217
    v_and_b32 v217, 16, v1
    v_lshl_add_u32 v203, v217, 1, v216
    v_xor_b32 v217, 16, v217
    v_lshl_add_u32 v204, v217, 1, v216
    s_waitcnt vmcnt(9)
    s_barrier
    s_cmp_lg_u32 s55, 0
    s_cbranch_scc1 o1
    s_add_u32 m0, s60, 36864
    s_add_u32 s49, s59, 221184
    buffer_load_dwordx4 v244, s[12:15], s49 offen offset:0 lds
    buffer_load_dwordx4 v245, s[12:15], s49 offen offset:1024 lds
    buffer_load_dwordx4 v246, s[12:15], s49 offen offset:2048 lds
    s_add_u32 m0, s60, 49152
    s_cmp_ge_u32 s59, 368640
    s_cselect_b32 s49, -5, 4
    s_mul_i32 s49, s49, 73728
    s_add_u32 s49, s49, s59
    buffer_load_dwordx4 v244, s[12:15], s49 offen offset:0 lds
    buffer_load_dwordx4 v245, s[12:15], s49 offen offset:1024 lds
    buffer_load_dwordx4 v246, s[12:15], s49 offen offset:2048 lds
    s_add_u32 m0, s60, 61440
    s_cmp_ge_u32 s59, 294912
    s_cselect_b32 s49, -4, 5
    s_mul_i32 s49, s49, 73728
    s_add_u32 s49, s49, s59
    buffer_load_dwordx4 v244, s[12:15], s49 offen offset:0 lds
    buffer_load_dwordx4 v245, s[12:15], s49 offen offset:1024 lds
    buffer_load_dwordx4 v246, s[12:15], s49 offen offset:2048 lds
    s_branch o0
s_fin:
    s_endpgm
o0:
    s_setprio 0
    s_mov_b32 s51, 0
    v_mov_b32 v38, 110592
    s_lshl2_add_u32 s47, s44, 110592
    v_mov_b32 v39, s47
    v_readfirstlane_b32 s24, v28
    v_mov_b32 v25, 0
    ds_write2_b32 v39, v25, v25 offset1:4
o0_redo:
    ds_read_b64_tr_b16 v[160:161], v203 offset:0
    ds_read_b64_tr_b16 v[162:163], v204 offset:3840
    s_lshl_b32 s52, s61, 10
    s_add_u32 s52, s52, 0x4f0000
    v_and_b32 v25, 3, v1
    ds_read_b64_tr_b16 v[164:165], v204 offset:0
    ds_read_b64_tr_b16 v[166:167], v203 offset:3840
    s_and_b32 s47, s57, 0
    s_xor_b32 s47, s47, s55
    s_lshl_b32 s49, s47, 11
    ds_read_b64_tr_b16 v[168:169], v203 offset:64
    ds_read_b64_tr_b16 v[170:171], v204 offset:3904
    s_add_u32 s49, s49, 16384
    v_lshl_add_u32 v210, v1, 3, s49
    s_lshl_b32 s47, s47, 13
    ds_read_b64_tr_b16 v[172:173], v204 offset:64
    ds_read_b64_tr_b16 v[174:175], v203 offset:3904
    v_lshl_add_u32 v209, v1, 4, s47
    v_and_b32 v26, 15, v1
    v_lshlrev_b32 v211, 6, v26
    ds_read_b64_tr_b16 v[176:177], v203 offset:128
    ds_read_b64_tr_b16 v[178:179], v204 offset:3968
    v_lshrrev_b32 v216, 3, v1
    v_and_b32 v217, 7, v1
    v_mul_u32_u24 v213, 4224, v216
    ds_read_b64_tr_b16 v[180:181], v204 offset:128
    ds_read_b64_tr_b16 v[182:183], v203 offset:3968
    v_lshl_add_u32 v213, v217, 4, v213
    s_lshl2_add_u32 s48, s57, s44
    s_mul_i32 s48, s48, 15360
    ds_read_b64_tr_b16 v[184:185], v204 offset:6912
    ds_read_b64_tr_b16 v[186:187], v203 offset:10752
    s_and_b32 s49, s56, 12
    s_add_u32 s48, s48, s49
    s_and_b32 s49, s56, 16
    ds_read_b64_tr_b16 v[188:189], v203 offset:6912
    ds_read_b64_tr_b16 v[190:191], v204 offset:10752
    s_lshl4_add_u32 s48, s49, s48
    s_and_b32 s49, s56, 3
    s_lshl_b32 s49, s49, 6
    ds_read_b64_tr_b16 v[192:193], v204 offset:6976
    ds_read_b64_tr_b16 v[194:195], v203 offset:10816
    s_add_u32 s48, s48, s49
    v_mul_u32_u24 v216, 640, v216
    v_and_b32 v217, 6, v1
    ds_read_b64_tr_b16 v[196:197], v203 offset:6976
    ds_read_b64_tr_b16 v[198:199], v204 offset:10816
    v_lshl_add_u32 v216, v217, 3, v216
    v_add_u32 v214, s48, v216
    s_mul_i32 s49, s44, 6144
    ds_read_b64_tr_b16 v[108:109], v204 offset:7040
    ds_read_b64_tr_b16 v[110:111], v203 offset:10880
    s_add_u32 s49, s49, 135168
    v_lshl_add_u32 v215, v1, 4, s49
    v_lshrrev_b32 v216, 2, v1
    ds_read_b64_tr_b16 v[112:113], v203 offset:7040
    ds_read_b64_tr_b16 v[114:115], v204 offset:10880
    v_lshlrev_b32 v216, 7, v216
    v_lshl_add_u32 v216, v25, 3, v216
    s_lshl_b32 s48, s44, 5
    ds_read_b64_tr_b16 v[116:117], v203 offset:13824
    ds_read_b64_tr_b16 v[118:119], v204 offset:17664
    s_add_u32 s48, s48, 122880
    v_add_u32 v208, s48, v216
    s_mul_i32 s49, s55, 55296
    ds_read_b64_tr_b16 v[120:121], v204 offset:13824
    ds_read_b64_tr_b16 v[122:123], v203 offset:17664
    s_add_u32 s49, s49, 3072
    v_bfe_u32 v216, v1, 3, 1
    v_bfe_u32 v217, v1, 2, 1
    ds_read_b64_tr_b16 v[124:125], v203 offset:13888
    ds_read_b64_tr_b16 v[126:127], v204 offset:17728
    v_mad_u32_u24 v216, v216, 36, 0
    v_lshl_add_u32 v216, v216, 1, v217
    v_bfe_u32 v27, v1, 4, 1
    ds_read_b64_tr_b16 v[128:129], v204 offset:13888
    ds_read_b64_tr_b16 v[130:131], v203 offset:17728
    v_lshl_add_u32 v216, v27, 1, v216
    v_lshrrev_b32 v217, 5, v1
    v_mad_u32_u24 v216, v217, 36, v216
    ds_read_b64_tr_b16 v[132:133], v203 offset:13952
    ds_read_b64_tr_b16 v[134:135], v204 offset:17792
    v_mul_u32_u24 v216, 192, v216
    v_lshl_add_u32 v25, v25, 3, s49
    v_add_u32 v216, v216, v25
    ds_read_b64_tr_b16 v[218:219], v204 offset:13952
    ds_read_b64_tr_b16 v[220:221], v203 offset:17792
    v_lshl_add_u32 v205, v217, 5, v216
    v_mul_u32_u24 v26, 1152, v26
    v_lshl_add_u32 v26, v27, 5, v26
    ds_read_b64_tr_b16 v[222:223], v204 offset:20736
    ds_read_b64_tr_b16 v[224:225], v203 offset:24576
    v_lshl_add_u32 v207, v217, 4, v26
    v_xor_b32 v217, 1, v217
    v_lshl_add_u32 v206, v217, 5, v216
    ds_read_b64_tr_b16 v[226:227], v203 offset:20736
    ds_read_b64_tr_b16 v[228:229], v204 offset:24576
    s_add_u32 s48, s62, 4096
    ds_read_b64_tr_b16 v[230:231], v204 offset:20800
    ds_read_b64_tr_b16 v[232:233], v203 offset:24640
    ds_read_b64_tr_b16 v[234:235], v203 offset:20800
    ds_read_b64_tr_b16 v[236:237], v204 offset:24640
    ds_read_b64_tr_b16 v[238:239], v204 offset:20864
    ds_read_b64_tr_b16 v[240:241], v203 offset:24704
    ds_read_b64_tr_b16 v[242:243], v203 offset:20864
    ds_read_b64_tr_b16 v[244:245], v204 offset:24704
    ds_read_b64_tr_b16 v[246:247], v203 offset:27648
    ds_read_b64_tr_b16 v[248:249], v204 offset:31488
    ds_read_b64_tr_b16 v[250:251], v204 offset:27648
    ds_read_b64_tr_b16 v[252:253], v203 offset:31488
    ds_read_b64_tr_b16 v[40:41], v203 offset:27712
    ds_read_b64_tr_b16 v[42:43], v204 offset:31552
    ds_read_b64_tr_b16 v[44:45], v204 offset:27712
    ds_read_b64_tr_b16 v[46:47], v203 offset:31552
    ds_read_b64_tr_b16 v[48:49], v203 offset:27776
    ds_read_b64_tr_b16 v[50:51], v204 offset:31616
    ds_read_b64_tr_b16 v[52:53], v204 offset:27776
    ds_read_b64_tr_b16 v[54:55], v203 offset:31616
    s_cmp_lg_u32 s51, 0
    s_cbranch_scc1 o0_w0
    v_lshl_add_u32 v29, v1, 4, s67
    s_waitcnt vmcnt(0)
    s_barrier
o0_w0:
    ds_read_b64_tr_b16 v[56:57], v204 offset:34560
    ds_read_b64_tr_b16 v[58:59], v203 offset:38400
    ds_read_b64_tr_b16 v[60:61], v203 offset:34560
    ds_read_b64_tr_b16 v[62:63], v204 offset:38400
    ds_read_b64_tr_b16 v[2:3], v204 offset:34624
    ds_read_b64_tr_b16 v[4:5], v203 offset:38464
    ds_read_b64_tr_b16 v[6:7], v203 offset:34624
    ds_read_b64_tr_b16 v[8:9], v204 offset:38464
    ds_read_b64_tr_b16 v[10:11], v204 offset:34688
    ds_read_b64_tr_b16 v[12:13], v203 offset:38528
    ds_read_b64_tr_b16 v[14:15], v203 offset:34688
    ds_read_b64_tr_b16 v[16:17], v204 offset:38528
    buffer_load_dwordx2 v[22:23], v211, s[40:43], s52 offen sc1
    s_cmp_lg_u32 s51, 0
    s_cbranch_scc1 o0_w
    s_mov_b32 s50, 0
    s_and_b32 s47, s57, 0
    s_xor_b32 s47, s47, 0
    s_lshl_b32 s47, s47, 9
    s_add_u32 s68, s68, s47
    v_readfirstlane_b32 s24, v28
    s_waitcnt lgkmcnt(0)
    s_barrier
    s_buffer_load_dword s32, s[40:43], s68 offset:0 glc
    s_buffer_load_dword s33, s[40:43], s68 offset:128 glc
    s_buffer_load_dword s34, s[40:43], s68 offset:256 glc
    s_buffer_load_dword s35, s[40:43], s68 offset:384 glc
    s_add_u32 m0, s67, 0
    s_add_u32 s47, s69, 0
    buffer_load_dwordx4 v213, s[40:43], s47 offen sc1 lds
    s_mov_b32 s47, 0x680000
    buffer_load_dword v30, v214, s[40:43], s47 offen sc1
    s_add_u32 m0, s67, 1024
    s_add_u32 s47, s69, 33792
    buffer_load_dwordx4 v213, s[40:43], s47 offen sc1 lds
    s_mov_b32 s47, 0x681400
    buffer_load_dword v31, v214, s[40:43], s47 offen sc1
    s_add_u32 m0, s67, 2048
    s_add_u32 s47, s69, 67584
    buffer_load_dwordx4 v213, s[40:43], s47 offen sc1 lds
    s_mov_b32 s47, 0x682800
    buffer_load_dword v32, v214, s[40:43], s47 offen sc1
o0_rp:
    s_waitcnt lgkmcnt(0)
    s_xor_b32 s32, s32, s24
    s_xor_b32 s33, s33, s24
    s_xor_b32 s34, s34, s24
    s_xor_b32 s35, s35, s24
    s_or_b64 s[32:33], s[32:33], s[34:35]
    s_cbranch_scc0 o0_rq
    s_sleep 4
    s_buffer_load_dword s32, s[40:43], s68 offset:0 glc
    s_buffer_load_dword s33, s[40:43], s68 offset:128 glc
    s_buffer_load_dword s34, s[40:43], s68 offset:256 glc
    s_buffer_load_dword s35, s[40:43], s68 offset:384 glc
    s_add_u32 s50, s50, 1
    s_cmp_lt_u32 s50, 32768
    s_cbranch_scc1 o0_rp
    s_waitcnt lgkmcnt(0)
o0_rq:
o0_w:
    s_cmp_lg_u32 s51, 0
    s_cbranch_scc1 o0_bi
    s_mov_b32 s50, 0
    s_waitcnt vmcnt(0)
o0_b4:
    ds_read_b128 v[136:139], v29 offset:0
    ds_read_b128 v[140:143], v29 offset:1024
    ds_read_b128 v[144:147], v29 offset:2048
    s_waitcnt lgkmcnt(0)
    v_bitop3_b32 v136, v136, v137, v138 bitop3:0x96
    v_xor_b32 v136, v136, v139
    v_bitop3_b32 v140, v140, v141, v142 bitop3:0x96
    v_xor_b32 v140, v140, v143
    v_bitop3_b32 v144, v144, v145, v146 bitop3:0x96
    v_xor_b32 v144, v144, v147
    v_xor_b32_dpp v136, v136, v136 quad_perm:[1,0,3,2] row_mask:0xf bank_mask:0xf
    v_xor_b32_dpp v140, v140, v140 quad_perm:[1,0,3,2] row_mask:0xf bank_mask:0xf
    v_xor_b32_dpp v144, v144, v144 quad_perm:[1,0,3,2] row_mask:0xf bank_mask:0xf
    v_bitop3_b32 v136, v136, v30, v28 bitop3:0x96
    v_bitop3_b32 v140, v140, v31, v28 bitop3:0x96
    v_bitop3_b32 v144, v144, v32, v28 bitop3:0x96
    v_or3_b32 v136, v136, v140, v144
    v_cmp_ne_u32 vcc, 0, v136
    s_nop 3
    s_cbranch_vccz o0_b3
    s_add_u32 m0, s67, 0
    s_add_u32 s47, s69, 0
    buffer_load_dwordx4 v213, s[40:43], s47 offen sc1 lds
    s_mov_b32 s47, 0x680000
    buffer_load_dword v30, v214, s[40:43], s47 offen sc1
    s_add_u32 m0, s67, 1024
    s_add_u32 s47, s69, 33792
    buffer_load_dwordx4 v213, s[40:43], s47 offen sc1 lds
    s_mov_b32 s47, 0x681400
    buffer_load_dword v31, v214, s[40:43], s47 offen sc1
    s_add_u32 m0, s67, 2048
    s_add_u32 s47, s69, 67584
    buffer_load_dwordx4 v213, s[40:43], s47 offen sc1 lds
    s_mov_b32 s47, 0x682800
    buffer_load_dword v32, v214, s[40:43], s47 offen sc1
    s_add_u32 s50, s50, 1
    s_cmp_lt_u32 s50, 32768
    s_waitcnt vmcnt(0)
    s_cbranch_scc1 o0_b4
o0_b3:
    ds_write_b32 v39, v28
    s_waitcnt lgkmcnt(0)
o0_bi:
    buffer_load_dwordx4 v[64:67], v209, s[40:43], s62 offen offset:0 sc1
    buffer_load_dwordx4 v[68:71], v209, s[40:43], s62 offen offset:1024 sc1
    buffer_load_dwordx4 v[72:75], v209, s[40:43], s62 offen offset:2048 sc1
    buffer_load_dwordx4 v[76:79], v209, s[40:43], s62 offen offset:3072 sc1
    buffer_load_dwordx4 v[80:83], v209, s[40:43], s48 offen offset:0 sc1
    s_waitcnt vmcnt(4)
    s_waitcnt lgkmcnt(14)
    v_mfma_f32_16x16x32_bf16 v[136:139], v[160:163], v[64:67], 0
    ds_read_b64_tr_b16 v[18:19], v203 offset:41472
    ds_read_b64_tr_b16 v[20:21], v204 offset:45312
    buffer_load_dwordx4 v[84:87], v209, s[40:43], s48 offen offset:1024 sc1
    v_bitop3_b32 v33, v64, v65, v28 bitop3:0x96
    v_mfma_f32_16x16x32_bf16 v[140:143], v[164:167], v[64:67], 0
    ds_read_b64_tr_b16 v[160:161], v204 offset:41472
    ds_read_b64_tr_b16 v[162:163], v203 offset:45312
    v_bitop3_b32 v33, v66, v67, v33 bitop3:0x96
    v_mfma_f32_16x16x32_bf16 v[144:147], v[168:171], v[64:67], 0
    ds_read_b64_tr_b16 v[164:165], v203 offset:41536
    ds_read_b64_tr_b16 v[166:167], v204 offset:45376
    v_mfma_f32_16x16x32_bf16 v[148:151], v[172:175], v[64:67], 0
    ds_read_b64_tr_b16 v[168:169], v204 offset:41536
    ds_read_b64_tr_b16 v[170:171], v203 offset:45376
    buffer_load_dwordx4 v[88:91], v209, s[40:43], s48 offen offset:2048 sc1
    v_mfma_f32_16x16x32_bf16 v[152:155], v[176:179], v[64:67], 0
    ds_read_b64_tr_b16 v[172:173], v203 offset:41600
    ds_read_b64_tr_b16 v[174:175], v204 offset:45440
    v_mfma_f32_16x16x32_bf16 v[156:159], v[180:183], v[64:67], 0
    ds_read_b64_tr_b16 v[176:177], v204 offset:41600
    ds_read_b64_tr_b16 v[178:179], v203 offset:45440
    s_waitcnt vmcnt(5)
    v_mfma_f32_16x16x32_bf16 v[136:139], v[184:187], v[68:71], v[136:139]
    ds_read_b64_tr_b16 v[180:181], v204 offset:48384
    ds_read_b64_tr_b16 v[182:183], v203 offset:52224
    buffer_load_dwordx4 v[92:95], v209, s[40:43], s48 offen offset:3072 sc1
    v_bitop3_b32 v33, v68, v69, v33 bitop3:0x96
    v_mfma_f32_16x16x32_bf16 v[140:143], v[188:191], v[68:71], v[140:143]
    ds_read_b64_tr_b16 v[184:185], v203 offset:48384
    ds_read_b64_tr_b16 v[186:187], v204 offset:52224
    v_bitop3_b32 v33, v70, v71, v33 bitop3:0x96
    v_mfma_f32_16x16x32_bf16 v[144:147], v[192:195], v[68:71], v[144:147]
    ds_read_b64_tr_b16 v[188:189], v204 offset:48448
    ds_read_b64_tr_b16 v[190:191], v203 offset:52288
    v_mfma_f32_16x16x32_bf16 v[148:151], v[196:199], v[68:71], v[148:151]
    ds_read_b64_tr_b16 v[192:193], v203 offset:48448
    ds_read_b64_tr_b16 v[194:195], v204 offset:52288
    buffer_load_dwordx2 v[100:101], v210, s[40:43], s62 offen offset:0 sc1
    v_mfma_f32_16x16x32_bf16 v[152:155], v[108:111], v[68:71], v[152:155]
    ds_read_b64_tr_b16 v[196:197], v204 offset:48512
    ds_read_b64_tr_b16 v[198:199], v203 offset:52352
    v_mfma_f32_16x16x32_bf16 v[156:159], v[112:115], v[68:71], v[156:159]
    ds_read_b64_tr_b16 v[108:109], v203 offset:48512
    ds_read_b64_tr_b16 v[110:111], v204 offset:52352
    s_waitcnt vmcnt(6)
    v_mfma_f32_16x16x32_bf16 v[136:139], v[116:119], v[72:75], v[136:139]
    ds_read_b64_tr_b16 v[112:113], v205 offset:0
    ds_read_b64_tr_b16 v[114:115], v205 offset:27648
    buffer_load_dwordx2 v[102:103], v210, s[40:43], s62 offen offset:512 sc1
    v_bitop3_b32 v34, v72, v73, v28 bitop3:0x96
    v_mfma_f32_16x16x32_bf16 v[140:143], v[120:123], v[72:75], v[140:143]
    ds_read_b64_tr_b16 v[116:117], v206 offset:0
    ds_read_b64_tr_b16 v[118:119], v206 offset:27648
    v_bitop3_b32 v34, v74, v75, v34 bitop3:0x96
    v_mfma_f32_16x16x32_bf16 v[144:147], v[124:127], v[72:75], v[144:147]
    ds_read_b64_tr_b16 v[120:121], v205 offset:64
    ds_read_b64_tr_b16 v[122:123], v205 offset:27712
    v_mfma_f32_16x16x32_bf16 v[148:151], v[128:131], v[72:75], v[148:151]
    ds_read_b64_tr_b16 v[124:125], v206 offset:64
    ds_read_b64_tr_b16 v[126:127], v206 offset:27712
    buffer_load_dwordx2 v[104:105], v210, s[40:43], s62 offen offset:1024 sc1
    v_mfma_f32_16x16x32_bf16 v[152:155], v[132:135], v[72:75], v[152:155]
    ds_read_b64_tr_b16 v[128:129], v205 offset:128
    ds_read_b64_tr_b16 v[130:131], v205 offset:27776
    v_mfma_f32_16x16x32_bf16 v[156:159], v[218:221], v[72:75], v[156:159]
    ds_read_b64_tr_b16 v[132:133], v206 offset:128
    ds_read_b64_tr_b16 v[134:135], v206 offset:27776
    s_waitcnt vmcnt(7)
    v_mfma_f32_16x16x32_bf16 v[136:139], v[222:225], v[76:79], v[136:139]
    buffer_load_dwordx2 v[106:107], v210, s[40:43], s62 offen offset:1536 sc1
    v_bitop3_b32 v34, v76, v77, v34 bitop3:0x96
    v_mfma_f32_16x16x32_bf16 v[140:143], v[226:229], v[76:79], v[140:143]
    v_bitop3_b32 v34, v78, v79, v34 bitop3:0x96
    v_mfma_f32_16x16x32_bf16 v[144:147], v[230:233], v[76:79], v[144:147]
    v_xor_b32 v25, v23, v28
    v_mfma_f32_16x16x32_bf16 v[148:151], v[234:237], v[76:79], v[148:151]
    v_and_b32 v26, 15, v1
    v_mfma_f32_16x16x32_bf16 v[152:155], v[238:241], v[76:79], v[152:155]
    v_mul_u32_u24 v26, 208, v26
    v_mfma_f32_16x16x32_bf16 v[156:159], v[242:245], v[76:79], v[156:159]
    v_lshrrev_b32 v27, 4, v1
    s_waitcnt vmcnt(7)
    v_mfma_f32_16x16x32_bf16 v[136:139], v[246:249], v[80:83], v[136:139]
    v_bitop3_b32 v35, v80, v81, v28 bitop3:0x96
    v_mfma_f32_16x16x32_bf16 v[140:143], v[250:253], v[80:83], v[140:143]
    v_bitop3_b32 v35, v82, v83, v35 bitop3:0x96
    v_mfma_f32_16x16x32_bf16 v[144:147], v[40:43], v[80:83], v[144:147]
    v_lshl_add_u32 v26, v27, 3, v26
    v_mfma_f32_16x16x32_bf16 v[148:151], v[44:47], v[80:83], v[148:151]
    s_mul_i32 s47, s44, 6144
    s_waitcnt lgkmcnt(14)
    v_mfma_f32_16x16x32_bf16 v[152:155], v[48:51], v[80:83], v[152:155]
    s_add_u32 s47, s47, 135168
    v_mfma_f32_16x16x32_bf16 v[156:159], v[52:55], v[80:83], v[156:159]
    v_add_u32 v26, s47, v26
    s_waitcnt vmcnt(6)
    v_mfma_f32_16x16x32_bf16 v[136:139], v[56:59], v[84:87], v[136:139]
    v_bitop3_b32 v35, v84, v85, v35 bitop3:0x96
    v_mfma_f32_16x16x32_bf16 v[140:143], v[60:63], v[84:87], v[140:143]
    v_bitop3_b32 v35, v86, v87, v35 bitop3:0x96
    v_mfma_f32_16x16x32_bf16 v[144:147], v[2:5], v[84:87], v[144:147]
    v_lshrrev_b32 v37, 2, v1
    v_mfma_f32_16x16x32_bf16 v[148:151], v[6:9], v[84:87], v[148:151]
    v_and_b32 v38, 3, v1
    v_mfma_f32_16x16x32_bf16 v[152:155], v[10:13], v[84:87], v[152:155]
    v_lshlrev_b32 v38, 4, v38
    v_mfma_f32_16x16x32_bf16 v[156:159], v[14:17], v[84:87], v[156:159]
    v_mul_u32_u24 v27, 208, v37
    s_waitcnt vmcnt(5)
    v_mfma_f32_16x16x32_bf16 v[136:139], v[18:21], v[88:91], v[136:139]
    v_bitop3_b32 v36, v88, v89, v28 bitop3:0x96
    v_mfma_f32_16x16x32_bf16 v[140:143], v[160:163], v[88:91], v[140:143]
    v_bitop3_b32 v36, v90, v91, v36 bitop3:0x96
    v_mfma_f32_16x16x32_bf16 v[144:147], v[164:167], v[88:91], v[144:147]
    v_add3_u32 v27, v27, v38, s47
    v_mfma_f32_16x16x32_bf16 v[148:151], v[168:171], v[88:91], v[148:151]
    v_mul_u32_u24 v37, 1152, v37
    v_mfma_f32_16x16x32_bf16 v[152:155], v[172:175], v[88:91], v[152:155]
    v_add_u32 v37, v37, v38
    v_mfma_f32_16x16x32_bf16 v[156:159], v[176:179], v[88:91], v[156:159]
    s_waitcnt vmcnt(4)
    v_mfma_f32_16x16x32_bf16 v[136:139], v[180:183], v[92:95], v[136:139]
    v_bitop3_b32 v36, v92, v93, v36 bitop3:0x96
    v_mfma_f32_16x16x32_bf16 v[140:143], v[184:187], v[92:95], v[140:143]
    v_bitop3_b32 v36, v94, v95, v36 bitop3:0x96
    s_waitcnt vmcnt(0)
    v_mfma_f32_16x16x32_bf16 v[144:147], v[188:191], v[92:95], v[144:147]
    v_mov_b32 v96, v100
    v_mov_b32 v97, v102
    v_mov_b32 v98, v104
    v_mov_b32 v99, v106
    v_mfma_f32_16x16x32_bf16 v[148:151], v[192:195], v[92:95], v[148:151]
    v_bitop3_b32 v101, v101, v100, v33 bitop3:0x96
    v_bitop3_b32 v103, v103, v102, v34 bitop3:0x96
    v_bitop3_b32 v105, v105, v104, v35 bitop3:0x96
    v_bitop3_b32 v107, v107, v106, v36 bitop3:0x96
    s_waitcnt lgkmcnt(12)
    v_mfma_f32_16x16x32_bf16 v[152:155], v[196:199], v[92:95], v[152:155]
    v_or3_b32 v25, v25, v101, v103
    v_or3_b32 v25, v25, v105, v107
    v_cmp_ne_u32 vcc, 0, v25
    v_mfma_f32_16x16x32_bf16 v[156:159], v[108:111], v[92:95], v[156:159]
    s_waitcnt lgkmcnt(8)
    v_mfma_f32_16x16x32_bf16 v[136:139], v[112:115], v[96:99], v[136:139]
    s_mov_b32 s50, 0
o0_x:
    ds_read_b32 v242, v39 offset:16
    s_add_u32 s50, s50, 1
    s_waitcnt lgkmcnt(0)
    v_cmp_ne_u32 s[20:21], v242, v28
    s_cmp_lt_u32 s50, 2097152
    s_cselect_b64 s[20:21], s[20:21], 0
    s_cmp_lg_u64 s[20:21], 0
    s_nop 0
    s_cbranch_scc1 o0_x
    ds_read_b128 v[218:221], v215 offset:0
    ds_read_b128 v[222:225], v215 offset:1024
    ds_read_b128 v[226:229], v215 offset:2048
    ds_read_b128 v[230:233], v215 offset:3072
    ds_read_b128 v[234:237], v215 offset:4096
    ds_read_b128 v[238:241], v215 offset:5120
    v_mfma_f32_16x16x32_bf16 v[140:143], v[116:119], v[96:99], v[140:143]
    v_mfma_f32_16x16x32_bf16 v[144:147], v[120:123], v[96:99], v[144:147]
    v_mfma_f32_16x16x32_bf16 v[148:151], v[124:127], v[96:99], v[148:151]
    v_mfma_f32_16x16x32_bf16 v[152:155], v[128:131], v[96:99], v[152:155]
    v_mfma_f32_16x16x32_bf16 v[156:159], v[132:135], v[96:99], v[156:159]
    s_nop 6
    s_cbranch_vccnz o0_slow
o0_ok:
    s_waitcnt lgkmcnt(0)
    v_pk_fma_f32 v[218:219], v[136:137], v[22:23], v[218:219] op_sel:[0,0,0] op_sel_hi:[1,0,1]
    v_pk_fma_f32 v[220:221], v[138:139], v[22:23], v[220:221] op_sel:[0,0,0] op_sel_hi:[1,0,1]
    v_cvt_pk_bf16_f32 v64, v218, v219
    v_cvt_pk_bf16_f32 v65, v220, v221
    ds_write_b64 v26, v[64:65] offset:0
    v_pk_fma_f32 v[222:223], v[140:141], v[22:23], v[222:223] op_sel:[0,0,0] op_sel_hi:[1,0,1]
    v_pk_fma_f32 v[224:225], v[142:143], v[22:23], v[224:225] op_sel:[0,0,0] op_sel_hi:[1,0,1]
    v_cvt_pk_bf16_f32 v66, v222, v223
    v_cvt_pk_bf16_f32 v67, v224, v225
    ds_write_b64 v26, v[66:67] offset:32
    v_pk_fma_f32 v[226:227], v[144:145], v[22:23], v[226:227] op_sel:[0,0,0] op_sel_hi:[1,0,1]
    v_pk_fma_f32 v[228:229], v[146:147], v[22:23], v[228:229] op_sel:[0,0,0] op_sel_hi:[1,0,1]
    v_cvt_pk_bf16_f32 v68, v226, v227
    v_cvt_pk_bf16_f32 v69, v228, v229
    ds_write_b64 v26, v[68:69] offset:64
    v_pk_fma_f32 v[230:231], v[148:149], v[22:23], v[230:231] op_sel:[0,0,0] op_sel_hi:[1,0,1]
    v_pk_fma_f32 v[232:233], v[150:151], v[22:23], v[232:233] op_sel:[0,0,0] op_sel_hi:[1,0,1]
    v_cvt_pk_bf16_f32 v70, v230, v231
    v_cvt_pk_bf16_f32 v71, v232, v233
    ds_write_b64 v26, v[70:71] offset:96
    v_pk_fma_f32 v[234:235], v[152:153], v[22:23], v[234:235] op_sel:[0,0,0] op_sel_hi:[1,0,1]
    v_pk_fma_f32 v[236:237], v[154:155], v[22:23], v[236:237] op_sel:[0,0,0] op_sel_hi:[1,0,1]
    v_cvt_pk_bf16_f32 v72, v234, v235
    v_cvt_pk_bf16_f32 v73, v236, v237
    ds_write_b64 v26, v[72:73] offset:128
    v_pk_fma_f32 v[238:239], v[156:157], v[22:23], v[238:239] op_sel:[0,0,0] op_sel_hi:[1,0,1]
    v_pk_fma_f32 v[240:241], v[158:159], v[22:23], v[240:241] op_sel:[0,0,0] op_sel_hi:[1,0,1]
    v_cvt_pk_bf16_f32 v74, v238, v239
    v_cvt_pk_bf16_f32 v75, v240, v241
    ds_write_b64 v26, v[74:75] offset:160
    ds_read_b128 v[80:83], v27 offset:0
    ds_read_b128 v[84:87], v27 offset:64
    ds_read_b128 v[88:91], v27 offset:128
    s_waitcnt lgkmcnt(2)
    buffer_store_dwordx4 v[80:83], v37, s[16:19], s63 offen offset:0 sc1
    s_waitcnt lgkmcnt(1)
    buffer_store_dwordx4 v[84:87], v37, s[16:19], s63 offen offset:64 sc1
    s_waitcnt lgkmcnt(0)
    buffer_store_dwordx4 v[88:91], v37, s[16:19], s63 offen offset:128 sc1
    s_endpgm
o0_slow:
    s_add_u32 s51, s51, 1
    s_cmp_lt_u32 s51, 32768
    s_waitcnt vmcnt(0) lgkmcnt(0)
    s_cbranch_scc1 o0_redo
    s_branch o0_ok
o1:
    s_setprio 1
    s_mov_b32 s51, 0
    v_mov_b32 v38, 110592
    s_lshl2_add_u32 s47, s44, 110592
    v_mov_b32 v39, s47
    s_barrier
o1_redo:
    ds_read_b64_tr_b16 v[160:161], v203 offset:0
    ds_read_b64_tr_b16 v[162:163], v204 offset:3840
    s_lshl_b32 s52, s61, 10
    s_add_u32 s52, s52, 0x4f0000
    v_and_b32 v25, 3, v1
    ds_read_b64_tr_b16 v[164:165], v204 offset:0
    ds_read_b64_tr_b16 v[166:167], v203 offset:3840
    s_and_b32 s47, s57, 0
    s_xor_b32 s47, s47, s55
    s_lshl_b32 s49, s47, 11
    ds_read_b64_tr_b16 v[168:169], v203 offset:64
    ds_read_b64_tr_b16 v[170:171], v204 offset:3904
    s_add_u32 s49, s49, 16384
    v_lshl_add_u32 v210, v1, 3, s49
    s_lshl_b32 s47, s47, 13
    ds_read_b64_tr_b16 v[172:173], v204 offset:64
    ds_read_b64_tr_b16 v[174:175], v203 offset:3904
    v_lshl_add_u32 v209, v1, 4, s47
    v_and_b32 v26, 15, v1
    v_lshlrev_b32 v211, 6, v26
    ds_read_b64_tr_b16 v[176:177], v203 offset:128
    ds_read_b64_tr_b16 v[178:179], v204 offset:3968
    v_lshrrev_b32 v216, 3, v1
    v_and_b32 v217, 7, v1
    v_mul_u32_u24 v213, 4224, v216
    ds_read_b64_tr_b16 v[180:181], v204 offset:128
    ds_read_b64_tr_b16 v[182:183], v203 offset:3968
    v_lshl_add_u32 v213, v217, 4, v213
    s_lshl2_add_u32 s48, s57, s44
    s_mul_i32 s48, s48, 15360
    ds_read_b64_tr_b16 v[184:185], v204 offset:6912
    ds_read_b64_tr_b16 v[186:187], v203 offset:10752
    s_and_b32 s49, s56, 12
    s_add_u32 s48, s48, s49
    s_and_b32 s49, s56, 16
    ds_read_b64_tr_b16 v[188:189], v203 offset:6912
    ds_read_b64_tr_b16 v[190:191], v204 offset:10752
    s_lshl4_add_u32 s48, s49, s48
    s_and_b32 s49, s56, 3
    s_lshl_b32 s49, s49, 6
    ds_read_b64_tr_b16 v[192:193], v204 offset:6976
    ds_read_b64_tr_b16 v[194:195], v203 offset:10816
    s_add_u32 s48, s48, s49
    v_mul_u32_u24 v216, 640, v216
    v_and_b32 v217, 6, v1
    ds_read_b64_tr_b16 v[196:197], v203 offset:6976
    ds_read_b64_tr_b16 v[198:199], v204 offset:10816
    v_lshl_add_u32 v216, v217, 3, v216
    v_add_u32 v214, s48, v216
    s_mul_i32 s49, s44, 6144
    ds_read_b64_tr_b16 v[108:109], v204 offset:7040
    ds_read_b64_tr_b16 v[110:111], v203 offset:10880
    s_add_u32 s49, s49, 135168
    v_lshl_add_u32 v215, v1, 4, s49
    v_lshrrev_b32 v216, 2, v1
    ds_read_b64_tr_b16 v[112:113], v203 offset:7040
    ds_read_b64_tr_b16 v[114:115], v204 offset:10880
    v_lshlrev_b32 v216, 7, v216
    v_lshl_add_u32 v216, v25, 3, v216
    s_lshl_b32 s48, s44, 5
    ds_read_b64_tr_b16 v[116:117], v203 offset:13824
    ds_read_b64_tr_b16 v[118:119], v204 offset:17664
    s_add_u32 s48, s48, 122880
    v_add_u32 v208, s48, v216
    s_mul_i32 s49, s55, 55296
    ds_read_b64_tr_b16 v[120:121], v204 offset:13824
    ds_read_b64_tr_b16 v[122:123], v203 offset:17664
    s_add_u32 s49, s49, 3072
    v_bfe_u32 v216, v1, 3, 1
    v_bfe_u32 v217, v1, 2, 1
    ds_read_b64_tr_b16 v[124:125], v203 offset:13888
    ds_read_b64_tr_b16 v[126:127], v204 offset:17728
    v_mad_u32_u24 v216, v216, 36, 0
    v_lshl_add_u32 v216, v216, 1, v217
    v_bfe_u32 v27, v1, 4, 1
    ds_read_b64_tr_b16 v[128:129], v204 offset:13888
    ds_read_b64_tr_b16 v[130:131], v203 offset:17728
    v_lshl_add_u32 v216, v27, 1, v216
    v_lshrrev_b32 v217, 5, v1
    v_mad_u32_u24 v216, v217, 36, v216
    ds_read_b64_tr_b16 v[132:133], v203 offset:13952
    ds_read_b64_tr_b16 v[134:135], v204 offset:17792
    v_mul_u32_u24 v216, 192, v216
    v_lshl_add_u32 v25, v25, 3, s49
    v_add_u32 v216, v216, v25
    ds_read_b64_tr_b16 v[218:219], v204 offset:13952
    ds_read_b64_tr_b16 v[220:221], v203 offset:17792
    v_lshl_add_u32 v205, v217, 5, v216
    v_mul_u32_u24 v26, 1152, v26
    v_lshl_add_u32 v26, v27, 5, v26
    ds_read_b64_tr_b16 v[222:223], v204 offset:20736
    ds_read_b64_tr_b16 v[224:225], v203 offset:24576
    v_lshl_add_u32 v207, v217, 4, v26
    v_xor_b32 v217, 1, v217
    v_lshl_add_u32 v206, v217, 5, v216
    ds_read_b64_tr_b16 v[226:227], v203 offset:20736
    ds_read_b64_tr_b16 v[228:229], v204 offset:24576
    s_add_u32 s48, s62, 4096
    ds_read_b64_tr_b16 v[230:231], v204 offset:20800
    ds_read_b64_tr_b16 v[232:233], v203 offset:24640
    ds_read_b64_tr_b16 v[234:235], v203 offset:20800
    ds_read_b64_tr_b16 v[236:237], v204 offset:24640
    ds_read_b64_tr_b16 v[238:239], v204 offset:20864
    ds_read_b64_tr_b16 v[240:241], v203 offset:24704
    ds_read_b64_tr_b16 v[242:243], v203 offset:20864
    ds_read_b64_tr_b16 v[244:245], v204 offset:24704
    ds_read_b64_tr_b16 v[246:247], v203 offset:27648
    ds_read_b64_tr_b16 v[248:249], v204 offset:31488
    ds_read_b64_tr_b16 v[250:251], v204 offset:27648
    ds_read_b64_tr_b16 v[252:253], v203 offset:31488
    ds_read_b64_tr_b16 v[40:41], v203 offset:27712
    ds_read_b64_tr_b16 v[42:43], v204 offset:31552
    ds_read_b64_tr_b16 v[44:45], v204 offset:27712
    ds_read_b64_tr_b16 v[46:47], v203 offset:31552
    buffer_load_dwordx2 v[22:23], v211, s[40:43], s52 offen sc1
    s_cmp_lg_u32 s51, 0
    s_cbranch_scc1 o1_w
    s_waitcnt vmcnt(2)
    s_mov_b32 s50, 0
    s_and_b32 s47, s57, 0
    s_xor_b32 s47, s47, 1
    s_lshl_b32 s47, s47, 9
    s_add_u32 s68, s68, s47
    v_readfirstlane_b32 s24, v28
    s_nop 0
    s_barrier
    s_buffer_load_dword s32, s[40:43], s68 offset:0 glc
    s_buffer_load_dword s33, s[40:43], s68 offset:128 glc
    s_buffer_load_dword s34, s[40:43], s68 offset:256 glc
    s_buffer_load_dword s35, s[40:43], s68 offset:384 glc
o1_rp:
    s_waitcnt lgkmcnt(0)
    s_xor_b32 s32, s32, s24
    s_xor_b32 s33, s33, s24
    s_xor_b32 s34, s34, s24
    s_xor_b32 s35, s35, s24
    s_or_b64 s[32:33], s[32:33], s[34:35]
    s_cbranch_scc0 o1_rq
    s_sleep 4
    s_buffer_load_dword s32, s[40:43], s68 offset:0 glc
    s_buffer_load_dword s33, s[40:43], s68 offset:128 glc
    s_buffer_load_dword s34, s[40:43], s68 offset:256 glc
    s_buffer_load_dword s35, s[40:43], s68 offset:384 glc
    s_add_u32 s50, s50, 1
    s_cmp_lt_u32 s50, 32768
    s_cbranch_scc1 o1_rp
    s_waitcnt lgkmcnt(0)
o1_rq:
o1_w:
    buffer_load_dwordx4 v[64:67], v209, s[40:43], s62 offen offset:0 sc1
    buffer_load_dwordx4 v[68:71], v209, s[40:43], s62 offen offset:1024 sc1
    buffer_load_dwordx4 v[72:75], v209, s[40:43], s62 offen offset:2048 sc1
    buffer_load_dwordx4 v[76:79], v209, s[40:43], s62 offen offset:3072 sc1
    buffer_load_dwordx4 v[80:83], v209, s[40:43], s48 offen offset:0 sc1
    buffer_load_dwordx4 v[84:87], v209, s[40:43], s48 offen offset:1024 sc1
    buffer_load_dwordx4 v[88:91], v209, s[40:43], s48 offen offset:2048 sc1
    buffer_load_dwordx4 v[92:95], v209, s[40:43], s48 offen offset:3072 sc1
    buffer_load_dwordx2 v[100:101], v210, s[40:43], s62 offen offset:0 sc1
    buffer_load_dwordx2 v[102:103], v210, s[40:43], s62 offen offset:512 sc1
    ds_read_b64_tr_b16 v[48:49], v203 offset:27776
    ds_read_b64_tr_b16 v[50:51], v204 offset:31616
    ds_read_b64_tr_b16 v[52:53], v204 offset:27776
    ds_read_b64_tr_b16 v[54:55], v203 offset:31616
    ds_read_b64_tr_b16 v[56:57], v204 offset:34560
    ds_read_b64_tr_b16 v[58:59], v203 offset:38400
    ds_read_b64_tr_b16 v[60:61], v203 offset:34560
    ds_read_b64_tr_b16 v[62:63], v204 offset:38400
    ds_read_b64_tr_b16 v[2:3], v204 offset:34624
    ds_read_b64_tr_b16 v[4:5], v203 offset:38464
    ds_read_b64_tr_b16 v[6:7], v203 offset:34624
    ds_read_b64_tr_b16 v[8:9], v204 offset:38464
    ds_read_b64_tr_b16 v[10:11], v204 offset:34688
    ds_read_b64_tr_b16 v[12:13], v203 offset:38528
    ds_read_b64_tr_b16 v[14:15], v203 offset:34688
    ds_read_b64_tr_b16 v[16:17], v204 offset:38528
    s_waitcnt vmcnt(9)
    s_waitcnt lgkmcnt(14)
    v_mfma_f32_16x16x32_bf16 v[136:139], v[160:163], v[64:67], 0
    ds_read_b64_tr_b16 v[18:19], v203 offset:41472
    ds_read_b64_tr_b16 v[20:21], v204 offset:45312
    buffer_load_dwordx2 v[104:105], v210, s[40:43], s62 offen offset:1024 sc1
    v_bitop3_b32 v33, v64, v65, v28 bitop3:0x96
    v_mfma_f32_16x16x32_bf16 v[140:143], v[164:167], v[64:67], 0
    ds_read_b64_tr_b16 v[160:161], v204 offset:41472
    ds_read_b64_tr_b16 v[162:163], v203 offset:45312
    v_bitop3_b32 v33, v66, v67, v33 bitop3:0x96
    v_mfma_f32_16x16x32_bf16 v[144:147], v[168:171], v[64:67], 0
    ds_read_b64_tr_b16 v[164:165], v203 offset:41536
    ds_read_b64_tr_b16 v[166:167], v204 offset:45376
    v_mfma_f32_16x16x32_bf16 v[148:151], v[172:175], v[64:67], 0
    ds_read_b64_tr_b16 v[168:169], v204 offset:41536
    ds_read_b64_tr_b16 v[170:171], v203 offset:45376
    buffer_load_dwordx2 v[106:107], v210, s[40:43], s62 offen offset:1536 sc1
    v_mfma_f32_16x16x32_bf16 v[152:155], v[176:179], v[64:67], 0
    ds_read_b64_tr_b16 v[172:173], v203 offset:41600
    ds_read_b64_tr_b16 v[174:175], v204 offset:45440
    v_mfma_f32_16x16x32_bf16 v[156:159], v[180:183], v[64:67], 0
    ds_read_b64_tr_b16 v[176:177], v204 offset:41600
    ds_read_b64_tr_b16 v[178:179], v203 offset:45440
    s_waitcnt vmcnt(10)
    v_mfma_f32_16x16x32_bf16 v[136:139], v[184:187], v[68:71], v[136:139]
    ds_read_b64_tr_b16 v[180:181], v204 offset:48384
    ds_read_b64_tr_b16 v[182:183], v203 offset:52224
    v_bitop3_b32 v33, v68, v69, v33 bitop3:0x96
    v_mfma_f32_16x16x32_bf16 v[140:143], v[188:191], v[68:71], v[140:143]
    ds_read_b64_tr_b16 v[184:185], v203 offset:48384
    ds_read_b64_tr_b16 v[186:187], v204 offset:52224
    v_bitop3_b32 v33, v70, v71, v33 bitop3:0x96
    v_mfma_f32_16x16x32_bf16 v[144:147], v[192:195], v[68:71], v[144:147]
    ds_read_b64_tr_b16 v[188:189], v204 offset:48448
    ds_read_b64_tr_b16 v[190:191], v203 offset:52288
    v_mfma_f32_16x16x32_bf16 v[148:151], v[196:199], v[68:71], v[148:151]
    ds_read_b64_tr_b16 v[192:193], v203 offset:48448
    ds_read_b64_tr_b16 v[194:195], v204 offset:52288
    v_mfma_f32_16x16x32_bf16 v[152:155], v[108:111], v[68:71], v[152:155]
    ds_read_b64_tr_b16 v[196:197], v204 offset:48512
    ds_read_b64_tr_b16 v[198:199], v203 offset:52352
    v_mfma_f32_16x16x32_bf16 v[156:159], v[112:115], v[68:71], v[156:159]
    ds_read_b64_tr_b16 v[108:109], v203 offset:48512
    ds_read_b64_tr_b16 v[110:111], v204 offset:52352
    s_waitcnt vmcnt(9)
    v_mfma_f32_16x16x32_bf16 v[136:139], v[116:119], v[72:75], v[136:139]
    ds_read_b64_tr_b16 v[112:113], v205 offset:0
    ds_read_b64_tr_b16 v[114:115], v205 offset:27648
    v_bitop3_b32 v34, v72, v73, v28 bitop3:0x96
    v_mfma_f32_16x16x32_bf16 v[140:143], v[120:123], v[72:75], v[140:143]
    ds_read_b64_tr_b16 v[116:117], v206 offset:0
    ds_read_b64_tr_b16 v[118:119], v206 offset:27648
    v_bitop3_b32 v34, v74, v75, v34 bitop3:0x96
    v_mfma_f32_16x16x32_bf16 v[144:147], v[124:127], v[72:75], v[144:147]
    ds_read_b64_tr_b16 v[120:121], v205 offset:64
    ds_read_b64_tr_b16 v[122:123], v205 offset:27712
    v_mfma_f32_16x16x32_bf16 v[148:151], v[128:131], v[72:75], v[148:151]
    ds_read_b64_tr_b16 v[124:125], v206 offset:64
    ds_read_b64_tr_b16 v[126:127], v206 offset:27712
    v_mfma_f32_16x16x32_bf16 v[152:155], v[132:135], v[72:75], v[152:155]
    ds_read_b64_tr_b16 v[128:129], v205 offset:128
    ds_read_b64_tr_b16 v[130:131], v205 offset:27776
    v_mfma_f32_16x16x32_bf16 v[156:159], v[218:221], v[72:75], v[156:159]
    ds_read_b64_tr_b16 v[132:133], v206 offset:128
    ds_read_b64_tr_b16 v[134:135], v206 offset:27776
    s_waitcnt vmcnt(8)
    v_mfma_f32_16x16x32_bf16 v[136:139], v[222:225], v[76:79], v[136:139]
    v_bitop3_b32 v34, v76, v77, v34 bitop3:0x96
    v_mfma_f32_16x16x32_bf16 v[140:143], v[226:229], v[76:79], v[140:143]
    v_bitop3_b32 v34, v78, v79, v34 bitop3:0x96
    v_mfma_f32_16x16x32_bf16 v[144:147], v[230:233], v[76:79], v[144:147]
    v_xor_b32 v25, v23, v28
    v_mfma_f32_16x16x32_bf16 v[148:151], v[234:237], v[76:79], v[148:151]
    v_sub_f32 v24, 1.0, v22
    v_mfma_f32_16x16x32_bf16 v[152:155], v[238:241], v[76:79], v[152:155]
    v_cvt_pk_bf16_f32 v24, v24, v24
    v_mfma_f32_16x16x32_bf16 v[156:159], v[242:245], v[76:79], v[156:159]
    v_lshlrev_b32 v24, 16, v24
    s_waitcnt vmcnt(7)
    v_mfma_f32_16x16x32_bf16 v[136:139], v[246:249], v[80:83], v[136:139]
    v_bitop3_b32 v35, v80, v81, v28 bitop3:0x96
    v_mfma_f32_16x16x32_bf16 v[140:143], v[250:253], v[80:83], v[140:143]
    v_bitop3_b32 v35, v82, v83, v35 bitop3:0x96
    v_mfma_f32_16x16x32_bf16 v[144:147], v[40:43], v[80:83], v[144:147]
    v_mfma_f32_16x16x32_bf16 v[148:151], v[44:47], v[80:83], v[148:151]
    s_waitcnt lgkmcnt(14)
    v_mfma_f32_16x16x32_bf16 v[152:155], v[48:51], v[80:83], v[152:155]
    v_mfma_f32_16x16x32_bf16 v[156:159], v[52:55], v[80:83], v[156:159]
    s_waitcnt vmcnt(6)
    v_mfma_f32_16x16x32_bf16 v[136:139], v[56:59], v[84:87], v[136:139]
    v_bitop3_b32 v35, v84, v85, v35 bitop3:0x96
    v_mfma_f32_16x16x32_bf16 v[140:143], v[60:63], v[84:87], v[140:143]
    v_bitop3_b32 v35, v86, v87, v35 bitop3:0x96
    v_mfma_f32_16x16x32_bf16 v[144:147], v[2:5], v[84:87], v[144:147]
    v_mfma_f32_16x16x32_bf16 v[148:151], v[6:9], v[84:87], v[148:151]
    v_mfma_f32_16x16x32_bf16 v[152:155], v[10:13], v[84:87], v[152:155]
    v_mfma_f32_16x16x32_bf16 v[156:159], v[14:17], v[84:87], v[156:159]
    s_waitcnt vmcnt(5)
    v_mfma_f32_16x16x32_bf16 v[136:139], v[18:21], v[88:91], v[136:139]
    v_bitop3_b32 v36, v88, v89, v28 bitop3:0x96
    v_mfma_f32_16x16x32_bf16 v[140:143], v[160:163], v[88:91], v[140:143]
    v_bitop3_b32 v36, v90, v91, v36 bitop3:0x96
    v_mfma_f32_16x16x32_bf16 v[144:147], v[164:167], v[88:91], v[144:147]
    v_mfma_f32_16x16x32_bf16 v[148:151], v[168:171], v[88:91], v[148:151]
    v_mfma_f32_16x16x32_bf16 v[152:155], v[172:175], v[88:91], v[152:155]
    s_mov_b32 s50, 0
o1_x:
    ds_read_b128 v[242:245], v38
    s_add_u32 s50, s50, 1
    s_waitcnt lgkmcnt(0)
    v_xor_b32 v242, v242, v28
    v_xor_b32 v244, v244, v28
    v_bitop3_b32 v242, v242, v243, v28 bitop3:0xf6
    v_bitop3_b32 v244, v244, v245, v28 bitop3:0xf6
    v_or_b32 v242, v242, v244
    v_cmp_ne_u32 s[20:21], 0, v242
    s_cmp_lt_u32 s50, 2097152
    s_cselect_b64 s[20:21], s[20:21], 0
    s_cmp_lg_u64 s[20:21], 0
    s_nop 0
    s_cbranch_scc1 o1_x
    ds_read_b64_tr_b16 v[242:243], v208 offset:0
    ds_read_b64_tr_b16 v[244:245], v208 offset:2048
    ds_read_b64_tr_b16 v[246:247], v208 offset:4096
    ds_read_b64_tr_b16 v[248:249], v208 offset:6144
    ds_read_b64_tr_b16 v[250:251], v208 offset:8192
    ds_read_b64_tr_b16 v[252:253], v208 offset:10240
    v_mfma_f32_16x16x32_bf16 v[156:159], v[176:179], v[88:91], v[156:159]
    s_waitcnt vmcnt(4)
    v_mfma_f32_16x16x32_bf16 v[136:139], v[180:183], v[92:95], v[136:139]
    v_bitop3_b32 v36, v92, v93, v36 bitop3:0x96
    v_bitop3_b32 v36, v94, v95, v36 bitop3:0x96
    s_waitcnt lgkmcnt(0)
    v_mfma_f32_16x16x32_bf16 v[140:143], v[184:187], v[92:95], v[140:143]
    v_lshlrev_b32 v218, 16, v242
    v_and_b32 v219, 0xffff0000, v242
    v_lshlrev_b32 v220, 16, v243
    v_and_b32 v221, 0xffff0000, v243
    s_waitcnt vmcnt(0)
    v_mfma_f32_16x16x32_bf16 v[144:147], v[188:191], v[92:95], v[144:147]
    v_mov_b32 v96, v100
    v_mov_b32 v97, v102
    v_mov_b32 v98, v104
    v_mov_b32 v99, v106
    v_mfma_f32_16x16x32_bf16 v[148:151], v[192:195], v[92:95], v[148:151]
    v_lshlrev_b32 v222, 16, v244
    v_and_b32 v223, 0xffff0000, v244
    v_lshlrev_b32 v224, 16, v245
    v_and_b32 v225, 0xffff0000, v245
    v_mfma_f32_16x16x32_bf16 v[152:155], v[196:199], v[92:95], v[152:155]
    v_lshlrev_b32 v226, 16, v246
    v_and_b32 v227, 0xffff0000, v246
    v_lshlrev_b32 v228, 16, v247
    v_and_b32 v229, 0xffff0000, v247
    v_mfma_f32_16x16x32_bf16 v[156:159], v[108:111], v[92:95], v[156:159]
    v_lshlrev_b32 v230, 16, v248
    v_and_b32 v231, 0xffff0000, v248
    v_lshlrev_b32 v232, 16, v249
    v_and_b32 v233, 0xffff0000, v249
    v_mfma_f32_16x16x32_bf16 v[136:139], v[112:115], v[96:99], v[136:139]
    v_lshlrev_b32 v234, 16, v250
    v_and_b32 v235, 0xffff0000, v250
    v_lshlrev_b32 v236, 16, v251
    v_and_b32 v237, 0xffff0000, v251
    v_mfma_f32_16x16x32_bf16 v[140:143], v[116:119], v[96:99], v[140:143]
    v_lshlrev_b32 v238, 16, v252
    v_and_b32 v239, 0xffff0000, v252
    v_lshlrev_b32 v240, 16, v253
    v_and_b32 v241, 0xffff0000, v253
    v_mfma_f32_16x16x32_bf16 v[144:147], v[120:123], v[96:99], v[144:147]
    v_mul_f32 v218, v218, v24
    v_mul_f32 v219, v219, v24
    v_mul_f32 v220, v220, v24
    v_mul_f32 v221, v221, v24
    v_mfma_f32_16x16x32_bf16 v[148:151], v[124:127], v[96:99], v[148:151]
    v_mul_f32 v222, v222, v24
    v_mul_f32 v223, v223, v24
    v_mul_f32 v224, v224, v24
    v_mul_f32 v225, v225, v24
    v_mfma_f32_16x16x32_bf16 v[152:155], v[128:131], v[96:99], v[152:155]
    v_mul_f32 v226, v226, v24
    v_mul_f32 v227, v227, v24
    v_mul_f32 v228, v228, v24
    v_mul_f32 v229, v229, v24
    v_mfma_f32_16x16x32_bf16 v[156:159], v[132:135], v[96:99], v[156:159]
    v_mul_f32 v230, v230, v24
    v_mul_f32 v231, v231, v24
    v_mul_f32 v232, v232, v24
    v_mul_f32 v233, v233, v24
    v_mul_f32 v234, v234, v24
    v_mul_f32 v235, v235, v24
    v_mul_f32 v236, v236, v24
    v_mul_f32 v237, v237, v24
    v_mul_f32 v238, v238, v24
    v_mul_f32 v239, v239, v24
    v_mul_f32 v240, v240, v24
    v_mul_f32 v241, v241, v24
    v_bitop3_b32 v101, v101, v100, v33 bitop3:0x96
    v_bitop3_b32 v103, v103, v102, v34 bitop3:0x96
    v_bitop3_b32 v105, v105, v104, v35 bitop3:0x96
    v_bitop3_b32 v107, v107, v106, v36 bitop3:0x96
    v_or3_b32 v25, v25, v101, v103
    v_or3_b32 v25, v25, v105, v107
    v_cmp_ne_u32 vcc, 0, v25
    s_nop 3
    s_cbranch_vccnz o1_slow
o1_ok:
    v_fmac_f32 v218, v136, v22
    v_fmac_f32 v219, v137, v22
    v_fmac_f32 v220, v138, v22
    v_fmac_f32 v221, v139, v22
    ds_write_b128 v215, v[218:221] offset:0
    v_fmac_f32 v222, v140, v22
    v_fmac_f32 v223, v141, v22
    v_fmac_f32 v224, v142, v22
    v_fmac_f32 v225, v143, v22
    ds_write_b128 v215, v[222:225] offset:1024
    v_fmac_f32 v226, v144, v22
    v_fmac_f32 v227, v145, v22
    v_fmac_f32 v228, v146, v22
    v_fmac_f32 v229, v147, v22
    ds_write_b128 v215, v[226:229] offset:2048
    v_fmac_f32 v230, v148, v22
    v_fmac_f32 v231, v149, v22
    v_fmac_f32 v232, v150, v22
    v_fmac_f32 v233, v151, v22
    ds_write_b128 v215, v[230:233] offset:3072
    v_fmac_f32 v234, v152, v22
    v_fmac_f32 v235, v153, v22
    v_fmac_f32 v236, v154, v22
    v_fmac_f32 v237, v155, v22
    ds_write_b128 v215, v[234:237] offset:4096
    v_fmac_f32 v238, v156, v22
    v_fmac_f32 v239, v157, v22
    v_fmac_f32 v240, v158, v22
    v_fmac_f32 v241, v159, v22
    ds_write_b128 v215, v[238:241] offset:5120
    s_waitcnt lgkmcnt(0)
    ds_write_b32 v39, v28 offset:16
    s_endpgm
o1_slow:
    s_add_u32 s51, s51, 1
    s_cmp_lt_u32 s51, 32768
    s_waitcnt vmcnt(0) lgkmcnt(0)
    s_cbranch_scc1 o1_redo
    s_branch o1_ok
g_l2:
    v_and_b32 v11, 15, v1
    v_lshlrev_b32 v12, 3, v11
    v_lshlrev_b32 v2, 4, v1
    s_lshl2_add_u32 s58, s55, s44
    s_lshl_b32 s58, s58, 10
    s_add_u32 s58, s58, 0x530000
    s_lshl2_add_u32 s47, s46, s44
    s_lshl_b32 s47, s47, 2
    v_lshrrev_b32 v21, 4, v1
    v_add_u32 v13, s47, v21
    s_lshl_b32 s48, s45, 13
    v_lshl_add_u32 v26, v13, 6, s48
    v_lshl_add_u32 v26, v11, 2, v26
    v_bfe_u32 v14, v13, 1, 3
    v_lshrrev_b32 v15, 1, v11
    v_xor_b32 v14, v14, v15
    v_lshlrev_b32 v13, 7, v13
    v_lshl_add_u32 v13, v14, 4, v13
    v_and_b32 v14, 1, v11
    v_lshl_add_u32 v17, v14, 3, v13
    v_add_u32 v18, 81920, v17
    s_and_b32 s56, s44, 1
    s_lshl_b32 s47, s44, 10
    v_add_u32 v24, s47, v2
    s_lshr_b32 s47, s44, 1
    s_lshl_b32 s47, s47, 10
    s_lshl3_add_u32 s47, s56, s47
    v_add_u32 v25, s47, v2
    v_mov_b32 v50, 0
    v_mov_b32 v51, 0
    v_mov_b32 v52, 0
    v_mov_b32 v53, 0
    v_subrev_u32 v64, 8, v11
    v_ashrrev_i32 v64, 1, v64
    v_and_b32 v65, 1, v11
    v_mov_b32 v66, 159792
    s_lshl_b32 s47, s56, 2
    s_cmp_ge_u32 s44, 2
    s_cbranch_scc1 g_sc1
    v_cmp_gt_u32 vcc, 8, v11
    s_nop 1
    v_cndmask_b32 v67, v64, v11, vcc
    v_cndmask_b32 v68, v65, 2, vcc
    v_mul_u32_u24 v67, 1088, v67
    v_lshl_add_u32 v67, v68, 4, v67
    v_lshl_add_u32 v67, v21, 8, v67
    s_add_u32 s47, s47, 159744
    v_add_u32 v67, s47, v67
    v_and_b32 v68, 12, v11
    v_cmp_eq_u32 vcc, 4, v68
    s_nop 1
    v_cndmask_b32 v22, v67, v66, vcc
    s_nop 0
    s_branch g_sc2
g_sc1:
    v_and_b32 v67, 1, v21
    v_lshl_add_u32 v68, v67, 1, s56
    v_lshlrev_b32 v69, 10, v68
    v_lshl_add_u32 v69, v67, 8, v69
    s_add_u32 s47, s47, 118792
    v_add_u32 v69, s47, v69
    v_lshl_add_u32 v70, v11, 4, v69
    v_lshl_add_u32 v71, v68, 6, v69
    v_add_u32 v71, 40960, v71
    v_lshl_add_u32 v72, v65, 4, v71
    v_cmp_eq_u32 vcc, v64, v68
    s_nop 1
    v_cndmask_b32 v72, v66, v72, vcc
    v_add_u32 v71, 32, v71
    v_cmp_eq_u32 vcc, 0, v11
    s_nop 1
    v_cndmask_b32 v72, v72, v71, vcc
    v_cmp_gt_u32 vcc, 32, v1
    s_nop 1
    v_cndmask_b32 v22, v72, v70, vcc
g_sc2:
    s_lshr_b32 s56, s46, 2
    s_lshl1_add_u32 s56, s45, s56
    s_and_b32 s57, s46, 3
    s_mov_b32 s12, s8
    s_and_b32 s13, s9, 0xffff
    s_mov_b32 s14, 0xa2000
    s_mov_b32 s15, 0x20000
    s_mov_b32 s48, 0x5556
    v_add_u32 v220, 0, v1
    v_lshrrev_b32 v221, 2, v220
    v_mul_u32_u24 v222, s48, v221
    v_lshrrev_b32 v222, 16, v222
    v_mul_u32_u24 v223, 12, v222
    v_sub_u32 v223, v220, v223
    v_lshrrev_b32 v224, 1, v222
    v_and_b32 v224, 2, v224
    v_xor_b32 v223, v223, v224
    v_mul_u32_u24 v222, 1152, v222
    v_lshl_add_u32 v200, v223, 4, v222
    v_add_u32 v220, 64, v1
    v_lshrrev_b32 v221, 2, v220
    v_mul_u32_u24 v222, s48, v221
    v_lshrrev_b32 v222, 16, v222
    v_mul_u32_u24 v223, 12, v222
    v_sub_u32 v223, v220, v223
    v_lshrrev_b32 v224, 1, v222
    v_and_b32 v224, 2, v224
    v_xor_b32 v223, v223, v224
    v_mul_u32_u24 v222, 1152, v222
    v_lshl_add_u32 v201, v223, 4, v222
    v_subrev_u32 v201, 1024, v201
    v_add_u32 v220, 128, v1
    v_lshrrev_b32 v221, 2, v220
    v_mul_u32_u24 v222, s48, v221
    v_lshrrev_b32 v222, 16, v222
    v_mul_u32_u24 v223, 12, v222
    v_sub_u32 v223, v220, v223
    v_lshrrev_b32 v224, 1, v222
    v_and_b32 v224, 2, v224
    v_xor_b32 v223, v223, v224
    v_mul_u32_u24 v222, 1152, v222
    v_lshl_add_u32 v202, v223, 4, v222
    v_subrev_u32 v202, 2048, v202
    s_and_b32 s48, s57, 0
    s_mul_i32 s48, s48, 18
    s_add_u32 s48, s48, s44
    s_mul_i32 s59, s48, 18432
    s_mul_i32 s48, s57, 192
    s_add_u32 s59, s59, s48
    s_mul_i32 s60, s44, 3072
    s_mov_b32 s55, 0
    s_lshl2_add_u32 s61, s56, s44
    s_mov_b32 s16, s26
    s_and_b32 s17, s27, 0xffff
    s_mov_b32 s18, 0x240000
    s_mov_b32 s19, 0x20000
    s_lshl2_add_u32 s48, s57, s44
    s_mul_i32 s69, s48, 101376
    s_lshl_b32 s49, s56, 7
    s_add_u32 s69, s69, s49
    s_add_u32 s69, s69, 0x280000
    s_mul_i32 s67, s44, 3072
    s_add_u32 s67, s67, 122880
    s_mul_i32 s62, s61, 20480
    s_lshr_b32 s68, s61, 1
    s_lshl_b32 s68, s68, 10
    s_add_u32 s68, s68, 0x4e0000
    s_mul_i32 s63, s61, 18432
    s_mul_i32 s48, s57, 192
    s_add_u32 s63, s63, s48
    s_mul_i32 s49, s55, 55296
    v_lshrrev_b32 v216, 2, v1
    v_and_b32 v217, 3, v1
    v_lshl_add_u32 v217, v217, 3, s49
    v_mul_u32_u24 v216, 192, v216
    v_add_u32 v216, v216, v217
    v_and_b32 v217, 16, v1
    v_lshl_add_u32 v203, v217, 1, v216
    v_xor_b32 v217, 16, v217
    v_lshl_add_u32 v204, v217, 1, v216
    s_add_u32 m0, s53, 40960
    s_nop 0
    buffer_load_dwordx4 v4, s[32:35], s64 offen offset:0 lds
    buffer_load_dwordx4 v5, s[32:35], s64 offen offset:1024 lds
    buffer_load_dwordx4 v6, s[32:35], s64 offen offset:2048 lds
    buffer_load_dwordx4 v7, s[32:35], s64 offen offset:3072 lds
    s_add_u32 s48, s65, 1152
    s_add_u32 m0, s54, 57344
    s_add_u32 s47, s65, 2304
    buffer_load_dwordx4 v8, s[36:39], s48 offen offset:0 lds
    buffer_load_dwordx4 v9, s[36:39], s48 offen offset:1024 lds
    buffer_load_dwordx4 v10, s[36:39], s48 offen offset:2048 lds
    s_add_u32 m0, s54, 69632
    s_nop 0
    buffer_load_dwordx4 v8, s[36:39], s47 offen offset:0 lds
    buffer_load_dwordx4 v9, s[36:39], s47 offen offset:1024 lds
    buffer_load_dwordx4 v10, s[36:39], s47 offen offset:2048 lds
    s_add_u32 s64, s51, 256
    s_add_u32 s65, s52, 442368
    s_mov_b32 s40, s30
    s_and_b32 s41, s31, 0xffff
    s_mov_b32 s42, 0x6e0000
    s_mov_b32 s43, 0x20000
    v_mov_b32 v30, 0
    s_waitcnt vmcnt(10)
    s_barrier
    s_add_u32 m0, s53, 81920
    s_nop 0
    buffer_load_dwordx4 v4, s[32:35], s64 offen offset:0 lds
    buffer_load_dwordx4 v5, s[32:35], s64 offen offset:1024 lds
    buffer_load_dwordx4 v6, s[32:35], s64 offen offset:2048 lds
    buffer_load_dwordx4 v7, s[32:35], s64 offen offset:3072 lds
    s_add_u32 s48, s65, 1152
    s_add_u32 m0, s54, 98304
    s_add_u32 s47, s65, 2304
    buffer_load_dwordx4 v8, s[36:39], s48 offen offset:0 lds
    buffer_load_dwordx4 v9, s[36:39], s48 offen offset:1024 lds
    buffer_load_dwordx4 v10, s[36:39], s48 offen offset:2048 lds
    global_load_dwordx2 v[32:33], v12, s[24:25] offset:0
    global_load_dwordx2 v[34:35], v12, s[24:25] offset:128
    s_add_u32 m0, s54, 110592
    s_nop 0
    buffer_load_dwordx4 v8, s[36:39], s47 offen offset:0 lds
    buffer_load_dwordx4 v9, s[36:39], s47 offen offset:1024 lds
    buffer_load_dwordx4 v10, s[36:39], s47 offen offset:2048 lds
    s_add_u32 s64, s51, 384
    s_add_u32 s65, s52, 663552
    s_waitcnt vmcnt(12)
    s_barrier
    ds_read_b64 v[80:81], v17 offset:0
    s_add_u32 m0, s53, 122880
    s_nop 0
    buffer_load_dwordx4 v4, s[32:35], s64 offen offset:0 lds
    buffer_load_dwordx4 v5, s[32:35], s64 offen offset:1024 lds
    buffer_load_dwordx4 v6, s[32:35], s64 offen offset:2048 lds
    buffer_load_dwordx4 v7, s[32:35], s64 offen offset:3072 lds
    s_add_u32 s48, s65, 1152
    s_add_u32 m0, s54, 139264
    s_add_u32 s47, s65, 2304
    buffer_load_dwordx4 v8, s[36:39], s48 offen offset:0 lds
    buffer_load_dwordx4 v9, s[36:39], s48 offen offset:1024 lds
    buffer_load_dwordx4 v10, s[36:39], s48 offen offset:2048 lds
    global_load_dwordx2 v[36:37], v12, s[24:25] offset:256
    global_load_dwordx2 v[38:39], v12, s[24:25] offset:384
    s_add_u32 m0, s54, 151552
    s_nop 0
    buffer_load_dwordx4 v8, s[36:39], s47 offen offset:0 lds
    buffer_load_dwordx4 v9, s[36:39], s47 offen offset:1024 lds
    buffer_load_dwordx4 v10, s[36:39], s47 offen offset:2048 lds
    s_add_u32 s64, s51, 512
    s_add_u32 s65, s52, 884736
    s_waitcnt vmcnt(12)
    s_barrier
    ds_read_b64 v[82:83], v17 offset:40960
    s_add_u32 m0, s53, 0
    s_nop 0
    buffer_load_dwordx4 v4, s[32:35], s64 offen offset:0 lds
    buffer_load_dwordx4 v5, s[32:35], s64 offen offset:1024 lds
    buffer_load_dwordx4 v6, s[32:35], s64 offen offset:2048 lds
    buffer_load_dwordx4 v7, s[32:35], s64 offen offset:3072 lds
    s_add_u32 s48, s65, 1152
    s_add_u32 m0, s54, 16384
    s_add_u32 s47, s65, 2304
    buffer_load_dwordx4 v8, s[36:39], s48 offen offset:0 lds
    buffer_load_dwordx4 v9, s[36:39], s48 offen offset:1024 lds
    buffer_load_dwordx4 v10, s[36:39], s48 offen offset:2048 lds
    global_load_dwordx2 v[40:41], v12, s[24:25] offset:512
    global_load_dwordx2 v[42:43], v12, s[24:25] offset:640
    s_waitcnt lgkmcnt(0)
    v_lshlrev_b32 v58, 16, v80
    v_and_b32 v59, 0xffff0000, v80
    v_lshlrev_b32 v60, 16, v32
    v_and_b32 v61, 0xffff0000, v32
    v_lshlrev_b32 v62, 16, v81
    v_and_b32 v63, 0xffff0000, v81
    v_lshlrev_b32 v64, 16, v33
    v_and_b32 v65, 0xffff0000, v33
    v_mul_f32 v58, v58, v60
    v_mul_f32 v59, v59, v61
    v_mul_f32 v62, v62, v64
    v_mul_f32 v63, v63, v65
    v_cvt_pk_bf16_f32 v60, v58, v59
    v_cvt_pk_bf16_f32 v64, v62, v63
    v_lshlrev_b32 v58, 16, v60
    v_and_b32 v59, 0xffff0000, v60
    v_lshlrev_b32 v62, 16, v64
    v_and_b32 v63, 0xffff0000, v64
    v_add_f32 v50, v50, v58
    v_add_f32 v51, v51, v59
    v_add_f32 v52, v52, v62
    v_add_f32 v53, v53, v63
    v_lshlrev_b32 v58, 16, v82
    v_and_b32 v59, 0xffff0000, v82
    v_lshlrev_b32 v60, 16, v34
    v_and_b32 v61, 0xffff0000, v34
    v_lshlrev_b32 v62, 16, v83
    v_and_b32 v63, 0xffff0000, v83
    v_lshlrev_b32 v64, 16, v35
    v_and_b32 v65, 0xffff0000, v35
    v_mul_f32 v58, v58, v60
    v_mul_f32 v59, v59, v61
    v_mul_f32 v62, v62, v64
    v_mul_f32 v63, v63, v65
    v_cvt_pk_bf16_f32 v60, v58, v59
    v_cvt_pk_bf16_f32 v64, v62, v63
    v_lshlrev_b32 v58, 16, v60
    v_and_b32 v59, 0xffff0000, v60
    v_lshlrev_b32 v62, 16, v64
    v_and_b32 v63, 0xffff0000, v64
    v_add_f32 v50, v50, v58
    v_add_f32 v51, v51, v59
    v_add_f32 v52, v52, v62
    v_add_f32 v53, v53, v63
    s_add_u32 m0, s54, 28672
    s_nop 0
    buffer_load_dwordx4 v8, s[36:39], s47 offen offset:0 lds
    buffer_load_dwordx4 v9, s[36:39], s47 offen offset:1024 lds
    buffer_load_dwordx4 v10, s[36:39], s47 offen offset:2048 lds
    s_add_u32 s64, s51, 640
    s_add_u32 s65, s52, 1105920
    s_waitcnt vmcnt(12)
    s_barrier
    ds_read_b64 v[54:55], v18 offset:0
    s_add_u32 m0, s53, 40960
    s_nop 0
    buffer_load_dwordx4 v4, s[32:35], s64 offen offset:0 lds
    buffer_load_dwordx4 v5, s[32:35], s64 offen offset:1024 lds
    buffer_load_dwordx4 v6, s[32:35], s64 offen offset:2048 lds
    buffer_load_dwordx4 v7, s[32:35], s64 offen offset:3072 lds
    s_add_u32 s48, s65, 1152
    s_add_u32 m0, s54, 57344
    s_add_u32 s47, s65, 2304
    buffer_load_dwordx4 v8, s[36:39], s48 offen offset:0 lds
    buffer_load_dwordx4 v9, s[36:39], s48 offen offset:1024 lds
    buffer_load_dwordx4 v10, s[36:39], s48 offen offset:2048 lds
    global_load_dwordx2 v[44:45], v12, s[24:25] offset:768
    global_load_dwordx2 v[46:47], v12, s[24:25] offset:896
    s_waitcnt lgkmcnt(0)
    v_lshlrev_b32 v58, 16, v54
    v_and_b32 v59, 0xffff0000, v54
    v_lshlrev_b32 v60, 16, v36
    v_and_b32 v61, 0xffff0000, v36
    v_lshlrev_b32 v62, 16, v55
    v_and_b32 v63, 0xffff0000, v55
    v_lshlrev_b32 v64, 16, v37
    v_and_b32 v65, 0xffff0000, v37
    v_mul_f32 v58, v58, v60
    v_mul_f32 v59, v59, v61
    v_mul_f32 v62, v62, v64
    v_mul_f32 v63, v63, v65
    v_cvt_pk_bf16_f32 v60, v58, v59
    v_cvt_pk_bf16_f32 v64, v62, v63
    v_lshlrev_b32 v58, 16, v60
    v_and_b32 v59, 0xffff0000, v60
    v_lshlrev_b32 v62, 16, v64
    v_and_b32 v63, 0xffff0000, v64
    v_add_f32 v50, v50, v58
    v_add_f32 v51, v51, v59
    v_add_f32 v52, v52, v62
    v_add_f32 v53, v53, v63
    s_add_u32 m0, s54, 69632
    s_nop 0
    buffer_load_dwordx4 v8, s[36:39], s47 offen offset:0 lds
    buffer_load_dwordx4 v9, s[36:39], s47 offen offset:1024 lds
    buffer_load_dwordx4 v10, s[36:39], s47 offen offset:2048 lds
    s_add_u32 s64, s51, 768
    s_add_u32 s65, s52, 1327104
    s_waitcnt vmcnt(12)
    s_barrier
    ds_read_b64 v[56:57], v18 offset:40960
    s_add_u32 m0, s53, 81920
    s_nop 0
    buffer_load_dwordx4 v4, s[32:35], s64 offen offset:0 lds
    buffer_load_dwordx4 v5, s[32:35], s64 offen offset:1024 lds
    buffer_load_dwordx4 v6, s[32:35], s64 offen offset:2048 lds
    buffer_load_dwordx4 v7, s[32:35], s64 offen offset:3072 lds
    s_add_u32 s48, s65, 1152
    s_add_u32 m0, s54, 98304
    s_add_u32 s47, s65, 2304
    buffer_load_dwordx4 v8, s[36:39], s48 offen offset:0 lds
    buffer_load_dwordx4 v9, s[36:39], s48 offen offset:1024 lds
    buffer_load_dwordx4 v10, s[36:39], s48 offen offset:2048 lds
    global_load_dwordx2 v[48:49], v12, s[24:25] offset:1024
    s_waitcnt lgkmcnt(0)
    v_lshlrev_b32 v58, 16, v56
    v_and_b32 v59, 0xffff0000, v56
    v_lshlrev_b32 v60, 16, v38
    v_and_b32 v61, 0xffff0000, v38
    v_lshlrev_b32 v62, 16, v57
    v_and_b32 v63, 0xffff0000, v57
    v_lshlrev_b32 v64, 16, v39
    v_and_b32 v65, 0xffff0000, v39
    v_mul_f32 v58, v58, v60
    v_mul_f32 v59, v59, v61
    v_mul_f32 v62, v62, v64
    v_mul_f32 v63, v63, v65
    v_cvt_pk_bf16_f32 v60, v58, v59
    v_cvt_pk_bf16_f32 v64, v62, v63
    v_lshlrev_b32 v58, 16, v60
    v_and_b32 v59, 0xffff0000, v60
    v_lshlrev_b32 v62, 16, v64
    v_and_b32 v63, 0xffff0000, v64
    v_add_f32 v50, v50, v58
    v_add_f32 v51, v51, v59
    v_add_f32 v52, v52, v62
    v_add_f32 v53, v53, v63
    s_add_u32 m0, s54, 110592
    s_nop 0
    buffer_load_dwordx4 v8, s[36:39], s47 offen offset:0 lds
    buffer_load_dwordx4 v9, s[36:39], s47 offen offset:1024 lds
    buffer_load_dwordx4 v10, s[36:39], s47 offen offset:2048 lds
    s_add_u32 s64, s51, 896
    s_add_u32 s65, s52, 1548288
    s_waitcnt vmcnt(11)
    s_barrier
    ds_read_b64 v[54:55], v17 offset:0
    s_add_u32 m0, s53, 122880
    s_nop 0
    buffer_load_dwordx4 v4, s[32:35], s64 offen offset:0 lds
    buffer_load_dwordx4 v5, s[32:35], s64 offen offset:1024 lds
    buffer_load_dwordx4 v6, s[32:35], s64 offen offset:2048 lds
    buffer_load_dwordx4 v7, s[32:35], s64 offen offset:3072 lds
    s_add_u32 s48, s65, 1152
    s_add_u32 m0, s54, 139264
    s_add_u32 s47, s65, 2304
    buffer_load_dwordx4 v8, s[36:39], s48 offen offset:0 lds
    buffer_load_dwordx4 v9, s[36:39], s48 offen offset:1024 lds
    buffer_load_dwordx4 v10, s[36:39], s48 offen offset:2048 lds
    global_load_dword v28, v30, s[28:29] sc1
    s_waitcnt lgkmcnt(0)
    v_lshlrev_b32 v58, 16, v54
    v_and_b32 v59, 0xffff0000, v54
    v_lshlrev_b32 v60, 16, v40
    v_and_b32 v61, 0xffff0000, v40
    v_lshlrev_b32 v62, 16, v55
    v_and_b32 v63, 0xffff0000, v55
    v_lshlrev_b32 v64, 16, v41
    v_and_b32 v65, 0xffff0000, v41
    v_mul_f32 v58, v58, v60
    v_mul_f32 v59, v59, v61
    v_mul_f32 v62, v62, v64
    v_mul_f32 v63, v63, v65
    v_cvt_pk_bf16_f32 v60, v58, v59
    v_cvt_pk_bf16_f32 v64, v62, v63
    v_lshlrev_b32 v58, 16, v60
    v_and_b32 v59, 0xffff0000, v60
    v_lshlrev_b32 v62, 16, v64
    v_and_b32 v63, 0xffff0000, v64
    v_add_f32 v50, v50, v58
    v_add_f32 v51, v51, v59
    v_add_f32 v52, v52, v62
    v_add_f32 v53, v53, v63
    s_add_u32 m0, s54, 151552
    s_nop 0
    buffer_load_dwordx4 v8, s[36:39], s47 offen offset:0 lds
    buffer_load_dwordx4 v9, s[36:39], s47 offen offset:1024 lds
    buffer_load_dwordx4 v10, s[36:39], s47 offen offset:2048 lds
    s_add_u32 s64, s51, 1024
    s_add_u32 s65, s52, 1769472
    s_waitcnt vmcnt(11)
    s_barrier
    ds_read_b64 v[56:57], v17 offset:40960
    s_add_u32 m0, s53, 0
    s_nop 0
    buffer_load_dwordx4 v4, s[32:35], s64 offen offset:0 lds
    buffer_load_dwordx4 v5, s[32:35], s64 offen offset:1024 lds
    buffer_load_dwordx4 v6, s[32:35], s64 offen offset:2048 lds
    buffer_load_dwordx4 v7, s[32:35], s64 offen offset:3072 lds
    s_add_u32 s48, s65, 1152
    s_add_u32 m0, s54, 16384
    s_add_u32 s47, s65, 2304
    buffer_load_dwordx4 v8, s[36:39], s48 offen offset:0 lds
    buffer_load_dwordx4 v9, s[36:39], s48 offen offset:1024 lds
    buffer_load_dwordx4 v10, s[36:39], s48 offen offset:2048 lds
    s_waitcnt lgkmcnt(0)
    v_lshlrev_b32 v58, 16, v56
    v_and_b32 v59, 0xffff0000, v56
    v_lshlrev_b32 v60, 16, v42
    v_and_b32 v61, 0xffff0000, v42
    v_lshlrev_b32 v62, 16, v57
    v_and_b32 v63, 0xffff0000, v57
    v_lshlrev_b32 v64, 16, v43
    v_and_b32 v65, 0xffff0000, v43
    v_mul_f32 v58, v58, v60
    v_mul_f32 v59, v59, v61
    v_mul_f32 v62, v62, v64
    v_mul_f32 v63, v63, v65
    v_cvt_pk_bf16_f32 v60, v58, v59
    v_cvt_pk_bf16_f32 v64, v62, v63
    v_lshlrev_b32 v58, 16, v60
    v_and_b32 v59, 0xffff0000, v60
    v_lshlrev_b32 v62, 16, v64
    v_and_b32 v63, 0xffff0000, v64
    v_add_f32 v50, v50, v58
    v_add_f32 v51, v51, v59
    v_add_f32 v52, v52, v62
    v_add_f32 v53, v53, v63
    s_add_u32 m0, s54, 28672
    s_nop 0
    buffer_load_dwordx4 v8, s[36:39], s47 offen offset:0 lds
    buffer_load_dwordx4 v9, s[36:39], s47 offen offset:1024 lds
    buffer_load_dwordx4 v10, s[36:39], s47 offen offset:2048 lds
    s_add_u32 s65, s52, 0
    s_waitcnt vmcnt(10)
    s_barrier
    ds_read_b64 v[54:55], v18 offset:0
    s_add_u32 m0, s54, 40960
    s_nop 0
    buffer_load_dwordx4 v8, s[36:39], s65 offen offset:0 lds
    buffer_load_dwordx4 v9, s[36:39], s65 offen offset:1024 lds
    buffer_load_dwordx4 v10, s[36:39], s65 offen offset:2048 lds
    s_add_u32 s65, s52, 221184
    s_waitcnt lgkmcnt(0)
    v_lshlrev_b32 v58, 16, v54
    v_and_b32 v59, 0xffff0000, v54
    v_lshlrev_b32 v60, 16, v44
    v_and_b32 v61, 0xffff0000, v44
    v_lshlrev_b32 v62, 16, v55
    v_and_b32 v63, 0xffff0000, v55
    v_lshlrev_b32 v64, 16, v45
    v_and_b32 v65, 0xffff0000, v45
    v_mul_f32 v58, v58, v60
    v_mul_f32 v59, v59, v61
    v_mul_f32 v62, v62, v64
    v_mul_f32 v63, v63, v65
    v_cvt_pk_bf16_f32 v60, v58, v59
    v_cvt_pk_bf16_f32 v64, v62, v63
    v_lshlrev_b32 v58, 16, v60
    v_and_b32 v59, 0xffff0000, v60
    v_lshlrev_b32 v62, 16, v64
    v_and_b32 v63, 0xffff0000, v64
    v_add_f32 v50, v50, v58
    v_add_f32 v51, v51, v59
    v_add_f32 v52, v52, v62
    v_add_f32 v53, v53, v63
    s_add_u32 m0, s54, 53248
    s_nop 0
    buffer_load_dwordx4 v8, s[36:39], s65 offen offset:0 lds
    buffer_load_dwordx4 v9, s[36:39], s65 offen offset:1024 lds
    buffer_load_dwordx4 v10, s[36:39], s65 offen offset:2048 lds
    s_add_u32 s65, s52, 442368
    s_add_u32 m0, s54, 65536
    s_nop 0
    buffer_load_dwordx4 v8, s[36:39], s65 offen offset:0 lds
    buffer_load_dwordx4 v9, s[36:39], s65 offen offset:1024 lds
    buffer_load_dwordx4 v10, s[36:39], s65 offen offset:2048 lds
    s_add_u32 s65, s52, 663552
    s_waitcnt vmcnt(9)
    s_barrier
    ds_read_b64 v[56:57], v18 offset:40960
    ds_read_b64 v[54:55], v17 offset:0
    s_add_u32 m0, s54, 81920
    s_nop 0
    buffer_load_dwordx4 v8, s[36:39], s65 offen offset:0 lds
    buffer_load_dwordx4 v9, s[36:39], s65 offen offset:1024 lds
    buffer_load_dwordx4 v10, s[36:39], s65 offen offset:2048 lds
    s_add_u32 s65, s52, 884736
    s_waitcnt lgkmcnt(0)
    v_lshlrev_b32 v58, 16, v56
    v_and_b32 v59, 0xffff0000, v56
    v_lshlrev_b32 v60, 16, v46
    v_and_b32 v61, 0xffff0000, v46
    v_lshlrev_b32 v62, 16, v57
    v_and_b32 v63, 0xffff0000, v57
    v_lshlrev_b32 v64, 16, v47
    v_and_b32 v65, 0xffff0000, v47
    v_mul_f32 v58, v58, v60
    v_mul_f32 v59, v59, v61
    v_mul_f32 v62, v62, v64
    v_mul_f32 v63, v63, v65
    v_cvt_pk_bf16_f32 v60, v58, v59
    v_cvt_pk_bf16_f32 v64, v62, v63
    v_lshlrev_b32 v58, 16, v60
    v_and_b32 v59, 0xffff0000, v60
    v_lshlrev_b32 v62, 16, v64
    v_and_b32 v63, 0xffff0000, v64
    v_add_f32 v50, v50, v58
    v_add_f32 v51, v51, v59
    v_add_f32 v52, v52, v62
    v_add_f32 v53, v53, v63
    v_lshlrev_b32 v58, 16, v54
    v_and_b32 v59, 0xffff0000, v54
    v_lshlrev_b32 v60, 16, v48
    v_and_b32 v61, 0xffff0000, v48
    v_lshlrev_b32 v62, 16, v55
    v_and_b32 v63, 0xffff0000, v55
    v_lshlrev_b32 v64, 16, v49
    v_and_b32 v65, 0xffff0000, v49
    v_mul_f32 v58, v58, v60
    v_mul_f32 v59, v59, v61
    v_mul_f32 v62, v62, v64
    v_mul_f32 v63, v63, v65
    v_cvt_pk_bf16_f32 v60, v58, v59
    v_cvt_pk_bf16_f32 v64, v62, v63
    v_lshlrev_b32 v58, 16, v60
    v_and_b32 v59, 0xffff0000, v60
    v_lshlrev_b32 v62, 16, v64
    v_and_b32 v63, 0xffff0000, v64
    v_add_f32 v50, v50, v58
    v_add_f32 v51, v51, v59
    v_add_f32 v52, v52, v62
    v_add_f32 v53, v53, v63
    s_add_u32 m0, s54, 94208
    s_nop 0
    buffer_load_dwordx4 v8, s[36:39], s65 offen offset:0 lds
    buffer_load_dwordx4 v9, s[36:39], s65 offen offset:1024 lds
    buffer_load_dwordx4 v10, s[36:39], s65 offen offset:2048 lds
    s_add_u32 s65, s52, 1105920
    s_add_u32 m0, s54, 106496
    s_nop 0
    buffer_load_dwordx4 v8, s[36:39], s65 offen offset:0 lds
    buffer_load_dwordx4 v9, s[36:39], s65 offen offset:1024 lds
    buffer_load_dwordx4 v10, s[36:39], s65 offen offset:2048 lds
    s_add_u32 s65, s52, 1327104
    s_barrier
    s_add_u32 m0, s54, 122880
    s_nop 0
    buffer_load_dwordx4 v8, s[36:39], s65 offen offset:0 lds
    buffer_load_dwordx4 v9, s[36:39], s65 offen offset:1024 lds
    buffer_load_dwordx4 v10, s[36:39], s65 offen offset:2048 lds
    s_add_u32 s65, s52, 1548288
    s_add_u32 m0, s54, 135168
    s_nop 0
    buffer_load_dwordx4 v8, s[36:39], s65 offen offset:0 lds
    buffer_load_dwordx4 v9, s[36:39], s65 offen offset:1024 lds
    buffer_load_dwordx4 v10, s[36:39], s65 offen offset:2048 lds
    s_add_u32 s65, s52, 1769472
    s_add_u32 m0, s54, 147456
    s_nop 0
    buffer_load_dwordx4 v8, s[36:39], s65 offen offset:0 lds
    buffer_load_dwordx4 v9, s[36:39], s65 offen offset:1024 lds
    buffer_load_dwordx4 v10, s[36:39], s65 offen offset:2048 lds
    s_add_u32 m0, s60, 24576
    s_add_u32 s49, s59, 147456
    buffer_load_dwordx4 v200, s[12:15], s49 offen offset:0 lds
    buffer_load_dwordx4 v201, s[12:15], s49 offen offset:1024 lds
    buffer_load_dwordx4 v202, s[12:15], s49 offen offset:2048 lds
    v_mov_b32 v12, 0
    v_mov_b32 v13, 0
    v_mov_b32 v14, 0
    v_mov_b32 v15, 0
    v_add_u32 v27, 118784, v24
    ds_write_b128 v27, v[12:15]
    ds_write_b128 v27, v[12:15] offset:40960
    s_mov_b32 s50, 0
g_fl:
    v_cmp_eq_u32 vcc, 0, v28
    s_nop 3
    s_cbranch_vccz g_flok
    global_load_dword v28, v30, s[28:29] sc1
    s_add_u32 s50, s50, 1
    s_cmp_lt_u32 s50, 32768
    s_waitcnt vmcnt(0)
    s_cbranch_scc1 g_fl
g_flok:
    v_lshlrev_b32 v18, 3, v1
    s_mov_b32 s20, 0x807fffff
    v_alignbit_b32 v20, v28, v28, v18
    v_and_b32 v20, s20, v20
    v_mov_b32 v18, 159856
    s_mov_b32 s21, 0x7800000
    s_waitcnt vmcnt(3) lgkmcnt(0)
    s_barrier
    ds_read_b128 v[64:67], v24 offset:0
    ds_read_b64 v[68:69], v25 offset:4096
    ds_read_b128 v[70:73], v24 offset:6144
    ds_read_b64 v[74:75], v25 offset:10240
    ds_read_b128 v[76:79], v24 offset:12288
    ds_read_b64 v[80:81], v25 offset:16384
    ds_read_b128 v[82:85], v24 offset:18432
    ds_read_b64 v[86:87], v25 offset:22528
    s_waitcnt lgkmcnt(4)
    v_add_f32 v64, v64, v70
    v_add_f32 v65, v65, v71
    v_add_f32 v66, v66, v72
    v_add_f32 v67, v67, v73
    v_add_f32 v68, v68, v74
    v_add_f32 v69, v69, v75
    s_waitcnt lgkmcnt(0)
    v_add_f32 v76, v76, v82
    v_add_f32 v77, v77, v83
    v_add_f32 v78, v78, v84
    v_add_f32 v79, v79, v85
    v_add_f32 v80, v80, v86
    v_add_f32 v81, v81, v87
    v_add_f32 v64, v64, v76
    v_add_f32 v65, v65, v77
    v_add_f32 v66, v66, v78
    v_add_f32 v67, v67, v79
    v_add_f32 v68, v68, v80
    v_add_f32 v69, v69, v81
    v_max3_f32 v70, |v64|, |v65|, |v66|
    v_max3_f32 v71, |v67|, |v68|, |v69|
    v_max3_f32 v70, v70, v71, s21
    v_and_b32 v70, 0x7f800000, v70
    v_sub_u32 v71, 0x86000000, v70
    v_subrev_u32 v70, 0x7000000, v70
    v_fma_mixlo_f16 v72, v64, v71, 0
    v_fma_mixlo_f16 v73, v66, v71, 0
    v_fma_mixlo_f16 v74, v68, v71, 0
    v_xor_b32 v75, v70, v20
    v_fma_mixhi_f16 v72, v65, v71, 0
    v_fma_mixhi_f16 v73, v67, v71, 0
    v_fma_mixhi_f16 v74, v69, v71, 0
    buffer_store_dwordx4 v[72:75], v2, s[40:43], s58 offen sc1
    ds_write_b32 v18, v28
    s_barrier
    s_lshl4_add_u32 s47, s46, 0
    s_lshl2_add_u32 s47, s47, s44
    s_lshl_b32 s47, s47, 10
    s_add_u32 s47, s47, 0x530000
    v_add_u32 v31, 4096, v2
    s_add_u32 m0, s60, 0
    s_add_u32 s49, s59, 0
    buffer_load_dwordx4 v200, s[12:15], s49 offen offset:0 lds
    buffer_load_dwordx4 v201, s[12:15], s49 offen offset:1024 lds
    buffer_load_dwordx4 v202, s[12:15], s49 offen offset:2048 lds
    s_add_u32 m0, s60, 12288
    s_add_u32 s49, s59, 73728
    buffer_load_dwordx4 v200, s[12:15], s49 offen offset:0 lds
    buffer_load_dwordx4 v201, s[12:15], s49 offen offset:1024 lds
    buffer_load_dwordx4 v202, s[12:15], s49 offen offset:2048 lds
    v_add_f32 v50, v50, v52
    v_add_f32 v51, v51, v53
    v_add_f32 v50, v50, v51
    s_nop 1
    v_add_f32_dpp v50, v50, v50 row_ror:1 row_mask:0xf bank_mask:0xf
    s_nop 1
    v_add_f32_dpp v50, v50, v50 row_ror:2 row_mask:0xf bank_mask:0xf
    s_nop 1
    v_add_f32_dpp v50, v50, v50 row_ror:4 row_mask:0xf bank_mask:0xf
    s_nop 1
    v_add_f32_dpp v50, v50, v50 row_ror:8 row_mask:0xf bank_mask:0xf
    v_cvt_pk_bf16_f32 v50, v50, v50
    v_lshlrev_b32 v50, 16, v50
    v_mul_f32 v50, 0xbfb8aa3b, v50
    v_exp_f32 v50, v50
    s_nop 0
    v_add_f32 v50, 1.0, v50
    v_rcp_f32 v50, v50
    s_nop 0
    v_cvt_pk_bf16_f32 v50, v50, v50
    v_lshlrev_b32 v50, 16, v50
    s_mov_b32 s48, 0x4f0000
    s_mov_b32 vcc_lo, 0xaaaaaaaa
    s_mov_b32 vcc_hi, 0xaaaaaaaa
    v_cndmask_b32 v50, v50, v28, vcc
    buffer_store_dword v50, v26, s[40:43], s48 offen sc1
    s_add_u32 s48, s47, 0
    buffer_load_dwordx4 v[96:99], v2, s[40:43], s48 offen sc1
    buffer_load_dwordx4 v[100:103], v31, s[40:43], s48 offen sc1
    s_add_u32 s48, s47, 8192
    buffer_load_dwordx4 v[104:107], v2, s[40:43], s48 offen sc1
    buffer_load_dwordx4 v[108:111], v31, s[40:43], s48 offen sc1
    s_add_u32 s48, s47, 16384
    buffer_load_dwordx4 v[112:115], v2, s[40:43], s48 offen sc1
    buffer_load_dwordx4 v[116:119], v31, s[40:43], s48 offen sc1
    s_add_u32 s48, s47, 24576
    buffer_load_dwordx4 v[120:123], v2, s[40:43], s48 offen sc1
    buffer_load_dwordx4 v[124:127], v31, s[40:43], s48 offen sc1
    s_add_u32 s48, s47, 32768
    buffer_load_dwordx4 v[128:131], v2, s[40:43], s48 offen sc1
    buffer_load_dwordx4 v[132:135], v31, s[40:43], s48 offen sc1
    s_barrier
    s_mov_b32 s50, 0
    s_mov_b32 s64, 5
    s_waitcnt vmcnt(8)
    s_add_u32 s48, s47, 40960
    buffer_load_dwordx4 v[136:139], v2, s[40:43], s48 offen sc1
    buffer_load_dwordx4 v[140:143], v31, s[40:43], s48 offen sc1
    s_mov_b32 s64, 6
g_ok0:
    v_xor_b32 v64, v20, v99
    v_xor_b32 v65, v20, v103
    v_bitop3_b32 v66, v64, v65, s20 bitop3:0xa8
    v_cmp_ne_u32 vcc, 0, v66
    s_mov_b32 s66, 0
    s_nop 2
    s_cbranch_vccnz g_slow
g_go0:
    v_fma_mix_f32 v88, v96, v64, 0 op_sel:[0,0,0] op_sel_hi:[1,0,0]
    v_fma_mix_f32 v89, v96, v64, 0 op_sel:[1,0,0] op_sel_hi:[1,0,0]
    v_fma_mix_f32 v90, v97, v64, 0 op_sel:[0,0,0] op_sel_hi:[1,0,0]
    v_fma_mix_f32 v91, v97, v64, 0 op_sel:[1,0,0] op_sel_hi:[1,0,0]
    v_fma_mix_f32 v92, v98, v64, 0 op_sel:[0,0,0] op_sel_hi:[1,0,0]
    v_fma_mix_f32 v93, v98, v64, 0 op_sel:[1,0,0] op_sel_hi:[1,0,0]
    v_fma_mix_f32 v88, v100, v65, v88 op_sel:[0,0,0] op_sel_hi:[1,0,0]
    v_fma_mix_f32 v89, v100, v65, v89 op_sel:[1,0,0] op_sel_hi:[1,0,0]
    v_fma_mix_f32 v90, v101, v65, v90 op_sel:[0,0,0] op_sel_hi:[1,0,0]
    v_fma_mix_f32 v91, v101, v65, v91 op_sel:[1,0,0] op_sel_hi:[1,0,0]
    v_fma_mix_f32 v92, v102, v65, v92 op_sel:[0,0,0] op_sel_hi:[1,0,0]
    v_fma_mix_f32 v93, v102, v65, v93 op_sel:[1,0,0] op_sel_hi:[1,0,0]
    s_waitcnt vmcnt(8)
    s_add_u32 s48, s47, 49152
    buffer_load_dwordx4 v[144:147], v2, s[40:43], s48 offen sc1
    buffer_load_dwordx4 v[148:151], v31, s[40:43], s48 offen sc1
    s_mov_b32 s64, 7
g_ok1:
    v_xor_b32 v64, v20, v107
    v_xor_b32 v65, v20, v111
    v_bitop3_b32 v66, v64, v65, s20 bitop3:0xa8
    v_cmp_ne_u32 vcc, 0, v66
    s_mov_b32 s66, 1
    s_nop 2
    s_cbranch_vccnz g_slow
g_go1:
    v_fma_mix_f32 v88, v104, v64, v88 op_sel:[0,0,0] op_sel_hi:[1,0,0]
    v_fma_mix_f32 v89, v104, v64, v89 op_sel:[1,0,0] op_sel_hi:[1,0,0]
    v_fma_mix_f32 v90, v105, v64, v90 op_sel:[0,0,0] op_sel_hi:[1,0,0]
    v_fma_mix_f32 v91, v105, v64, v91 op_sel:[1,0,0] op_sel_hi:[1,0,0]
    v_fma_mix_f32 v92, v106, v64, v92 op_sel:[0,0,0] op_sel_hi:[1,0,0]
    v_fma_mix_f32 v93, v106, v64, v93 op_sel:[1,0,0] op_sel_hi:[1,0,0]
    v_fma_mix_f32 v88, v108, v65, v88 op_sel:[0,0,0] op_sel_hi:[1,0,0]
    v_fma_mix_f32 v89, v108, v65, v89 op_sel:[1,0,0] op_sel_hi:[1,0,0]
    v_fma_mix_f32 v90, v109, v65, v90 op_sel:[0,0,0] op_sel_hi:[1,0,0]
    v_fma_mix_f32 v91, v109, v65, v91 op_sel:[1,0,0] op_sel_hi:[1,0,0]
    v_fma_mix_f32 v92, v110, v65, v92 op_sel:[0,0,0] op_sel_hi:[1,0,0]
    v_fma_mix_f32 v93, v110, v65, v93 op_sel:[1,0,0] op_sel_hi:[1,0,0]
    s_waitcnt vmcnt(8)
    s_add_u32 s48, s47, 57344
    buffer_load_dwordx4 v[152:155], v2, s[40:43], s48 offen sc1
    buffer_load_dwordx4 v[156:159], v31, s[40:43], s48 offen sc1
    s_mov_b32 s64, 8
g_ok2:
    v_xor_b32 v64, v20, v115
    v_xor_b32 v65, v20, v119
    v_bitop3_b32 v66, v64, v65, s20 bitop3:0xa8
    v_cmp_ne_u32 vcc, 0, v66
    s_mov_b32 s66, 2
    s_nop 2
    s_cbranch_vccnz g_slow
g_go2:
    v_fma_mix_f32 v88, v112, v64, v88 op_sel:[0,0,0] op_sel_hi:[1,0,0]
    v_fma_mix_f32 v89, v112, v64, v89 op_sel:[1,0,0] op_sel_hi:[1,0,0]
    v_fma_mix_f32 v90, v113, v64, v90 op_sel:[0,0,0] op_sel_hi:[1,0,0]
    v_fma_mix_f32 v91, v113, v64, v91 op_sel:[1,0,0] op_sel_hi:[1,0,0]
    v_fma_mix_f32 v92, v114, v64, v92 op_sel:[0,0,0] op_sel_hi:[1,0,0]
    v_fma_mix_f32 v93, v114, v64, v93 op_sel:[1,0,0] op_sel_hi:[1,0,0]
    v_fma_mix_f32 v88, v116, v65, v88 op_sel:[0,0,0] op_sel_hi:[1,0,0]
    v_fma_mix_f32 v89, v116, v65, v89 op_sel:[1,0,0] op_sel_hi:[1,0,0]
    v_fma_mix_f32 v90, v117, v65, v90 op_sel:[0,0,0] op_sel_hi:[1,0,0]
    v_fma_mix_f32 v91, v117, v65, v91 op_sel:[1,0,0] op_sel_hi:[1,0,0]
    v_fma_mix_f32 v92, v118, v65, v92 op_sel:[0,0,0] op_sel_hi:[1,0,0]
    v_fma_mix_f32 v93, v118, v65, v93 op_sel:[1,0,0] op_sel_hi:[1,0,0]
    s_add_u32 m0, s60, 36864
    s_add_u32 s49, s59, 221184
    buffer_load_dwordx4 v200, s[12:15], s49 offen offset:0 lds
    buffer_load_dwordx4 v201, s[12:15], s49 offen offset:1024 lds
    buffer_load_dwordx4 v202, s[12:15], s49 offen offset:2048 lds
    s_waitcnt vmcnt(11)
g_ok3:
    v_xor_b32 v64, v20, v123
    v_xor_b32 v65, v20, v127
    v_bitop3_b32 v66, v64, v65, s20 bitop3:0xa8
    v_cmp_ne_u32 vcc, 0, v66
    s_mov_b32 s66, 3
    s_nop 2
    s_cbranch_vccnz g_slow
g_go3:
    v_fma_mix_f32 v88, v120, v64, v88 op_sel:[0,0,0] op_sel_hi:[1,0,0]
    v_fma_mix_f32 v89, v120, v64, v89 op_sel:[1,0,0] op_sel_hi:[1,0,0]
    v_fma_mix_f32 v90, v121, v64, v90 op_sel:[0,0,0] op_sel_hi:[1,0,0]
    v_fma_mix_f32 v91, v121, v64, v91 op_sel:[1,0,0] op_sel_hi:[1,0,0]
    v_fma_mix_f32 v92, v122, v64, v92 op_sel:[0,0,0] op_sel_hi:[1,0,0]
    v_fma_mix_f32 v93, v122, v64, v93 op_sel:[1,0,0] op_sel_hi:[1,0,0]
    v_fma_mix_f32 v88, v124, v65, v88 op_sel:[0,0,0] op_sel_hi:[1,0,0]
    v_fma_mix_f32 v89, v124, v65, v89 op_sel:[1,0,0] op_sel_hi:[1,0,0]
    v_fma_mix_f32 v90, v125, v65, v90 op_sel:[0,0,0] op_sel_hi:[1,0,0]
    v_fma_mix_f32 v91, v125, v65, v91 op_sel:[1,0,0] op_sel_hi:[1,0,0]
    v_fma_mix_f32 v92, v126, v65, v92 op_sel:[0,0,0] op_sel_hi:[1,0,0]
    v_fma_mix_f32 v93, v126, v65, v93 op_sel:[1,0,0] op_sel_hi:[1,0,0]
    s_waitcnt vmcnt(9)
g_ok4:
    v_xor_b32 v64, v20, v131
    v_xor_b32 v65, v20, v135
    v_bitop3_b32 v66, v64, v65, s20 bitop3:0xa8
    v_cmp_ne_u32 vcc, 0, v66
    s_mov_b32 s66, 4
    s_nop 2
    s_cbranch_vccnz g_slow
g_go4:
    v_fma_mix_f32 v88, v128, v64, v88 op_sel:[0,0,0] op_sel_hi:[1,0,0]
    v_fma_mix_f32 v89, v128, v64, v89 op_sel:[1,0,0] op_sel_hi:[1,0,0]
    v_fma_mix_f32 v90, v129, v64, v90 op_sel:[0,0,0] op_sel_hi:[1,0,0]
    v_fma_mix_f32 v91, v129, v64, v91 op_sel:[1,0,0] op_sel_hi:[1,0,0]
    v_fma_mix_f32 v92, v130, v64, v92 op_sel:[0,0,0] op_sel_hi:[1,0,0]
    v_fma_mix_f32 v93, v130, v64, v93 op_sel:[1,0,0] op_sel_hi:[1,0,0]
    v_fma_mix_f32 v88, v132, v65, v88 op_sel:[0,0,0] op_sel_hi:[1,0,0]
    v_fma_mix_f32 v89, v132, v65, v89 op_sel:[1,0,0] op_sel_hi:[1,0,0]
    v_fma_mix_f32 v90, v133, v65, v90 op_sel:[0,0,0] op_sel_hi:[1,0,0]
    v_fma_mix_f32 v91, v133, v65, v91 op_sel:[1,0,0] op_sel_hi:[1,0,0]
    v_fma_mix_f32 v92, v134, v65, v92 op_sel:[0,0,0] op_sel_hi:[1,0,0]
    v_fma_mix_f32 v93, v134, v65, v93 op_sel:[1,0,0] op_sel_hi:[1,0,0]
    s_add_u32 m0, s60, 49152
    s_cmp_ge_u32 s59, 368640
    s_cselect_b32 s49, -5, 4
    s_mul_i32 s49, s49, 73728
    s_add_u32 s49, s49, s59
    buffer_load_dwordx4 v200, s[12:15], s49 offen offset:0 lds
    buffer_load_dwordx4 v201, s[12:15], s49 offen offset:1024 lds
    buffer_load_dwordx4 v202, s[12:15], s49 offen offset:2048 lds
    s_waitcnt vmcnt(10)
g_ok5:
    v_xor_b32 v64, v20, v139
    v_xor_b32 v65, v20, v143
    v_bitop3_b32 v66, v64, v65, s20 bitop3:0xa8
    v_cmp_ne_u32 vcc, 0, v66
    s_mov_b32 s66, 5
    s_nop 2
    s_cbranch_vccnz g_slow
g_go5:
    v_fma_mix_f32 v88, v136, v64, v88 op_sel:[0,0,0] op_sel_hi:[1,0,0]
    v_fma_mix_f32 v89, v136, v64, v89 op_sel:[1,0,0] op_sel_hi:[1,0,0]
    v_fma_mix_f32 v90, v137, v64, v90 op_sel:[0,0,0] op_sel_hi:[1,0,0]
    v_fma_mix_f32 v91, v137, v64, v91 op_sel:[1,0,0] op_sel_hi:[1,0,0]
    v_fma_mix_f32 v92, v138, v64, v92 op_sel:[0,0,0] op_sel_hi:[1,0,0]
    v_fma_mix_f32 v93, v138, v64, v93 op_sel:[1,0,0] op_sel_hi:[1,0,0]
    v_fma_mix_f32 v88, v140, v65, v88 op_sel:[0,0,0] op_sel_hi:[1,0,0]
    v_fma_mix_f32 v89, v140, v65, v89 op_sel:[1,0,0] op_sel_hi:[1,0,0]
    v_fma_mix_f32 v90, v141, v65, v90 op_sel:[0,0,0] op_sel_hi:[1,0,0]
    v_fma_mix_f32 v91, v141, v65, v91 op_sel:[1,0,0] op_sel_hi:[1,0,0]
    v_fma_mix_f32 v92, v142, v65, v92 op_sel:[0,0,0] op_sel_hi:[1,0,0]
    v_fma_mix_f32 v93, v142, v65, v93 op_sel:[1,0,0] op_sel_hi:[1,0,0]
    s_waitcnt vmcnt(8)
g_ok6:
    v_xor_b32 v64, v20, v147
    v_xor_b32 v65, v20, v151
    v_bitop3_b32 v66, v64, v65, s20 bitop3:0xa8
    v_cmp_ne_u32 vcc, 0, v66
    s_mov_b32 s66, 6
    s_nop 2
    s_cbranch_vccnz g_slow
g_go6:
    v_fma_mix_f32 v88, v144, v64, v88 op_sel:[0,0,0] op_sel_hi:[1,0,0]
    v_fma_mix_f32 v89, v144, v64, v89 op_sel:[1,0,0] op_sel_hi:[1,0,0]
    v_fma_mix_f32 v90, v145, v64, v90 op_sel:[0,0,0] op_sel_hi:[1,0,0]
    v_fma_mix_f32 v91, v145, v64, v91 op_sel:[1,0,0] op_sel_hi:[1,0,0]
    v_fma_mix_f32 v92, v146, v64, v92 op_sel:[0,0,0] op_sel_hi:[1,0,0]
    v_fma_mix_f32 v93, v146, v64, v93 op_sel:[1,0,0] op_sel_hi:[1,0,0]
    v_fma_mix_f32 v88, v148, v65, v88 op_sel:[0,0,0] op_sel_hi:[1,0,0]
    v_fma_mix_f32 v89, v148, v65, v89 op_sel:[1,0,0] op_sel_hi:[1,0,0]
    v_fma_mix_f32 v90, v149, v65, v90 op_sel:[0,0,0] op_sel_hi:[1,0,0]
    v_fma_mix_f32 v91, v149, v65, v91 op_sel:[1,0,0] op_sel_hi:[1,0,0]
    v_fma_mix_f32 v92, v150, v65, v92 op_sel:[0,0,0] op_sel_hi:[1,0,0]
    v_fma_mix_f32 v93, v150, v65, v93 op_sel:[1,0,0] op_sel_hi:[1,0,0]
    s_add_u32 m0, s60, 61440
    s_cmp_ge_u32 s59, 294912
    s_cselect_b32 s49, -4, 5
    s_mul_i32 s49, s49, 73728
    s_add_u32 s49, s49, s59
    buffer_load_dwordx4 v200, s[12:15], s49 offen offset:0 lds
    buffer_load_dwordx4 v201, s[12:15], s49 offen offset:1024 lds
    buffer_load_dwordx4 v202, s[12:15], s49 offen offset:2048 lds
    s_waitcnt vmcnt(9)
g_ok7:
    v_xor_b32 v64, v20, v155
    v_xor_b32 v65, v20, v159
    v_bitop3_b32 v66, v64, v65, s20 bitop3:0xa8
    v_cmp_ne_u32 vcc, 0, v66
    s_mov_b32 s66, 7
    s_nop 2
    s_cbranch_vccnz g_slow
g_go7:
    v_fma_mix_f32 v88, v152, v64, v88 op_sel:[0,0,0] op_sel_hi:[1,0,0]
    v_fma_mix_f32 v89, v152, v64, v89 op_sel:[1,0,0] op_sel_hi:[1,0,0]
    v_fma_mix_f32 v90, v153, v64, v90 op_sel:[0,0,0] op_sel_hi:[1,0,0]
    v_fma_mix_f32 v91, v153, v64, v91 op_sel:[1,0,0] op_sel_hi:[1,0,0]
    v_fma_mix_f32 v92, v154, v64, v92 op_sel:[0,0,0] op_sel_hi:[1,0,0]
    v_fma_mix_f32 v93, v154, v64, v93 op_sel:[1,0,0] op_sel_hi:[1,0,0]
    v_fma_mix_f32 v88, v156, v65, v88 op_sel:[0,0,0] op_sel_hi:[1,0,0]
    v_fma_mix_f32 v89, v156, v65, v89 op_sel:[1,0,0] op_sel_hi:[1,0,0]
    v_fma_mix_f32 v90, v157, v65, v90 op_sel:[0,0,0] op_sel_hi:[1,0,0]
    v_fma_mix_f32 v91, v157, v65, v91 op_sel:[1,0,0] op_sel_hi:[1,0,0]
    v_fma_mix_f32 v92, v158, v65, v92 op_sel:[0,0,0] op_sel_hi:[1,0,0]
    v_fma_mix_f32 v93, v158, v65, v93 op_sel:[1,0,0] op_sel_hi:[1,0,0]
    v_cvt_pk_bf16_f32 v88, v88, v89
    v_cvt_pk_bf16_f32 v89, v90, v91
    v_cvt_pk_bf16_f32 v90, v92, v93
    ds_write_b64 v27, v[88:89]
    ds_write_b32 v22, v90
    s_waitcnt lgkmcnt(0)
    s_barrier
    s_setprio 0
    s_mov_b32 s3, s46
    s_add_u32 m0, s60, 73728
    s_cmp_ge_u32 s59, 221184
    s_cselect_b32 s49, -3, 6
    s_mul_i32 s49, s49, 73728
    s_add_u32 s49, s49, s59
    buffer_load_dwordx4 v200, s[12:15], s49 offen offset:0 lds
    buffer_load_dwordx4 v201, s[12:15], s49 offen offset:1024 lds
    buffer_load_dwordx4 v202, s[12:15], s49 offen offset:2048 lds
    s_add_u32 m0, s60, 86016
    s_cmp_ge_u32 s59, 147456
    s_cselect_b32 s49, -2, 7
    s_mul_i32 s49, s49, 73728
    s_add_u32 s49, s49, s59
    buffer_load_dwordx4 v200, s[12:15], s49 offen offset:0 lds
    buffer_load_dwordx4 v201, s[12:15], s49 offen offset:1024 lds
    buffer_load_dwordx4 v202, s[12:15], s49 offen offset:2048 lds
    s_add_u32 m0, s60, 98304
    s_cmp_ge_u32 s59, 73728
    s_cselect_b32 s49, -1, 8
    s_mul_i32 s49, s49, 73728
    s_add_u32 s49, s49, s59
    buffer_load_dwordx4 v200, s[12:15], s49 offen offset:0 lds
    buffer_load_dwordx4 v201, s[12:15], s49 offen offset:1024 lds
    buffer_load_dwordx4 v202, s[12:15], s49 offen offset:2048 lds
    s_branch o0
g_slow:
    s_waitcnt vmcnt(0)
    s_cmp_gt_u32 s66, 0
    s_cbranch_scc1 g_sl0
    s_cmp_le_u32 s64, 0
    s_cbranch_scc1 g_sl7
    v_xor_b32 v64, v20, v99
    v_xor_b32 v65, v20, v103
    v_bitop3_b32 v66, v64, v65, s20 bitop3:0xa8
    v_cmp_ne_u32 vcc, 0, v66
    s_nop 3
    s_cbranch_vccz g_sl0
    s_add_u32 s48, s47, 0
    buffer_load_dwordx4 v[96:99], v2, s[40:43], s48 offen sc1
    buffer_load_dwordx4 v[100:103], v31, s[40:43], s48 offen sc1
g_sl0:
    s_cmp_gt_u32 s66, 1
    s_cbranch_scc1 g_sl1
    s_cmp_le_u32 s64, 1
    s_cbranch_scc1 g_sl7
    v_xor_b32 v64, v20, v107
    v_xor_b32 v65, v20, v111
    v_bitop3_b32 v66, v64, v65, s20 bitop3:0xa8
    v_cmp_ne_u32 vcc, 0, v66
    s_nop 3
    s_cbranch_vccz g_sl1
    s_add_u32 s48, s47, 8192
    buffer_load_dwordx4 v[104:107], v2, s[40:43], s48 offen sc1
    buffer_load_dwordx4 v[108:111], v31, s[40:43], s48 offen sc1
g_sl1:
    s_cmp_gt_u32 s66, 2
    s_cbranch_scc1 g_sl2
    s_cmp_le_u32 s64, 2
    s_cbranch_scc1 g_sl7
    v_xor_b32 v64, v20, v115
    v_xor_b32 v65, v20, v119
    v_bitop3_b32 v66, v64, v65, s20 bitop3:0xa8
    v_cmp_ne_u32 vcc, 0, v66
    s_nop 3
    s_cbranch_vccz g_sl2
    s_add_u32 s48, s47, 16384
    buffer_load_dwordx4 v[112:115], v2, s[40:43], s48 offen sc1
    buffer_load_dwordx4 v[116:119], v31, s[40:43], s48 offen sc1
g_sl2:
    s_cmp_gt_u32 s66, 3
    s_cbranch_scc1 g_sl3
    s_cmp_le_u32 s64, 3
    s_cbranch_scc1 g_sl7
    v_xor_b32 v64, v20, v123
    v_xor_b32 v65, v20, v127
    v_bitop3_b32 v66, v64, v65, s20 bitop3:0xa8
    v_cmp_ne_u32 vcc, 0, v66
    s_nop 3
    s_cbranch_vccz g_sl3
    s_add_u32 s48, s47, 24576
    buffer_load_dwordx4 v[120:123], v2, s[40:43], s48 offen sc1
    buffer_load_dwordx4 v[124:127], v31, s[40:43], s48 offen sc1
g_sl3:
    s_cmp_gt_u32 s66, 4
    s_cbranch_scc1 g_sl4
    s_cmp_le_u32 s64, 4
    s_cbranch_scc1 g_sl7
    v_xor_b32 v64, v20, v131
    v_xor_b32 v65, v20, v135
    v_bitop3_b32 v66, v64, v65, s20 bitop3:0xa8
    v_cmp_ne_u32 vcc, 0, v66
    s_nop 3
    s_cbranch_vccz g_sl4
    s_add_u32 s48, s47, 32768
    buffer_load_dwordx4 v[128:131], v2, s[40:43], s48 offen sc1
    buffer_load_dwordx4 v[132:135], v31, s[40:43], s48 offen sc1
g_sl4:
    s_cmp_gt_u32 s66, 5
    s_cbranch_scc1 g_sl5
    s_cmp_le_u32 s64, 5
    s_cbranch_scc1 g_sl7
    v_xor_b32 v64, v20, v139
    v_xor_b32 v65, v20, v143
    v_bitop3_b32 v66, v64, v65, s20 bitop3:0xa8
    v_cmp_ne_u32 vcc, 0, v66
    s_nop 3
    s_cbranch_vccz g_sl5
    s_add_u32 s48, s47, 40960
    buffer_load_dwordx4 v[136:139], v2, s[40:43], s48 offen sc1
    buffer_load_dwordx4 v[140:143], v31, s[40:43], s48 offen sc1
g_sl5:
    s_cmp_gt_u32 s66, 6
    s_cbranch_scc1 g_sl6
    s_cmp_le_u32 s64, 6
    s_cbranch_scc1 g_sl7
    v_xor_b32 v64, v20, v147
    v_xor_b32 v65, v20, v151
    v_bitop3_b32 v66, v64, v65, s20 bitop3:0xa8
    v_cmp_ne_u32 vcc, 0, v66
    s_nop 3
    s_cbranch_vccz g_sl6
    s_add_u32 s48, s47, 49152
    buffer_load_dwordx4 v[144:147], v2, s[40:43], s48 offen sc1
    buffer_load_dwordx4 v[148:151], v31, s[40:43], s48 offen sc1
g_sl6:
    s_cmp_gt_u32 s66, 7
    s_cbranch_scc1 g_sl7
    s_cmp_le_u32 s64, 7
    s_cbranch_scc1 g_sl7
    v_xor_b32 v64, v20, v155
    v_xor_b32 v65, v20, v159
    v_bitop3_b32 v66, v64, v65, s20 bitop3:0xa8
    v_cmp_ne_u32 vcc, 0, v66
    s_nop 3
    s_cbranch_vccz g_sl7
    s_add_u32 s48, s47, 57344
    buffer_load_dwordx4 v[152:155], v2, s[40:43], s48 offen sc1
    buffer_load_dwordx4 v[156:159], v31, s[40:43], s48 offen sc1
g_sl7:
    s_add_u32 s50, s50, 1
    s_cmp_lt_u32 s50, 32768
    s_cselect_b32 s49, 0, 8
    s_add_u32 s49, s49, s66
    s_waitcnt vmcnt(0)
    s_cmp_eq_u32 s49, 0
    s_cbranch_scc1 g_ok0
    s_cmp_eq_u32 s49, 1
    s_cbranch_scc1 g_ok1
    s_cmp_eq_u32 s49, 2
    s_cbranch_scc1 g_ok2
    s_cmp_eq_u32 s49, 3
    s_cbranch_scc1 g_ok3
    s_cmp_eq_u32 s49, 4
    s_cbranch_scc1 g_ok4
    s_cmp_eq_u32 s49, 5
    s_cbranch_scc1 g_ok5
    s_cmp_eq_u32 s49, 6
    s_cbranch_scc1 g_ok6
    s_cmp_eq_u32 s49, 7
    s_cbranch_scc1 g_ok7
    s_cmp_eq_u32 s49, 8
    s_cbranch_scc1 g_go0
    s_cmp_eq_u32 s49, 9
    s_cbranch_scc1 g_go1
    s_cmp_eq_u32 s49, 10
    s_cbranch_scc1 g_go2
    s_cmp_eq_u32 s49, 11
    s_cbranch_scc1 g_go3
    s_cmp_eq_u32 s49, 12
    s_cbranch_scc1 g_go4
    s_cmp_eq_u32 s49, 13
    s_cbranch_scc1 g_go5
    s_cmp_eq_u32 s49, 14
    s_cbranch_scc1 g_go6
    s_branch g_go7
g_comp:
    v_and_b32 v10, 15, v1
    v_lshrrev_b32 v11, 4, v1
    v_lshrrev_b32 v12, 1, v10
    v_xor_b32 v12, v12, v11
    v_lshlrev_b32 v13, 7, v10
    s_lshl_b32 s47, s44, 12
    v_add_u32 v13, s47, v13
    v_lshl_add_u32 v2, v12, 4, v13
    v_xor_b32 v3, 64, v2
    v_bfe_u32 v12, v1, 2, 2
    v_lshl_add_u32 v12, v11, 3, v12
    v_mul_u32_u24 v12, 192, v12
    v_and_b32 v13, 3, v1
    v_and_b32 v14, 1, v11
    v_lshlrev_b32 v14, 5, v14
    s_and_b32 s47, s46, 3
    s_lshl_b32 s47, s47, 4
    v_lshl_add_u32 v15, v13, 3, s47
    v_add_u32 v10, 0, v15
    v_xor_b32 v10, v10, v14
    v_add_u32 v4, v10, v12
    v_add_u32 v10, 40, v15
    v_xor_b32 v10, v10, v14
    v_add_u32 v5, v10, v12
    v_add_u32 v10, 72, v15
    v_xor_b32 v10, v10, v14
    v_add_u32 v6, v10, v12
    v_add_u32 v10, 112, v15
    v_xor_b32 v10, v10, v14
    v_add_u32 v7, v10, v12
    v_and_b32 v10, 1, v13
    v_mul_u32_u24 v10, 72, v10
    v_add3_u32 v10, v10, s47, 32
    v_xor_b32 v10, v10, v14
    v_add_u32 v10, v10, v12
    v_lshrrev_b32 v13, 1, v13
    v_mul_u32_u24 v9, 12288, v13
    v_add_u32 v8, v10, v9
    s_mov_b32 s32, 0xc020c02
    s_mov_b32 s33, 0xc020c02
    s_mov_b32 s34, 0x30043004
    s_mov_b32 s35, 0x30043004
    s_mov_b32 s36, 0xc008c008
    s_mov_b32 s37, 0xc008c008
    s_mov_b32 s38, 0xffff0000
    s_mov_b32 s39, 0x0
    s_mov_b32 s64, 0xff00ff
    s_mov_b32 s65, 0xff00ff
    s_waitcnt lgkmcnt(0)
    s_mov_b32 s40, s30
    s_and_b32 s41, s31, 0xffff
    s_mov_b32 s42, 0x6e0000
    s_mov_b32 s43, 0x20000
    s_waitcnt vmcnt(0)
    s_mov_b32 s22, 0x3fb8aa3b
    s_mov_b32 s23, 0x3fb8aa3b
    s_lshl2_add_u32 s52, s45, s44
    s_lshl3_add_u32 s53, s52, s46
    s_lshl_b32 s53, s53, 7
    s_add_u32 s53, s53, 0x4e0000
    s_mul_i32 s52, s52, 40960
    s_lshl_b32 s51, s46, 11
    s_add_u32 s51, s51, s52
    s_lshl_b32 s50, s46, 9
    s_add_u32 s52, s52, s50
    s_add_u32 s52, s52, 16384
    s_lshr_b32 s56, s46, 2
    s_lshl1_add_u32 s56, s45, s56
    s_and_b32 s57, s46, 3
    s_mov_b32 s55, 1
    s_lshl2_add_u32 s61, s56, s44
    s_mov_b32 s16, s26
    s_and_b32 s17, s27, 0xffff
    s_mov_b32 s18, 0x240000
    s_mov_b32 s19, 0x20000
    s_lshl2_add_u32 s48, s57, s44
    s_mul_i32 s69, s48, 101376
    s_lshl_b32 s49, s56, 7
    s_add_u32 s69, s69, s49
    s_add_u32 s69, s69, 0x280000
    s_mul_i32 s67, s44, 3072
    s_add_u32 s67, s67, 122880
    s_mul_i32 s62, s61, 20480
    s_lshr_b32 s68, s61, 1
    s_lshl_b32 s68, s68, 10
    s_add_u32 s68, s68, 0x4e0000
    s_mul_i32 s63, s61, 18432
    s_mul_i32 s48, s57, 192
    s_add_u32 s63, s63, s48
    v_and_b32 v10, 31, v1
    v_lshlrev_b32 v10, 2, v10
    v_mov_b32 v11, 0
    s_barrier
    ds_read_b128 v[16:19], v2 offset:0
    ds_read_b128 v[20:23], v2 offset:2048
    ds_read_b64_tr_b16 v[232:233], v4 offset:16384
    ds_read_b64_tr_b16 v[234:235], v4 offset:17152
    ds_read_b64_tr_b16 v[236:237], v5 offset:16384
    ds_read_b64_tr_b16 v[238:239], v5 offset:17152
    ds_read_b64_tr_b16 v[240:241], v6 offset:16384
    ds_read_b64_tr_b16 v[242:243], v6 offset:17152
    ds_read_b64_tr_b16 v[244:245], v7 offset:16384
    ds_read_b64_tr_b16 v[246:247], v7 offset:17152
    ds_read_b64_tr_b16 v[248:249], v8 offset:16384
    ds_read_b64_tr_b16 v[250:251], v8 offset:17152
    ds_read_b64_tr_b16 v[252:253], v4 offset:28672
    ds_read_b64_tr_b16 v[254:255], v4 offset:29440
    ds_read_b64_tr_b16 v[144:145], v5 offset:28672
    ds_read_b64_tr_b16 v[146:147], v5 offset:29440
    s_waitcnt lgkmcnt(12)
    v_mfma_f32_16x16x32_bf16 v[160:163], v[16:19], v[232:235], 0
    ds_read_b64_tr_b16 v[148:149], v6 offset:28672
    ds_read_b64_tr_b16 v[150:151], v6 offset:29440
    v_mfma_f32_16x16x32_bf16 v[164:167], v[20:23], v[232:235], 0
    ds_read_b64_tr_b16 v[152:153], v7 offset:28672
    ds_read_b64_tr_b16 v[154:155], v7 offset:29440
    s_waitcnt lgkmcnt(14)
    v_mfma_f32_16x16x32_bf16 v[168:171], v[16:19], v[236:239], 0
    ds_read_b128 v[24:27], v3 offset:0
    ds_read_b128 v[28:31], v3 offset:2048
    v_mfma_f32_16x16x32_bf16 v[172:175], v[20:23], v[236:239], 0
    ds_read_b64_tr_b16 v[156:157], v4 offset:22528
    ds_read_b64_tr_b16 v[158:159], v4 offset:23296
    s_waitcnt lgkmcnt(15)
    v_mfma_f32_16x16x32_bf16 v[176:179], v[16:19], v[240:243], 0
    ds_read_b64_tr_b16 v[232:233], v5 offset:22528
    ds_read_b64_tr_b16 v[234:235], v5 offset:23296
    v_mfma_f32_16x16x32_bf16 v[180:183], v[20:23], v[240:243], 0
    ds_read_b64_tr_b16 v[236:237], v6 offset:22528
    s_waitcnt lgkmcnt(15)
    v_mfma_f32_16x16x32_bf16 v[184:187], v[16:19], v[244:247], 0
    ds_read_b64_tr_b16 v[238:239], v6 offset:23296
    v_mfma_f32_16x16x32_bf16 v[188:191], v[20:23], v[244:247], 0
    ds_read_b64_tr_b16 v[240:241], v7 offset:22528
    v_mfma_f32_16x16x32_bf16 v[192:195], v[16:19], v[248:251], 0
    ds_read_b64_tr_b16 v[242:243], v7 offset:23296
    v_mfma_f32_16x16x32_bf16 v[196:199], v[20:23], v[248:251], 0
    ds_read_b64_tr_b16 v[244:245], v8 offset:22528
    s_waitcnt lgkmcnt(15)
    v_mfma_f32_16x16x32_bf16 v[200:203], v[16:19], v[252:255], 0
    ds_read_b64_tr_b16 v[246:247], v8 offset:23296
    v_mfma_f32_16x16x32_bf16 v[204:207], v[20:23], v[252:255], 0
    ds_read_b64_tr_b16 v[248:249], v4 offset:34816
    v_mfma_f32_16x16x32_bf16 v[208:211], v[16:19], v[144:147], 0
    ds_read_b64_tr_b16 v[250:251], v4 offset:35584
    v_mfma_f32_16x16x32_bf16 v[212:215], v[20:23], v[144:147], 0
    ds_read_b64_tr_b16 v[252:253], v5 offset:34816
    s_waitcnt lgkmcnt(15)
    v_mfma_f32_16x16x32_bf16 v[216:219], v[16:19], v[148:151], 0
    ds_read_b64_tr_b16 v[254:255], v5 offset:35584
    v_mfma_f32_16x16x32_bf16 v[220:223], v[20:23], v[148:151], 0
    ds_read_b64_tr_b16 v[144:145], v6 offset:34816
    v_mfma_f32_16x16x32_bf16 v[224:227], v[16:19], v[152:155], 0
    ds_read_b64_tr_b16 v[146:147], v6 offset:35584
    v_mfma_f32_16x16x32_bf16 v[228:231], v[20:23], v[152:155], 0
    ds_read_b64_tr_b16 v[148:149], v7 offset:34816
    s_waitcnt lgkmcnt(15)
    v_mfma_f32_16x16x32_bf16 v[160:163], v[24:27], v[156:159], v[160:163]
    ds_read_b64_tr_b16 v[150:151], v7 offset:35584
    v_mfma_f32_16x16x32_bf16 v[164:167], v[28:31], v[156:159], v[164:167]
    s_waitcnt lgkmcnt(14)
    v_mfma_f32_16x16x32_bf16 v[168:171], v[24:27], v[232:235], v[168:171]
    v_mfma_f32_16x16x32_bf16 v[172:175], v[28:31], v[232:235], v[172:175]
    s_waitcnt lgkmcnt(12)
    v_mfma_f32_16x16x32_bf16 v[176:179], v[24:27], v[236:239], v[176:179]
    v_mfma_f32_16x16x32_bf16 v[180:183], v[28:31], v[236:239], v[180:183]
    s_waitcnt lgkmcnt(10)
    v_mfma_f32_16x16x32_bf16 v[184:187], v[24:27], v[240:243], v[184:187]
    v_mfma_f32_16x16x32_bf16 v[188:191], v[28:31], v[240:243], v[188:191]
    s_waitcnt lgkmcnt(8)
    v_mfma_f32_16x16x32_bf16 v[192:195], v[24:27], v[244:247], v[192:195]
    v_mfma_f32_16x16x32_bf16 v[196:199], v[28:31], v[244:247], v[196:199]
    v_add_u32 v2, 40960, v2
    v_add_u32 v3, 40960, v3
    v_add_u32 v4, 40960, v4
    v_add_u32 v5, 40960, v5
    v_add_u32 v6, 40960, v6
    v_add_u32 v7, 40960, v7
    v_add_u32 v8, 40960, v8
    s_barrier
    ds_read_b128 v[32:35], v2 offset:0
    s_waitcnt lgkmcnt(7)
    v_mfma_f32_16x16x32_bf16 v[200:203], v[24:27], v[248:251], v[200:203]
    ds_read_b128 v[36:39], v2 offset:2048
    ds_read_b64_tr_b16 v[152:153], v4 offset:16384
    v_mfma_f32_16x16x32_bf16 v[204:207], v[28:31], v[248:251], v[204:207]
    ds_read_b64_tr_b16 v[154:155], v4 offset:17152
    ds_read_b64_tr_b16 v[156:157], v5 offset:16384
    s_waitcnt lgkmcnt(9)
    v_mfma_f32_16x16x32_bf16 v[208:211], v[24:27], v[252:255], v[208:211]
    ds_read_b64_tr_b16 v[158:159], v5 offset:17152
    ds_read_b64_tr_b16 v[232:233], v6 offset:16384
    v_mfma_f32_16x16x32_bf16 v[212:215], v[28:31], v[252:255], v[212:215]
    ds_read_b64_tr_b16 v[234:235], v6 offset:17152
    ds_read_b64_tr_b16 v[236:237], v7 offset:16384
    s_waitcnt lgkmcnt(11)
    v_mfma_f32_16x16x32_bf16 v[216:219], v[24:27], v[144:147], v[216:219]
    ds_read_b64_tr_b16 v[238:239], v7 offset:17152
    ds_read_b64_tr_b16 v[240:241], v8 offset:16384
    v_mfma_f32_16x16x32_bf16 v[220:223], v[28:31], v[144:147], v[220:223]
    ds_read_b64_tr_b16 v[242:243], v8 offset:17152
    ds_read_b64_tr_b16 v[244:245], v4 offset:28672
    s_waitcnt lgkmcnt(13)
    v_mfma_f32_16x16x32_bf16 v[224:227], v[24:27], v[148:151], v[224:227]
    ds_read_b64_tr_b16 v[246:247], v4 offset:29440
    ds_read_b64_tr_b16 v[248:249], v5 offset:28672
    v_mfma_f32_16x16x32_bf16 v[228:231], v[28:31], v[148:151], v[228:231]
    ds_read_b64_tr_b16 v[250:251], v5 offset:29440
    ds_read_b64_tr_b16 v[252:253], v6 offset:28672
    s_waitcnt lgkmcnt(13)
    v_mfma_f32_16x16x32_bf16 v[160:163], v[32:35], v[152:155], v[160:163]
    ds_read_b64_tr_b16 v[254:255], v6 offset:29440
    ds_read_b64_tr_b16 v[144:145], v7 offset:28672
    v_mfma_f32_16x16x32_bf16 v[164:167], v[36:39], v[152:155], v[164:167]
    ds_read_b64_tr_b16 v[146:147], v7 offset:29440
    s_waitcnt lgkmcnt(14)
    v_mfma_f32_16x16x32_bf16 v[168:171], v[32:35], v[156:159], v[168:171]
    ds_read_b128 v[40:43], v3 offset:0
    ds_read_b128 v[44:47], v3 offset:2048
    v_mfma_f32_16x16x32_bf16 v[172:175], v[36:39], v[156:159], v[172:175]
    ds_read_b64_tr_b16 v[148:149], v4 offset:22528
    ds_read_b64_tr_b16 v[150:151], v4 offset:23296
    s_waitcnt lgkmcnt(15)
    v_mfma_f32_16x16x32_bf16 v[176:179], v[32:35], v[232:235], v[176:179]
    ds_read_b64_tr_b16 v[152:153], v5 offset:22528
    ds_read_b64_tr_b16 v[154:155], v5 offset:23296
    v_mfma_f32_16x16x32_bf16 v[180:183], v[36:39], v[232:235], v[180:183]
    ds_read_b64_tr_b16 v[156:157], v6 offset:22528
    s_waitcnt lgkmcnt(15)
    v_mfma_f32_16x16x32_bf16 v[184:187], v[32:35], v[236:239], v[184:187]
    ds_read_b64_tr_b16 v[158:159], v6 offset:23296
    v_mfma_f32_16x16x32_bf16 v[188:191], v[36:39], v[236:239], v[188:191]
    ds_read_b64_tr_b16 v[232:233], v7 offset:22528
    v_mfma_f32_16x16x32_bf16 v[192:195], v[32:35], v[240:243], v[192:195]
    ds_read_b64_tr_b16 v[234:235], v7 offset:23296
    v_mfma_f32_16x16x32_bf16 v[196:199], v[36:39], v[240:243], v[196:199]
    ds_read_b64_tr_b16 v[236:237], v8 offset:22528
    s_waitcnt lgkmcnt(15)
    v_mfma_f32_16x16x32_bf16 v[200:203], v[32:35], v[244:247], v[200:203]
    ds_read_b64_tr_b16 v[238:239], v8 offset:23296
    v_mfma_f32_16x16x32_bf16 v[204:207], v[36:39], v[244:247], v[204:207]
    ds_read_b64_tr_b16 v[240:241], v4 offset:34816
    v_mfma_f32_16x16x32_bf16 v[208:211], v[32:35], v[248:251], v[208:211]
    ds_read_b64_tr_b16 v[242:243], v4 offset:35584
    v_mfma_f32_16x16x32_bf16 v[212:215], v[36:39], v[248:251], v[212:215]
    ds_read_b64_tr_b16 v[244:245], v5 offset:34816
    s_waitcnt lgkmcnt(15)
    v_mfma_f32_16x16x32_bf16 v[216:219], v[32:35], v[252:255], v[216:219]
    ds_read_b64_tr_b16 v[246:247], v5 offset:35584
    v_mfma_f32_16x16x32_bf16 v[220:223], v[36:39], v[252:255], v[220:223]
    ds_read_b64_tr_b16 v[248:249], v6 offset:34816
    v_mfma_f32_16x16x32_bf16 v[224:227], v[32:35], v[144:147], v[224:227]
    ds_read_b64_tr_b16 v[250:251], v6 offset:35584
    v_mfma_f32_16x16x32_bf16 v[228:231], v[36:39], v[144:147], v[228:231]
    ds_read_b64_tr_b16 v[252:253], v7 offset:34816
    s_waitcnt lgkmcnt(15)
    v_mfma_f32_16x16x32_bf16 v[160:163], v[40:43], v[148:151], v[160:163]
    ds_read_b64_tr_b16 v[254:255], v7 offset:35584
    v_mfma_f32_16x16x32_bf16 v[164:167], v[44:47], v[148:151], v[164:167]
    s_waitcnt lgkmcnt(14)
    v_mfma_f32_16x16x32_bf16 v[168:171], v[40:43], v[152:155], v[168:171]
    v_mfma_f32_16x16x32_bf16 v[172:175], v[44:47], v[152:155], v[172:175]
    s_waitcnt lgkmcnt(12)
    v_mfma_f32_16x16x32_bf16 v[176:179], v[40:43], v[156:159], v[176:179]
    v_mfma_f32_16x16x32_bf16 v[180:183], v[44:47], v[156:159], v[180:183]
    s_waitcnt lgkmcnt(10)
    v_mfma_f32_16x16x32_bf16 v[184:187], v[40:43], v[232:235], v[184:187]
    v_mfma_f32_16x16x32_bf16 v[188:191], v[44:47], v[232:235], v[188:191]
    s_waitcnt lgkmcnt(8)
    v_mfma_f32_16x16x32_bf16 v[192:195], v[40:43], v[236:239], v[192:195]
    v_mfma_f32_16x16x32_bf16 v[196:199], v[44:47], v[236:239], v[196:199]
    v_add_u32 v2, 40960, v2
    v_add_u32 v3, 40960, v3
    v_add_u32 v4, 40960, v4
    v_add_u32 v5, 40960, v5
    v_add_u32 v6, 40960, v6
    v_add_u32 v7, 40960, v7
    v_add_u32 v8, 40960, v8
    s_barrier
    ds_read_b128 v[48:51], v2 offset:0
    s_waitcnt lgkmcnt(7)
    v_mfma_f32_16x16x32_bf16 v[200:203], v[40:43], v[240:243], v[200:203]
    ds_read_b128 v[52:55], v2 offset:2048
    ds_read_b64_tr_b16 v[144:145], v4 offset:16384
    v_mfma_f32_16x16x32_bf16 v[204:207], v[44:47], v[240:243], v[204:207]
    ds_read_b64_tr_b16 v[146:147], v4 offset:17152
    ds_read_b64_tr_b16 v[148:149], v5 offset:16384
    s_waitcnt lgkmcnt(9)
    v_mfma_f32_16x16x32_bf16 v[208:211], v[40:43], v[244:247], v[208:211]
    ds_read_b64_tr_b16 v[150:151], v5 offset:17152
    ds_read_b64_tr_b16 v[152:153], v6 offset:16384
    v_mfma_f32_16x16x32_bf16 v[212:215], v[44:47], v[244:247], v[212:215]
    ds_read_b64_tr_b16 v[154:155], v6 offset:17152
    ds_read_b64_tr_b16 v[156:157], v7 offset:16384
    s_waitcnt lgkmcnt(11)
    v_mfma_f32_16x16x32_bf16 v[216:219], v[40:43], v[248:251], v[216:219]
    ds_read_b64_tr_b16 v[158:159], v7 offset:17152
    ds_read_b64_tr_b16 v[232:233], v8 offset:16384
    v_mfma_f32_16x16x32_bf16 v[220:223], v[44:47], v[248:251], v[220:223]
    ds_read_b64_tr_b16 v[234:235], v8 offset:17152
    ds_read_b64_tr_b16 v[236:237], v4 offset:28672
    s_waitcnt lgkmcnt(13)
    v_mfma_f32_16x16x32_bf16 v[224:227], v[40:43], v[252:255], v[224:227]
    ds_read_b64_tr_b16 v[238:239], v4 offset:29440
    ds_read_b64_tr_b16 v[240:241], v5 offset:28672
    v_mfma_f32_16x16x32_bf16 v[228:231], v[44:47], v[252:255], v[228:231]
    ds_read_b64_tr_b16 v[242:243], v5 offset:29440
    ds_read_b64_tr_b16 v[244:245], v6 offset:28672
    s_waitcnt lgkmcnt(13)
    v_mfma_f32_16x16x32_bf16 v[160:163], v[48:51], v[144:147], v[160:163]
    ds_read_b64_tr_b16 v[246:247], v6 offset:29440
    ds_read_b64_tr_b16 v[248:249], v7 offset:28672
    v_mfma_f32_16x16x32_bf16 v[164:167], v[52:55], v[144:147], v[164:167]
    ds_read_b64_tr_b16 v[250:251], v7 offset:29440
    s_waitcnt lgkmcnt(14)
    v_mfma_f32_16x16x32_bf16 v[168:171], v[48:51], v[148:151], v[168:171]
    ds_read_b128 v[56:59], v3 offset:0
    ds_read_b128 v[60:63], v3 offset:2048
    v_mfma_f32_16x16x32_bf16 v[172:175], v[52:55], v[148:151], v[172:175]
    ds_read_b64_tr_b16 v[252:253], v4 offset:22528
    ds_read_b64_tr_b16 v[254:255], v4 offset:23296
    s_waitcnt lgkmcnt(15)
    v_mfma_f32_16x16x32_bf16 v[176:179], v[48:51], v[152:155], v[176:179]
    ds_read_b64_tr_b16 v[144:145], v5 offset:22528
    ds_read_b64_tr_b16 v[146:147], v5 offset:23296
    v_mfma_f32_16x16x32_bf16 v[180:183], v[52:55], v[152:155], v[180:183]
    ds_read_b64_tr_b16 v[148:149], v6 offset:22528
    s_waitcnt lgkmcnt(15)
    v_mfma_f32_16x16x32_bf16 v[184:187], v[48:51], v[156:159], v[184:187]
    ds_read_b64_tr_b16 v[150:151], v6 offset:23296
    v_mfma_f32_16x16x32_bf16 v[188:191], v[52:55], v[156:159], v[188:191]
    ds_read_b64_tr_b16 v[152:153], v7 offset:22528
    v_mfma_f32_16x16x32_bf16 v[192:195], v[48:51], v[232:235], v[192:195]
    ds_read_b64_tr_b16 v[154:155], v7 offset:23296
    v_mfma_f32_16x16x32_bf16 v[196:199], v[52:55], v[232:235], v[196:199]
    ds_read_b64_tr_b16 v[156:157], v8 offset:22528
    s_waitcnt lgkmcnt(15)
    v_mfma_f32_16x16x32_bf16 v[200:203], v[48:51], v[236:239], v[200:203]
    ds_read_b64_tr_b16 v[158:159], v8 offset:23296
    v_mfma_f32_16x16x32_bf16 v[204:207], v[52:55], v[236:239], v[204:207]
    ds_read_b64_tr_b16 v[232:233], v4 offset:34816
    v_mfma_f32_16x16x32_bf16 v[208:211], v[48:51], v[240:243], v[208:211]
    ds_read_b64_tr_b16 v[234:235], v4 offset:35584
    v_mfma_f32_16x16x32_bf16 v[212:215], v[52:55], v[240:243], v[212:215]
    ds_read_b64_tr_b16 v[236:237], v5 offset:34816
    s_waitcnt lgkmcnt(15)
    v_mfma_f32_16x16x32_bf16 v[216:219], v[48:51], v[244:247], v[216:219]
    ds_read_b64_tr_b16 v[238:239], v5 offset:35584
    v_mfma_f32_16x16x32_bf16 v[220:223], v[52:55], v[244:247], v[220:223]
    ds_read_b64_tr_b16 v[240:241], v6 offset:34816
    v_mfma_f32_16x16x32_bf16 v[224:227], v[48:51], v[248:251], v[224:227]
    ds_read_b64_tr_b16 v[242:243], v6 offset:35584
    v_mfma_f32_16x16x32_bf16 v[228:231], v[52:55], v[248:251], v[228:231]
    ds_read_b64_tr_b16 v[244:245], v7 offset:34816
    s_waitcnt lgkmcnt(15)
    v_mfma_f32_16x16x32_bf16 v[160:163], v[56:59], v[252:255], v[160:163]
    ds_read_b64_tr_b16 v[246:247], v7 offset:35584
    v_mfma_f32_16x16x32_bf16 v[164:167], v[60:63], v[252:255], v[164:167]
    s_waitcnt lgkmcnt(14)
    v_mfma_f32_16x16x32_bf16 v[168:171], v[56:59], v[144:147], v[168:171]
    v_mfma_f32_16x16x32_bf16 v[172:175], v[60:63], v[144:147], v[172:175]
    s_waitcnt lgkmcnt(12)
    v_mfma_f32_16x16x32_bf16 v[176:179], v[56:59], v[148:151], v[176:179]
    v_mfma_f32_16x16x32_bf16 v[180:183], v[60:63], v[148:151], v[180:183]
    s_waitcnt lgkmcnt(10)
    v_mfma_f32_16x16x32_bf16 v[184:187], v[56:59], v[152:155], v[184:187]
    v_mfma_f32_16x16x32_bf16 v[188:191], v[60:63], v[152:155], v[188:191]
    s_waitcnt lgkmcnt(8)
    v_mfma_f32_16x16x32_bf16 v[192:195], v[56:59], v[156:159], v[192:195]
    v_mfma_f32_16x16x32_bf16 v[196:199], v[60:63], v[156:159], v[196:199]
    v_add_u32 v2, 40960, v2
    v_add_u32 v3, 40960, v3
    v_add_u32 v4, 40960, v4
    v_add_u32 v5, 40960, v5
    v_add_u32 v6, 40960, v6
    v_add_u32 v7, 40960, v7
    v_add_u32 v8, 40960, v8
    s_barrier
    ds_read_b128 v[64:67], v2 offset:0
    s_waitcnt lgkmcnt(7)
    v_mfma_f32_16x16x32_bf16 v[200:203], v[56:59], v[232:235], v[200:203]
    ds_read_b128 v[68:71], v2 offset:2048
    ds_read_b64_tr_b16 v[248:249], v4 offset:16384
    v_mfma_f32_16x16x32_bf16 v[204:207], v[60:63], v[232:235], v[204:207]
    ds_read_b64_tr_b16 v[250:251], v4 offset:17152
    ds_read_b64_tr_b16 v[252:253], v5 offset:16384
    s_waitcnt lgkmcnt(9)
    v_mfma_f32_16x16x32_bf16 v[208:211], v[56:59], v[236:239], v[208:211]
    ds_read_b64_tr_b16 v[254:255], v5 offset:17152
    ds_read_b64_tr_b16 v[144:145], v6 offset:16384
    v_mfma_f32_16x16x32_bf16 v[212:215], v[60:63], v[236:239], v[212:215]
    ds_read_b64_tr_b16 v[146:147], v6 offset:17152
    ds_read_b64_tr_b16 v[148:149], v7 offset:16384
    s_waitcnt lgkmcnt(11)
    v_mfma_f32_16x16x32_bf16 v[216:219], v[56:59], v[240:243], v[216:219]
    ds_read_b64_tr_b16 v[150:151], v7 offset:17152
    ds_read_b64_tr_b16 v[152:153], v8 offset:16384
    v_mfma_f32_16x16x32_bf16 v[220:223], v[60:63], v[240:243], v[220:223]
    ds_read_b64_tr_b16 v[154:155], v8 offset:17152
    ds_read_b64_tr_b16 v[156:157], v4 offset:28672
    s_waitcnt lgkmcnt(13)
    v_mfma_f32_16x16x32_bf16 v[224:227], v[56:59], v[244:247], v[224:227]
    ds_read_b64_tr_b16 v[158:159], v4 offset:29440
    ds_read_b64_tr_b16 v[232:233], v5 offset:28672
    v_mfma_f32_16x16x32_bf16 v[228:231], v[60:63], v[244:247], v[228:231]
    ds_read_b64_tr_b16 v[234:235], v5 offset:29440
    ds_read_b64_tr_b16 v[236:237], v6 offset:28672
    s_waitcnt lgkmcnt(13)
    v_mfma_f32_16x16x32_bf16 v[160:163], v[64:67], v[248:251], v[160:163]
    ds_read_b64_tr_b16 v[238:239], v6 offset:29440
    ds_read_b64_tr_b16 v[240:241], v7 offset:28672
    v_mfma_f32_16x16x32_bf16 v[164:167], v[68:71], v[248:251], v[164:167]
    ds_read_b64_tr_b16 v[242:243], v7 offset:29440
    s_waitcnt lgkmcnt(14)
    v_mfma_f32_16x16x32_bf16 v[168:171], v[64:67], v[252:255], v[168:171]
    ds_read_b128 v[72:75], v3 offset:0
    ds_read_b128 v[76:79], v3 offset:2048
    v_mfma_f32_16x16x32_bf16 v[172:175], v[68:71], v[252:255], v[172:175]
    ds_read_b64_tr_b16 v[244:245], v4 offset:22528
    ds_read_b64_tr_b16 v[246:247], v4 offset:23296
    s_waitcnt lgkmcnt(15)
    v_mfma_f32_16x16x32_bf16 v[176:179], v[64:67], v[144:147], v[176:179]
    ds_read_b64_tr_b16 v[248:249], v5 offset:22528
    ds_read_b64_tr_b16 v[250:251], v5 offset:23296
    v_mfma_f32_16x16x32_bf16 v[180:183], v[68:71], v[144:147], v[180:183]
    ds_read_b64_tr_b16 v[252:253], v6 offset:22528
    s_waitcnt lgkmcnt(15)
    v_mfma_f32_16x16x32_bf16 v[184:187], v[64:67], v[148:151], v[184:187]
    ds_read_b64_tr_b16 v[254:255], v6 offset:23296
    v_mfma_f32_16x16x32_bf16 v[188:191], v[68:71], v[148:151], v[188:191]
    ds_read_b64_tr_b16 v[144:145], v7 offset:22528
    v_mfma_f32_16x16x32_bf16 v[192:195], v[64:67], v[152:155], v[192:195]
    ds_read_b64_tr_b16 v[146:147], v7 offset:23296
    v_mfma_f32_16x16x32_bf16 v[196:199], v[68:71], v[152:155], v[196:199]
    ds_read_b64_tr_b16 v[148:149], v8 offset:22528
    s_waitcnt lgkmcnt(15)
    v_mfma_f32_16x16x32_bf16 v[200:203], v[64:67], v[156:159], v[200:203]
    ds_read_b64_tr_b16 v[150:151], v8 offset:23296
    v_mfma_f32_16x16x32_bf16 v[204:207], v[68:71], v[156:159], v[204:207]
    ds_read_b64_tr_b16 v[152:153], v4 offset:34816
    v_mfma_f32_16x16x32_bf16 v[208:211], v[64:67], v[232:235], v[208:211]
    ds_read_b64_tr_b16 v[154:155], v4 offset:35584
    v_mfma_f32_16x16x32_bf16 v[212:215], v[68:71], v[232:235], v[212:215]
    ds_read_b64_tr_b16 v[156:157], v5 offset:34816
    s_waitcnt lgkmcnt(15)
    v_mfma_f32_16x16x32_bf16 v[216:219], v[64:67], v[236:239], v[216:219]
    ds_read_b64_tr_b16 v[158:159], v5 offset:35584
    v_mfma_f32_16x16x32_bf16 v[220:223], v[68:71], v[236:239], v[220:223]
    ds_read_b64_tr_b16 v[232:233], v6 offset:34816
    v_mfma_f32_16x16x32_bf16 v[224:227], v[64:67], v[240:243], v[224:227]
    ds_read_b64_tr_b16 v[234:235], v6 offset:35584
    v_mfma_f32_16x16x32_bf16 v[228:231], v[68:71], v[240:243], v[228:231]
    ds_read_b64_tr_b16 v[236:237], v7 offset:34816
    s_waitcnt lgkmcnt(15)
    v_mfma_f32_16x16x32_bf16 v[160:163], v[72:75], v[244:247], v[160:163]
    ds_read_b64_tr_b16 v[238:239], v7 offset:35584
    v_mfma_f32_16x16x32_bf16 v[164:167], v[76:79], v[244:247], v[164:167]
    s_waitcnt lgkmcnt(14)
    v_mfma_f32_16x16x32_bf16 v[168:171], v[72:75], v[248:251], v[168:171]
    v_mfma_f32_16x16x32_bf16 v[172:175], v[76:79], v[248:251], v[172:175]
    s_waitcnt lgkmcnt(12)
    v_mfma_f32_16x16x32_bf16 v[176:179], v[72:75], v[252:255], v[176:179]
    v_mfma_f32_16x16x32_bf16 v[180:183], v[76:79], v[252:255], v[180:183]
    s_waitcnt lgkmcnt(10)
    v_mfma_f32_16x16x32_bf16 v[184:187], v[72:75], v[144:147], v[184:187]
    v_mfma_f32_16x16x32_bf16 v[188:191], v[76:79], v[144:147], v[188:191]
    s_waitcnt lgkmcnt(8)
    v_mfma_f32_16x16x32_bf16 v[192:195], v[72:75], v[148:151], v[192:195]
    v_mfma_f32_16x16x32_bf16 v[196:199], v[76:79], v[148:151], v[196:199]
    v_subrev_u32 v2, 122880, v2
    v_subrev_u32 v3, 122880, v3
    v_subrev_u32 v4, 122880, v4
    v_subrev_u32 v5, 122880, v5
    v_subrev_u32 v6, 122880, v6
    v_subrev_u32 v7, 122880, v7
    v_subrev_u32 v8, 122880, v8
    s_barrier
    ds_read_b128 v[80:83], v2 offset:0
    s_waitcnt lgkmcnt(7)
    v_mfma_f32_16x16x32_bf16 v[200:203], v[72:75], v[152:155], v[200:203]
    ds_read_b128 v[84:87], v2 offset:2048
    ds_read_b64_tr_b16 v[240:241], v4 offset:16384
    v_mfma_f32_16x16x32_bf16 v[204:207], v[76:79], v[152:155], v[204:207]
    ds_read_b64_tr_b16 v[242:243], v4 offset:17152
    ds_read_b64_tr_b16 v[244:245], v5 offset:16384
    s_waitcnt lgkmcnt(9)
    v_mfma_f32_16x16x32_bf16 v[208:211], v[72:75], v[156:159], v[208:211]
    ds_read_b64_tr_b16 v[246:247], v5 offset:17152
    ds_read_b64_tr_b16 v[248:249], v6 offset:16384
    v_mfma_f32_16x16x32_bf16 v[212:215], v[76:79], v[156:159], v[212:215]
    ds_read_b64_tr_b16 v[250:251], v6 offset:17152
    ds_read_b64_tr_b16 v[252:253], v7 offset:16384
    s_waitcnt lgkmcnt(11)
    v_mfma_f32_16x16x32_bf16 v[216:219], v[72:75], v[232:235], v[216:219]
    ds_read_b64_tr_b16 v[254:255], v7 offset:17152
    ds_read_b64_tr_b16 v[144:145], v8 offset:16384
    v_mfma_f32_16x16x32_bf16 v[220:223], v[76:79], v[232:235], v[220:223]
    ds_read_b64_tr_b16 v[146:147], v8 offset:17152
    ds_read_b64_tr_b16 v[148:149], v4 offset:28672
    s_waitcnt lgkmcnt(13)
    v_mfma_f32_16x16x32_bf16 v[224:227], v[72:75], v[236:239], v[224:227]
    ds_read_b64_tr_b16 v[150:151], v4 offset:29440
    ds_read_b64_tr_b16 v[152:153], v5 offset:28672
    v_mfma_f32_16x16x32_bf16 v[228:231], v[76:79], v[236:239], v[228:231]
    ds_read_b64_tr_b16 v[154:155], v5 offset:29440
    ds_read_b64_tr_b16 v[156:157], v6 offset:28672
    s_waitcnt lgkmcnt(13)
    v_mfma_f32_16x16x32_bf16 v[160:163], v[80:83], v[240:243], v[160:163]
    ds_read_b64_tr_b16 v[158:159], v6 offset:29440
    ds_read_b64_tr_b16 v[232:233], v7 offset:28672
    v_mfma_f32_16x16x32_bf16 v[164:167], v[84:87], v[240:243], v[164:167]
    ds_read_b64_tr_b16 v[234:235], v7 offset:29440
    s_waitcnt lgkmcnt(14)
    v_mfma_f32_16x16x32_bf16 v[168:171], v[80:83], v[244:247], v[168:171]
    ds_read_b128 v[88:91], v3 offset:0
    ds_read_b128 v[92:95], v3 offset:2048
    v_mfma_f32_16x16x32_bf16 v[172:175], v[84:87], v[244:247], v[172:175]
    ds_read_b64_tr_b16 v[236:237], v4 offset:22528
    ds_read_b64_tr_b16 v[238:239], v4 offset:23296
    s_waitcnt lgkmcnt(15)
    v_mfma_f32_16x16x32_bf16 v[176:179], v[80:83], v[248:251], v[176:179]
    ds_read_b64_tr_b16 v[240:241], v5 offset:22528
    ds_read_b64_tr_b16 v[242:243], v5 offset:23296
    v_mfma_f32_16x16x32_bf16 v[180:183], v[84:87], v[248:251], v[180:183]
    ds_read_b64_tr_b16 v[244:245], v6 offset:22528
    s_waitcnt lgkmcnt(15)
    v_mfma_f32_16x16x32_bf16 v[184:187], v[80:83], v[252:255], v[184:187]
    ds_read_b64_tr_b16 v[246:247], v6 offset:23296
    v_mfma_f32_16x16x32_bf16 v[188:191], v[84:87], v[252:255], v[188:191]
    ds_read_b64_tr_b16 v[248:249], v7 offset:22528
    v_mfma_f32_16x16x32_bf16 v[192:195], v[80:83], v[144:147], v[192:195]
    ds_read_b64_tr_b16 v[250:251], v7 offset:23296
    v_mfma_f32_16x16x32_bf16 v[196:199], v[84:87], v[144:147], v[196:199]
    ds_read_b64_tr_b16 v[252:253], v8 offset:22528
    s_waitcnt lgkmcnt(15)
    v_mfma_f32_16x16x32_bf16 v[200:203], v[80:83], v[148:151], v[200:203]
    ds_read_b64_tr_b16 v[254:255], v8 offset:23296
    v_mfma_f32_16x16x32_bf16 v[204:207], v[84:87], v[148:151], v[204:207]
    ds_read_b64_tr_b16 v[144:145], v4 offset:34816
    v_mfma_f32_16x16x32_bf16 v[208:211], v[80:83], v[152:155], v[208:211]
    ds_read_b64_tr_b16 v[146:147], v4 offset:35584
    v_mfma_f32_16x16x32_bf16 v[212:215], v[84:87], v[152:155], v[212:215]
    ds_read_b64_tr_b16 v[148:149], v5 offset:34816
    s_waitcnt lgkmcnt(15)
    v_mfma_f32_16x16x32_bf16 v[216:219], v[80:83], v[156:159], v[216:219]
    ds_read_b64_tr_b16 v[150:151], v5 offset:35584
    v_mfma_f32_16x16x32_bf16 v[220:223], v[84:87], v[156:159], v[220:223]
    ds_read_b64_tr_b16 v[152:153], v6 offset:34816
    v_mfma_f32_16x16x32_bf16 v[224:227], v[80:83], v[232:235], v[224:227]
    ds_read_b64_tr_b16 v[154:155], v6 offset:35584
    v_mfma_f32_16x16x32_bf16 v[228:231], v[84:87], v[232:235], v[228:231]
    ds_read_b64_tr_b16 v[156:157], v7 offset:34816
    s_waitcnt lgkmcnt(15)
    v_mfma_f32_16x16x32_bf16 v[160:163], v[88:91], v[236:239], v[160:163]
    ds_read_b64_tr_b16 v[158:159], v7 offset:35584
    v_mfma_f32_16x16x32_bf16 v[164:167], v[92:95], v[236:239], v[164:167]
    s_waitcnt lgkmcnt(14)
    v_mfma_f32_16x16x32_bf16 v[168:171], v[88:91], v[240:243], v[168:171]
    v_mfma_f32_16x16x32_bf16 v[172:175], v[92:95], v[240:243], v[172:175]
    s_waitcnt lgkmcnt(12)
    v_mfma_f32_16x16x32_bf16 v[176:179], v[88:91], v[244:247], v[176:179]
    v_mfma_f32_16x16x32_bf16 v[180:183], v[92:95], v[244:247], v[180:183]
    s_waitcnt lgkmcnt(10)
    v_mfma_f32_16x16x32_bf16 v[184:187], v[88:91], v[248:251], v[184:187]
    v_mfma_f32_16x16x32_bf16 v[188:191], v[92:95], v[248:251], v[188:191]
    s_waitcnt lgkmcnt(8)
    v_mfma_f32_16x16x32_bf16 v[192:195], v[88:91], v[252:255], v[192:195]
    v_mfma_f32_16x16x32_bf16 v[196:199], v[92:95], v[252:255], v[196:199]
    v_add_u32 v2, 40960, v2
    v_add_u32 v3, 40960, v3
    v_add_u32 v4, 40960, v4
    v_add_u32 v5, 40960, v5
    v_add_u32 v6, 40960, v6
    v_add_u32 v7, 40960, v7
    v_add_u32 v8, 40960, v8
    s_barrier
    ds_read_b128 v[96:99], v2 offset:0
    s_waitcnt lgkmcnt(7)
    v_mfma_f32_16x16x32_bf16 v[200:203], v[88:91], v[144:147], v[200:203]
    ds_read_b128 v[100:103], v2 offset:2048
    ds_read_b64_tr_b16 v[232:233], v4 offset:16384
    v_mfma_f32_16x16x32_bf16 v[204:207], v[92:95], v[144:147], v[204:207]
    ds_read_b64_tr_b16 v[234:235], v4 offset:17152
    ds_read_b64_tr_b16 v[236:237], v5 offset:16384
    s_waitcnt lgkmcnt(9)
    v_mfma_f32_16x16x32_bf16 v[208:211], v[88:91], v[148:151], v[208:211]
    ds_read_b64_tr_b16 v[238:239], v5 offset:17152
    ds_read_b64_tr_b16 v[240:241], v6 offset:16384
    v_mfma_f32_16x16x32_bf16 v[212:215], v[92:95], v[148:151], v[212:215]
    ds_read_b64_tr_b16 v[242:243], v6 offset:17152
    ds_read_b64_tr_b16 v[244:245], v7 offset:16384
    s_waitcnt lgkmcnt(11)
    v_mfma_f32_16x16x32_bf16 v[216:219], v[88:91], v[152:155], v[216:219]
    ds_read_b64_tr_b16 v[246:247], v7 offset:17152
    ds_read_b64_tr_b16 v[248:249], v8 offset:16384
    v_mfma_f32_16x16x32_bf16 v[220:223], v[92:95], v[152:155], v[220:223]
    ds_read_b64_tr_b16 v[250:251], v8 offset:17152
    ds_read_b64_tr_b16 v[252:253], v4 offset:28672
    s_waitcnt lgkmcnt(13)
    v_mfma_f32_16x16x32_bf16 v[224:227], v[88:91], v[156:159], v[224:227]
    ds_read_b64_tr_b16 v[254:255], v4 offset:29440
    ds_read_b64_tr_b16 v[144:145], v5 offset:28672
    v_mfma_f32_16x16x32_bf16 v[228:231], v[92:95], v[156:159], v[228:231]
    ds_read_b64_tr_b16 v[146:147], v5 offset:29440
    ds_read_b64_tr_b16 v[148:149], v6 offset:28672
    s_waitcnt lgkmcnt(13)
    v_mfma_f32_16x16x32_bf16 v[160:163], v[96:99], v[232:235], v[160:163]
    ds_read_b64_tr_b16 v[150:151], v6 offset:29440
    ds_read_b64_tr_b16 v[152:153], v7 offset:28672
    v_mfma_f32_16x16x32_bf16 v[164:167], v[100:103], v[232:235], v[164:167]
    ds_read_b64_tr_b16 v[154:155], v7 offset:29440
    s_waitcnt lgkmcnt(14)
    v_mfma_f32_16x16x32_bf16 v[168:171], v[96:99], v[236:239], v[168:171]
    ds_read_b128 v[104:107], v3 offset:0
    ds_read_b128 v[108:111], v3 offset:2048
    v_mfma_f32_16x16x32_bf16 v[172:175], v[100:103], v[236:239], v[172:175]
    ds_read_b64_tr_b16 v[156:157], v4 offset:22528
    ds_read_b64_tr_b16 v[158:159], v4 offset:23296
    s_waitcnt lgkmcnt(15)
    v_mfma_f32_16x16x32_bf16 v[176:179], v[96:99], v[240:243], v[176:179]
    ds_read_b64_tr_b16 v[232:233], v5 offset:22528
    ds_read_b64_tr_b16 v[234:235], v5 offset:23296
    v_mfma_f32_16x16x32_bf16 v[180:183], v[100:103], v[240:243], v[180:183]
    ds_read_b64_tr_b16 v[236:237], v6 offset:22528
    s_waitcnt lgkmcnt(15)
    v_mfma_f32_16x16x32_bf16 v[184:187], v[96:99], v[244:247], v[184:187]
    ds_read_b64_tr_b16 v[238:239], v6 offset:23296
    v_mfma_f32_16x16x32_bf16 v[188:191], v[100:103], v[244:247], v[188:191]
    ds_read_b64_tr_b16 v[240:241], v7 offset:22528
    v_mfma_f32_16x16x32_bf16 v[192:195], v[96:99], v[248:251], v[192:195]
    ds_read_b64_tr_b16 v[242:243], v7 offset:23296
    v_mfma_f32_16x16x32_bf16 v[196:199], v[100:103], v[248:251], v[196:199]
    ds_read_b64_tr_b16 v[244:245], v8 offset:22528
    s_waitcnt lgkmcnt(15)
    v_mfma_f32_16x16x32_bf16 v[200:203], v[96:99], v[252:255], v[200:203]
    ds_read_b64_tr_b16 v[246:247], v8 offset:23296
    v_mfma_f32_16x16x32_bf16 v[204:207], v[100:103], v[252:255], v[204:207]
    ds_read_b64_tr_b16 v[248:249], v4 offset:34816
    v_mfma_f32_16x16x32_bf16 v[208:211], v[96:99], v[144:147], v[208:211]
    ds_read_b64_tr_b16 v[250:251], v4 offset:35584
    v_mfma_f32_16x16x32_bf16 v[212:215], v[100:103], v[144:147], v[212:215]
    ds_read_b64_tr_b16 v[252:253], v5 offset:34816
    s_waitcnt lgkmcnt(15)
    v_mfma_f32_16x16x32_bf16 v[216:219], v[96:99], v[148:151], v[216:219]
    ds_read_b64_tr_b16 v[254:255], v5 offset:35584
    v_mfma_f32_16x16x32_bf16 v[220:223], v[100:103], v[148:151], v[220:223]
    ds_read_b64_tr_b16 v[144:145], v6 offset:34816
    v_mfma_f32_16x16x32_bf16 v[224:227], v[96:99], v[152:155], v[224:227]
    ds_read_b64_tr_b16 v[146:147], v6 offset:35584
    v_mfma_f32_16x16x32_bf16 v[228:231], v[100:103], v[152:155], v[228:231]
    ds_read_b64_tr_b16 v[148:149], v7 offset:34816
    s_waitcnt lgkmcnt(15)
    v_mfma_f32_16x16x32_bf16 v[160:163], v[104:107], v[156:159], v[160:163]
    ds_read_b64_tr_b16 v[150:151], v7 offset:35584
    v_mfma_f32_16x16x32_bf16 v[164:167], v[108:111], v[156:159], v[164:167]
    buffer_store_dword v11, v10, s[40:43], s53 offen sc1
    s_waitcnt lgkmcnt(14)
    v_mfma_f32_16x16x32_bf16 v[168:171], v[104:107], v[232:235], v[168:171]
    v_mfma_f32_16x16x32_bf16 v[172:175], v[108:111], v[232:235], v[172:175]
    s_waitcnt lgkmcnt(12)
    v_mfma_f32_16x16x32_bf16 v[176:179], v[104:107], v[236:239], v[176:179]
    v_mfma_f32_16x16x32_bf16 v[180:183], v[108:111], v[236:239], v[180:183]
    s_waitcnt lgkmcnt(10)
    v_mfma_f32_16x16x32_bf16 v[184:187], v[104:107], v[240:243], v[184:187]
    v_mfma_f32_16x16x32_bf16 v[188:191], v[108:111], v[240:243], v[188:191]
    s_waitcnt lgkmcnt(8)
    v_mfma_f32_16x16x32_bf16 v[192:195], v[104:107], v[244:247], v[192:195]
    v_mfma_f32_16x16x32_bf16 v[196:199], v[108:111], v[244:247], v[196:199]
    v_add_u32 v2, 40960, v2
    v_add_u32 v3, 40960, v3
    v_add_u32 v4, 40960, v4
    v_add_u32 v5, 40960, v5
    v_add_u32 v6, 40960, v6
    v_add_u32 v7, 40960, v7
    v_add_u32 v8, 40960, v8
    s_barrier
    ds_read_b128 v[112:115], v2 offset:0
    s_waitcnt lgkmcnt(7)
    v_mfma_f32_16x16x32_bf16 v[200:203], v[104:107], v[248:251], v[200:203]
    ds_read_b128 v[116:119], v2 offset:2048
    ds_read_b64_tr_b16 v[152:153], v4 offset:16384
    v_mfma_f32_16x16x32_bf16 v[204:207], v[108:111], v[248:251], v[204:207]
    ds_read_b64_tr_b16 v[154:155], v4 offset:17152
    ds_read_b64_tr_b16 v[156:157], v5 offset:16384
    s_waitcnt lgkmcnt(9)
    v_mfma_f32_16x16x32_bf16 v[208:211], v[104:107], v[252:255], v[208:211]
    ds_read_b64_tr_b16 v[158:159], v5 offset:17152
    ds_read_b64_tr_b16 v[232:233], v6 offset:16384
    v_mfma_f32_16x16x32_bf16 v[212:215], v[108:111], v[252:255], v[212:215]
    ds_read_b64_tr_b16 v[234:235], v6 offset:17152
    ds_read_b64_tr_b16 v[236:237], v7 offset:16384
    s_waitcnt lgkmcnt(11)
    v_mfma_f32_16x16x32_bf16 v[216:219], v[104:107], v[144:147], v[216:219]
    ds_read_b64_tr_b16 v[238:239], v7 offset:17152
    ds_read_b64_tr_b16 v[240:241], v8 offset:16384
    v_mfma_f32_16x16x32_bf16 v[220:223], v[108:111], v[144:147], v[220:223]
    ds_read_b64_tr_b16 v[242:243], v8 offset:17152
    ds_read_b64_tr_b16 v[244:245], v4 offset:28672
    s_waitcnt lgkmcnt(13)
    v_mfma_f32_16x16x32_bf16 v[224:227], v[104:107], v[148:151], v[224:227]
    ds_read_b64_tr_b16 v[246:247], v4 offset:29440
    ds_read_b64_tr_b16 v[248:249], v5 offset:28672
    v_mfma_f32_16x16x32_bf16 v[228:231], v[108:111], v[148:151], v[228:231]
    ds_read_b64_tr_b16 v[250:251], v5 offset:29440
    ds_read_b64_tr_b16 v[252:253], v6 offset:28672
    s_waitcnt lgkmcnt(13)
    v_mfma_f32_16x16x32_bf16 v[160:163], v[112:115], v[152:155], v[160:163]
    ds_read_b64_tr_b16 v[254:255], v6 offset:29440
    ds_read_b64_tr_b16 v[144:145], v7 offset:28672
    v_mfma_f32_16x16x32_bf16 v[164:167], v[116:119], v[152:155], v[164:167]
    ds_read_b64_tr_b16 v[146:147], v7 offset:29440
    s_waitcnt lgkmcnt(14)
    v_mfma_f32_16x16x32_bf16 v[168:171], v[112:115], v[156:159], v[168:171]
    ds_read_b128 v[120:123], v3 offset:0
    ds_read_b128 v[124:127], v3 offset:2048
    v_mfma_f32_16x16x32_bf16 v[172:175], v[116:119], v[156:159], v[172:175]
    ds_read_b64_tr_b16 v[148:149], v4 offset:22528
    ds_read_b64_tr_b16 v[150:151], v4 offset:23296
    s_waitcnt lgkmcnt(15)
    v_mfma_f32_16x16x32_bf16 v[176:179], v[112:115], v[232:235], v[176:179]
    ds_read_b64_tr_b16 v[152:153], v5 offset:22528
    ds_read_b64_tr_b16 v[154:155], v5 offset:23296
    v_mfma_f32_16x16x32_bf16 v[180:183], v[116:119], v[232:235], v[180:183]
    ds_read_b64_tr_b16 v[156:157], v6 offset:22528
    s_waitcnt lgkmcnt(15)
    v_mfma_f32_16x16x32_bf16 v[184:187], v[112:115], v[236:239], v[184:187]
    ds_read_b64_tr_b16 v[158:159], v6 offset:23296
    v_mfma_f32_16x16x32_bf16 v[188:191], v[116:119], v[236:239], v[188:191]
    ds_read_b64_tr_b16 v[232:233], v7 offset:22528
    v_mfma_f32_16x16x32_bf16 v[192:195], v[112:115], v[240:243], v[192:195]
    ds_read_b64_tr_b16 v[234:235], v7 offset:23296
    v_mfma_f32_16x16x32_bf16 v[196:199], v[116:119], v[240:243], v[196:199]
    ds_read_b64_tr_b16 v[236:237], v8 offset:22528
    s_waitcnt lgkmcnt(15)
    v_mfma_f32_16x16x32_bf16 v[200:203], v[112:115], v[244:247], v[200:203]
    ds_read_b64_tr_b16 v[238:239], v8 offset:23296
    v_mfma_f32_16x16x32_bf16 v[204:207], v[116:119], v[244:247], v[204:207]
    ds_read_b64_tr_b16 v[240:241], v4 offset:34816
    v_mfma_f32_16x16x32_bf16 v[208:211], v[112:115], v[248:251], v[208:211]
    ds_read_b64_tr_b16 v[242:243], v4 offset:35584
    v_mfma_f32_16x16x32_bf16 v[212:215], v[116:119], v[248:251], v[212:215]
    ds_read_b64_tr_b16 v[244:245], v5 offset:34816
    s_waitcnt lgkmcnt(15)
    v_mfma_f32_16x16x32_bf16 v[216:219], v[112:115], v[252:255], v[216:219]
    ds_read_b64_tr_b16 v[246:247], v5 offset:35584
    v_mfma_f32_16x16x32_bf16 v[220:223], v[116:119], v[252:255], v[220:223]
    ds_read_b64_tr_b16 v[248:249], v6 offset:34816
    v_mfma_f32_16x16x32_bf16 v[224:227], v[112:115], v[144:147], v[224:227]
    ds_read_b64_tr_b16 v[250:251], v6 offset:35584
    v_mfma_f32_16x16x32_bf16 v[228:231], v[116:119], v[144:147], v[228:231]
    ds_read_b64_tr_b16 v[252:253], v7 offset:34816
    s_waitcnt lgkmcnt(15)
    v_mfma_f32_16x16x32_bf16 v[160:163], v[120:123], v[148:151], v[160:163]
    ds_read_b64_tr_b16 v[254:255], v7 offset:35584
    v_mfma_f32_16x16x32_bf16 v[164:167], v[124:127], v[148:151], v[164:167]
    s_waitcnt lgkmcnt(14)
    v_mfma_f32_16x16x32_bf16 v[168:171], v[120:123], v[152:155], v[168:171]
    v_mfma_f32_16x16x32_bf16 v[172:175], v[124:127], v[152:155], v[172:175]
    s_waitcnt lgkmcnt(12)
    v_mfma_f32_16x16x32_bf16 v[176:179], v[120:123], v[156:159], v[176:179]
    v_mfma_f32_16x16x32_bf16 v[180:183], v[124:127], v[156:159], v[180:183]
    s_waitcnt lgkmcnt(10)
    v_mfma_f32_16x16x32_bf16 v[184:187], v[120:123], v[232:235], v[184:187]
    v_mfma_f32_16x16x32_bf16 v[188:191], v[124:127], v[232:235], v[188:191]
    s_waitcnt lgkmcnt(8)
    v_mfma_f32_16x16x32_bf16 v[192:195], v[120:123], v[236:239], v[192:195]
    v_mfma_f32_16x16x32_bf16 v[196:199], v[124:127], v[236:239], v[196:199]
    v_add_u32 v2, 40960, v2
    v_add_u32 v3, 40960, v3
    v_add_u32 v4, 40960, v4
    v_add_u32 v5, 40960, v5
    v_add_u32 v6, 40960, v6
    v_add_u32 v7, 40960, v7
    v_add_u32 v8, 40960, v8
    s_barrier
    ds_read_b128 v[128:131], v2 offset:0
    s_waitcnt lgkmcnt(7)
    v_mfma_f32_16x16x32_bf16 v[200:203], v[120:123], v[240:243], v[200:203]
    ds_read_b128 v[132:135], v2 offset:2048
    ds_read_b64_tr_b16 v[144:145], v4 offset:16384
    v_mfma_f32_16x16x32_bf16 v[204:207], v[124:127], v[240:243], v[204:207]
    ds_read_b64_tr_b16 v[146:147], v4 offset:17152
    ds_read_b64_tr_b16 v[148:149], v5 offset:16384
    s_waitcnt lgkmcnt(9)
    v_mfma_f32_16x16x32_bf16 v[208:211], v[120:123], v[244:247], v[208:211]
    ds_read_b64_tr_b16 v[150:151], v5 offset:17152
    ds_read_b64_tr_b16 v[152:153], v6 offset:16384
    v_mfma_f32_16x16x32_bf16 v[212:215], v[124:127], v[244:247], v[212:215]
    ds_read_b64_tr_b16 v[154:155], v6 offset:17152
    ds_read_b64_tr_b16 v[156:157], v7 offset:16384
    s_waitcnt lgkmcnt(11)
    v_mfma_f32_16x16x32_bf16 v[216:219], v[120:123], v[248:251], v[216:219]
    ds_read_b64_tr_b16 v[158:159], v7 offset:17152
    ds_read_b64_tr_b16 v[232:233], v8 offset:16384
    v_mfma_f32_16x16x32_bf16 v[220:223], v[124:127], v[248:251], v[220:223]
    ds_read_b64_tr_b16 v[234:235], v8 offset:17152
    ds_read_b64_tr_b16 v[236:237], v4 offset:28672
    s_waitcnt lgkmcnt(13)
    v_mfma_f32_16x16x32_bf16 v[224:227], v[120:123], v[252:255], v[224:227]
    ds_read_b64_tr_b16 v[238:239], v4 offset:29440
    ds_read_b64_tr_b16 v[240:241], v5 offset:28672
    v_mfma_f32_16x16x32_bf16 v[228:231], v[124:127], v[252:255], v[228:231]
    ds_read_b64_tr_b16 v[242:243], v5 offset:29440
    ds_read_b64_tr_b16 v[244:245], v6 offset:28672
    s_waitcnt lgkmcnt(13)
    v_mfma_f32_16x16x32_bf16 v[160:163], v[128:131], v[144:147], v[160:163]
    ds_read_b64_tr_b16 v[246:247], v6 offset:29440
    ds_read_b64_tr_b16 v[248:249], v7 offset:28672
    v_mfma_f32_16x16x32_bf16 v[164:167], v[132:135], v[144:147], v[164:167]
    ds_read_b64_tr_b16 v[250:251], v7 offset:29440
    s_waitcnt lgkmcnt(14)
    v_mfma_f32_16x16x32_bf16 v[168:171], v[128:131], v[148:151], v[168:171]
    ds_read_b128 v[136:139], v3 offset:0
    v_mfma_f32_16x16x32_bf16 v[172:175], v[132:135], v[148:151], v[172:175]
    ds_read_b128 v[140:143], v3 offset:2048
    s_waitcnt lgkmcnt(14)
    v_mfma_f32_16x16x32_bf16 v[176:179], v[128:131], v[152:155], v[176:179]
    ds_read_b64_tr_b16 v[252:253], v4 offset:22528
    v_mfma_f32_16x16x32_bf16 v[180:183], v[132:135], v[152:155], v[180:183]
    ds_read_b64_tr_b16 v[254:255], v4 offset:23296
    s_waitcnt lgkmcnt(14)
    v_mfma_f32_16x16x32_bf16 v[184:187], v[128:131], v[156:159], v[184:187]
    v_mfma_f32_16x16x32_bf16 v[188:191], v[132:135], v[156:159], v[188:191]
    s_waitcnt lgkmcnt(12)
    v_mfma_f32_16x16x32_bf16 v[192:195], v[128:131], v[232:235], v[192:195]
    v_mfma_f32_16x16x32_bf16 v[196:199], v[132:135], v[232:235], v[196:199]
    s_waitcnt lgkmcnt(10)
    v_mfma_f32_16x16x32_bf16 v[200:203], v[128:131], v[236:239], v[200:203]
    ds_read_b64_tr_b16 v[232:233], v5 offset:22528
    v_mfma_f32_16x16x32_bf16 v[204:207], v[132:135], v[236:239], v[204:207]
    ds_read_b64_tr_b16 v[234:235], v5 offset:23296
    s_waitcnt lgkmcnt(10)
    v_mfma_f32_16x16x32_bf16 v[208:211], v[128:131], v[240:243], v[208:211]
    ds_read_b64_tr_b16 v[236:237], v6 offset:22528
    v_mfma_f32_16x16x32_bf16 v[212:215], v[132:135], v[240:243], v[212:215]
    ds_read_b64_tr_b16 v[238:239], v6 offset:23296
    s_waitcnt lgkmcnt(10)
    v_mfma_f32_16x16x32_bf16 v[216:219], v[128:131], v[244:247], v[216:219]
    ds_read_b64_tr_b16 v[240:241], v7 offset:22528
    v_mfma_f32_16x16x32_bf16 v[220:223], v[132:135], v[244:247], v[220:223]
    ds_read_b64_tr_b16 v[242:243], v7 offset:23296
    s_waitcnt lgkmcnt(10)
    v_mfma_f32_16x16x32_bf16 v[224:227], v[128:131], v[248:251], v[224:227]
    ds_read_b64_tr_b16 v[244:245], v8 offset:22528
    v_mfma_f32_16x16x32_bf16 v[228:231], v[132:135], v[248:251], v[228:231]
    ds_read_b64_tr_b16 v[246:247], v8 offset:23296
    s_waitcnt lgkmcnt(8)
    v_mfma_f32_16x16x32_bf16 v[160:163], v[136:139], v[252:255], v[160:163]
    ds_read_b64_tr_b16 v[248:249], v4 offset:34816
    v_mfma_f32_16x16x32_bf16 v[164:167], v[140:143], v[252:255], v[164:167]
    ds_read_b64_tr_b16 v[250:251], v4 offset:35584
    s_waitcnt lgkmcnt(8)
    v_mfma_f32_16x16x32_bf16 v[168:171], v[136:139], v[232:235], v[168:171]
    ds_read_b64_tr_b16 v[252:253], v5 offset:34816
    v_mfma_f32_16x16x32_bf16 v[172:175], v[140:143], v[232:235], v[172:175]
    ds_read_b64_tr_b16 v[254:255], v5 offset:35584
    s_waitcnt lgkmcnt(8)
    v_mfma_f32_16x16x32_bf16 v[176:179], v[136:139], v[236:239], v[176:179]
    ds_read_b64_tr_b16 v[232:233], v6 offset:34816
    v_mfma_f32_16x16x32_bf16 v[180:183], v[140:143], v[236:239], v[180:183]
    ds_read_b64_tr_b16 v[234:235], v6 offset:35584
    s_waitcnt lgkmcnt(8)
    v_mfma_f32_16x16x32_bf16 v[184:187], v[136:139], v[240:243], v[184:187]
    ds_read_b64_tr_b16 v[236:237], v7 offset:34816
    v_mfma_f32_16x16x32_bf16 v[188:191], v[140:143], v[240:243], v[188:191]
    ds_read_b64_tr_b16 v[238:239], v7 offset:35584
    s_waitcnt lgkmcnt(8)
    v_mfma_f32_16x16x32_bf16 v[192:195], v[136:139], v[244:247], v[192:195]
    v_mfma_f32_16x16x32_bf16 v[196:199], v[140:143], v[244:247], v[196:199]
    s_waitcnt lgkmcnt(6)
    v_mfma_f32_16x16x32_bf16 v[200:203], v[136:139], v[248:251], v[200:203]
    v_mfma_f32_16x16x32_bf16 v[204:207], v[140:143], v[248:251], v[204:207]
    s_waitcnt lgkmcnt(4)
    v_mfma_f32_16x16x32_bf16 v[208:211], v[136:139], v[252:255], v[208:211]
    v_mfma_f32_16x16x32_bf16 v[212:215], v[140:143], v[252:255], v[212:215]
    v_subrev_u32 v2, 122880, v2
    v_subrev_u32 v3, 122880, v3
    v_subrev_u32 v4, 122880, v4
    v_subrev_u32 v5, 122880, v5
    v_subrev_u32 v6, 122880, v6
    v_subrev_u32 v7, 122880, v7
    v_subrev_u32 v8, 122880, v8
    s_barrier
    ds_read_b128 v[144:147], v2 offset:0
    s_waitcnt lgkmcnt(3)
    v_mfma_f32_16x16x32_bf16 v[216:219], v[136:139], v[232:235], v[216:219]
    ds_read_b128 v[148:151], v2 offset:2048
    ds_read_b64_tr_b16 v[240:241], v4 offset:28672
    v_mfma_f32_16x16x32_bf16 v[220:223], v[140:143], v[232:235], v[220:223]
    ds_read_b64_tr_b16 v[242:243], v4 offset:29440
    ds_read_b128 v[152:155], v3 offset:0
    s_waitcnt lgkmcnt(5)
    v_mfma_f32_16x16x32_bf16 v[224:227], v[136:139], v[236:239], v[224:227]
    ds_read_b128 v[156:159], v3 offset:2048
    ds_read_b64_tr_b16 v[244:245], v4 offset:34816
    v_mfma_f32_16x16x32_bf16 v[228:231], v[140:143], v[236:239], v[228:231]
    ds_read_b64_tr_b16 v[246:247], v4 offset:35584
    ds_read_b64_tr_b16 v[248:249], v5 offset:28672
    s_waitcnt lgkmcnt(5)
    v_mfma_f32_16x16x32_bf16 v[200:203], v[144:147], v[240:243], v[200:203]
    ds_read_b64_tr_b16 v[250:251], v5 offset:29440
    ds_read_b64_tr_b16 v[252:253], v5 offset:34816
    v_mov_b32 v11, 0x3f803f80
    v_mfma_f32_16x16x32_bf16 v[204:207], v[148:151], v[240:243], v[204:207]
    ds_read_b64_tr_b16 v[254:255], v5 offset:35584
    ds_read_b64_tr_b16 v[232:233], v6 offset:28672
    s_mul_i32 s47, s44, 6144
    s_waitcnt lgkmcnt(5)
    v_mfma_f32_16x16x32_bf16 v[200:203], v[152:155], v[244:247], v[200:203]
    ds_read_b64_tr_b16 v[234:235], v6 offset:29440
    ds_read_b64_tr_b16 v[236:237], v6 offset:34816
    v_lshl_add_u32 v10, v1, 4, s47
    v_mfma_f32_16x16x32_bf16 v[204:207], v[156:159], v[244:247], v[204:207]
    ds_read_b64_tr_b16 v[238:239], v6 offset:35584
    s_waitcnt lgkmcnt(6)
    v_mfma_f32_16x16x32_bf16 v[208:211], v[144:147], v[248:251], v[208:211]
    ds_read_b64_tr_b16 v[240:241], v7 offset:28672
    ds_read_b64_tr_b16 v[242:243], v7 offset:29440
    v_mfma_f32_16x16x32_bf16 v[212:215], v[148:151], v[248:251], v[212:215]
    ds_read_b64_tr_b16 v[244:245], v7 offset:34816
    v_cvt_pk_bf16_f32 v200, v200, v201
    s_waitcnt lgkmcnt(7)
    v_mfma_f32_16x16x32_bf16 v[208:211], v[152:155], v[252:255], v[208:211]
    ds_read_b64_tr_b16 v[246:247], v7 offset:35584
    v_cvt_pk_bf16_f32 v201, v202, v203
    v_mfma_f32_16x16x32_bf16 v[212:215], v[156:159], v[252:255], v[212:215]
    ds_read_b64_tr_b16 v[248:249], v8 offset:16384
    v_cvt_pk_bf16_f32 v202, v204, v205
    s_waitcnt lgkmcnt(7)
    v_mfma_f32_16x16x32_bf16 v[216:219], v[144:147], v[232:235], v[216:219]
    ds_read_b64_tr_b16 v[250:251], v8 offset:17152
    v_cvt_pk_bf16_f32 v203, v206, v207
    v_mfma_f32_16x16x32_bf16 v[220:223], v[148:151], v[232:235], v[220:223]
    ds_read_b64_tr_b16 v[252:253], v8 offset:22528
    v_cvt_pk_bf16_f32 v208, v208, v209
    s_waitcnt lgkmcnt(7)
    v_mfma_f32_16x16x32_bf16 v[216:219], v[152:155], v[236:239], v[216:219]
    ds_read_b64_tr_b16 v[254:255], v8 offset:23296
    v_cvt_pk_bf16_f32 v209, v210, v211
    v_mfma_f32_16x16x32_bf16 v[220:223], v[156:159], v[236:239], v[220:223]
    ds_read_b64_tr_b16 v[232:233], v4 offset:16384
    v_cvt_pk_bf16_f32 v210, v212, v213
    s_waitcnt lgkmcnt(7)
    v_mfma_f32_16x16x32_bf16 v[224:227], v[144:147], v[240:243], v[224:227]
    ds_read_b64_tr_b16 v[234:235], v4 offset:17152
    v_cvt_pk_bf16_f32 v211, v214, v215
    v_mfma_f32_16x16x32_bf16 v[228:231], v[148:151], v[240:243], v[228:231]
    ds_read_b64_tr_b16 v[236:237], v4 offset:22528
    v_cvt_pk_bf16_f32 v216, v216, v217
    s_waitcnt lgkmcnt(7)
    v_mfma_f32_16x16x32_bf16 v[224:227], v[152:155], v[244:247], v[224:227]
    ds_read_b64_tr_b16 v[238:239], v4 offset:23296
    v_cvt_pk_bf16_f32 v217, v218, v219
    v_mfma_f32_16x16x32_bf16 v[228:231], v[156:159], v[244:247], v[228:231]
    ds_read_b64_tr_b16 v[240:241], v5 offset:16384
    v_cvt_pk_bf16_f32 v218, v220, v221
    s_waitcnt lgkmcnt(7)
    v_mfma_f32_16x16x32_bf16 v[192:195], v[144:147], v[248:251], v[192:195]
    ds_read_b64_tr_b16 v[242:243], v5 offset:17152
    v_cvt_pk_bf16_f32 v219, v222, v223
    v_mfma_f32_16x16x32_bf16 v[196:199], v[148:151], v[248:251], v[196:199]
    ds_read_b64_tr_b16 v[244:245], v5 offset:22528
    v_cvt_pk_bf16_f32 v224, v224, v225
    s_waitcnt lgkmcnt(7)
    v_mfma_f32_16x16x32_bf16 v[192:195], v[152:155], v[252:255], v[192:195]
    ds_read_b64_tr_b16 v[246:247], v5 offset:23296
    v_cvt_pk_bf16_f32 v225, v226, v227
    v_mfma_f32_16x16x32_bf16 v[196:199], v[156:159], v[252:255], v[196:199]
    ds_read_b64_tr_b16 v[248:249], v6 offset:16384
    v_cvt_pk_bf16_f32 v226, v228, v229
    s_waitcnt lgkmcnt(7)
    v_mfma_f32_16x16x32_bf16 v[160:163], v[144:147], v[232:235], v[160:163]
    ds_read_b64_tr_b16 v[250:251], v6 offset:17152
    v_cvt_pk_bf16_f32 v227, v230, v231
    v_mfma_f32_16x16x32_bf16 v[164:167], v[148:151], v[232:235], v[164:167]
    ds_read_b64_tr_b16 v[252:253], v6 offset:22528
    v_cvt_pk_bf16_f32 v12, v192, v193
    s_waitcnt lgkmcnt(7)
    v_mfma_f32_16x16x32_bf16 v[160:163], v[152:155], v[236:239], v[160:163]
    ds_read_b64_tr_b16 v[254:255], v6 offset:23296
    v_cvt_pk_bf16_f32 v13, v194, v195
    v_mfma_f32_16x16x32_bf16 v[164:167], v[156:159], v[236:239], v[164:167]
    ds_read_b64_tr_b16 v[232:233], v7 offset:16384
    v_cvt_pk_bf16_f32 v14, v196, v197
    s_waitcnt lgkmcnt(7)
    v_mfma_f32_16x16x32_bf16 v[168:171], v[144:147], v[240:243], v[168:171]
    ds_read_b64_tr_b16 v[234:235], v7 offset:17152
    v_cvt_pk_bf16_f32 v15, v198, v199
    v_mfma_f32_16x16x32_bf16 v[172:175], v[148:151], v[240:243], v[172:175]
    ds_read_b64_tr_b16 v[236:237], v7 offset:22528
    v_cndmask_b32 v12, v12, v11, s[64:65]
    v_cndmask_b32 v13, v13, v11, s[64:65]
    s_waitcnt lgkmcnt(7)
    v_mfma_f32_16x16x32_bf16 v[168:171], v[152:155], v[244:247], v[168:171]
    ds_read_b64_tr_b16 v[238:239], v7 offset:23296
    v_cndmask_b32 v14, v14, v11, s[64:65]
    v_cndmask_b32 v15, v15, v11, s[64:65]
    v_mfma_f32_16x16x32_bf16 v[172:175], v[156:159], v[244:247], v[172:175]
    s_waitcnt lgkmcnt(6)
    v_mfma_f32_16x16x32_bf16 v[176:179], v[144:147], v[248:251], v[176:179]
    v_mfma_f32_16x16x32_bf16 v[180:183], v[148:151], v[248:251], v[180:183]
    s_waitcnt lgkmcnt(4)
    v_mfma_f32_16x16x32_bf16 v[176:179], v[152:155], v[252:255], v[176:179]
    v_mfma_f32_16x16x32_bf16 v[180:183], v[156:159], v[252:255], v[180:183]
    s_waitcnt lgkmcnt(2)
    v_mfma_f32_16x16x32_bf16 v[184:187], v[144:147], v[232:235], v[184:187]
    v_mfma_f32_16x16x32_bf16 v[188:191], v[148:151], v[232:235], v[188:191]
    s_waitcnt lgkmcnt(0)
    v_mfma_f32_16x16x32_bf16 v[184:187], v[152:155], v[236:239], v[184:187]
    v_mfma_f32_16x16x32_bf16 v[188:191], v[156:159], v[236:239], v[188:191]
    s_barrier
    v_pk_mul_f32 v[204:205], v[192:193], s[22:23]
    v_pk_mul_f32 v[206:207], v[194:195], s[22:23]
    v_pk_mul_f32 v[212:213], v[196:197], s[22:23]
    v_pk_mul_f32 v[214:215], v[198:199], s[22:23]
    v_pk_mul_f32 v[220:221], v[160:161], s[22:23]
    v_pk_mul_f32 v[222:223], v[162:163], s[22:23]
    v_pk_mul_f32 v[228:229], v[164:165], s[22:23]
    v_pk_mul_f32 v[230:231], v[166:167], s[22:23]
    v_pk_mul_f32 v[232:233], v[168:169], s[22:23]
    v_pk_mul_f32 v[234:235], v[170:171], s[22:23]
    v_exp_f32 v204, v204 clamp
    v_max_f32 v192, 0x358637bd, v192
    v_exp_f32 v205, v205 clamp
    v_max_f32 v193, 0x358637bd, v193
    v_exp_f32 v206, v206 clamp
    v_max_f32 v194, 0x358637bd, v194
    v_exp_f32 v207, v207 clamp
    v_max_f32 v195, 0x358637bd, v195
    v_exp_f32 v212, v212 clamp
    v_max_f32 v196, 0x358637bd, v196
    v_exp_f32 v213, v213 clamp
    v_max_f32 v197, 0x358637bd, v197
    v_exp_f32 v214, v214 clamp
    v_max_f32 v198, 0x358637bd, v198
    v_exp_f32 v215, v215 clamp
    v_max_f32 v199, 0x358637bd, v199
    v_exp_f32 v220, v220 clamp
    v_max_f32 v160, 0x358637bd, v160
    v_exp_f32 v221, v221 clamp
    v_max_f32 v161, 0x358637bd, v161
    v_exp_f32 v222, v222 clamp
    v_max_f32 v162, 0x358637bd, v162
    v_exp_f32 v223, v223 clamp
    v_max_f32 v163, 0x358637bd, v163
    v_exp_f32 v228, v228 clamp
    v_max_f32 v164, 0x358637bd, v164
    v_exp_f32 v229, v229 clamp
    v_max_f32 v165, 0x358637bd, v165
    v_exp_f32 v230, v230 clamp
    v_max_f32 v166, 0x358637bd, v166
    v_exp_f32 v231, v231 clamp
    v_max_f32 v167, 0x358637bd, v167
    v_exp_f32 v232, v232 clamp
    v_max_f32 v168, 0x358637bd, v168
    v_exp_f32 v233, v233 clamp
    v_max_f32 v169, 0x358637bd, v169
    v_exp_f32 v234, v234 clamp
    v_max_f32 v170, 0x358637bd, v170
    v_exp_f32 v235, v235 clamp
    v_max_f32 v171, 0x358637bd, v171
    v_pk_add_f32 v[192:193], v[192:193], v[204:205]
    v_pk_add_f32 v[194:195], v[194:195], v[206:207]
    v_pk_add_f32 v[196:197], v[196:197], v[212:213]
    v_pk_add_f32 v[198:199], v[198:199], v[214:215]
    v_pk_add_f32 v[160:161], v[160:161], v[220:221]
    v_pk_add_f32 v[162:163], v[162:163], v[222:223]
    v_pk_add_f32 v[164:165], v[164:165], v[228:229]
    v_pk_add_f32 v[166:167], v[166:167], v[230:231]
    v_pk_add_f32 v[168:169], v[168:169], v[232:233]
    v_pk_add_f32 v[170:171], v[170:171], v[234:235]
    v_cvt_pk_bf16_f32 v192, v192, v193
    v_cvt_pk_bf16_f32 v193, v194, v195
    v_cvt_pk_bf16_f32 v194, v196, v197
    v_cvt_pk_bf16_f32 v195, v198, v199
    v_cvt_pk_bf16_f32 v160, v160, v161
    v_cvt_pk_bf16_f32 v161, v162, v163
    v_cvt_pk_bf16_f32 v162, v164, v165
    v_cvt_pk_bf16_f32 v163, v166, v167
    v_cvt_pk_bf16_f32 v168, v168, v169
    v_cvt_pk_bf16_f32 v169, v170, v171
    v_pk_mul_f32 v[204:205], v[172:173], s[22:23]
    v_pk_mul_f32 v[206:207], v[174:175], s[22:23]
    v_pk_mul_f32 v[212:213], v[176:177], s[22:23]
    v_pk_mul_f32 v[214:215], v[178:179], s[22:23]
    v_pk_mul_f32 v[220:221], v[180:181], s[22:23]
    v_pk_mul_f32 v[222:223], v[182:183], s[22:23]
    v_pk_mul_f32 v[228:229], v[184:185], s[22:23]
    v_pk_mul_f32 v[230:231], v[186:187], s[22:23]
    v_pk_mul_f32 v[232:233], v[188:189], s[22:23]
    v_pk_mul_f32 v[234:235], v[190:191], s[22:23]
    v_exp_f32 v204, v204 clamp
    v_max_f32 v172, 0x358637bd, v172
    v_exp_f32 v205, v205 clamp
    v_max_f32 v173, 0x358637bd, v173
    v_exp_f32 v206, v206 clamp
    v_max_f32 v174, 0x358637bd, v174
    v_exp_f32 v207, v207 clamp
    v_max_f32 v175, 0x358637bd, v175
    v_exp_f32 v212, v212 clamp
    v_max_f32 v176, 0x358637bd, v176
    v_exp_f32 v213, v213 clamp
    v_max_f32 v177, 0x358637bd, v177
    v_exp_f32 v214, v214 clamp
    v_max_f32 v178, 0x358637bd, v178
    v_exp_f32 v215, v215 clamp
    v_max_f32 v179, 0x358637bd, v179
    v_exp_f32 v220, v220 clamp
    v_max_f32 v180, 0x358637bd, v180
    v_exp_f32 v221, v221 clamp
    v_max_f32 v181, 0x358637bd, v181
    v_exp_f32 v222, v222 clamp
    v_max_f32 v182, 0x358637bd, v182
    v_exp_f32 v223, v223 clamp
    v_max_f32 v183, 0x358637bd, v183
    v_exp_f32 v228, v228 clamp
    v_max_f32 v184, 0x358637bd, v184
    v_exp_f32 v229, v229 clamp
    v_max_f32 v185, 0x358637bd, v185
    v_exp_f32 v230, v230 clamp
    v_max_f32 v186, 0x358637bd, v186
    v_exp_f32 v231, v231 clamp
    v_max_f32 v187, 0x358637bd, v187
    v_exp_f32 v232, v232 clamp
    v_max_f32 v188, 0x358637bd, v188
    v_exp_f32 v233, v233 clamp
    v_max_f32 v189, 0x358637bd, v189
    v_exp_f32 v234, v234 clamp
    v_max_f32 v190, 0x358637bd, v190
    v_exp_f32 v235, v235 clamp
    v_max_f32 v191, 0x358637bd, v191
    v_pk_add_f32 v[172:173], v[172:173], v[204:205]
    v_pk_add_f32 v[174:175], v[174:175], v[206:207]
    v_pk_add_f32 v[176:177], v[176:177], v[212:213]
    v_pk_add_f32 v[178:179], v[178:179], v[214:215]
    v_pk_add_f32 v[180:181], v[180:181], v[220:221]
    v_pk_add_f32 v[182:183], v[182:183], v[222:223]
    v_pk_add_f32 v[184:185], v[184:185], v[228:229]
    v_pk_add_f32 v[186:187], v[186:187], v[230:231]
    v_pk_add_f32 v[188:189], v[188:189], v[232:233]
    v_pk_add_f32 v[190:191], v[190:191], v[234:235]
    v_cvt_pk_bf16_f32 v170, v172, v173
    v_cvt_pk_bf16_f32 v171, v174, v175
    v_cvt_pk_bf16_f32 v176, v176, v177
    v_cvt_pk_bf16_f32 v177, v178, v179
    v_cvt_pk_bf16_f32 v178, v180, v181
    v_cvt_pk_bf16_f32 v179, v182, v183
    v_cvt_pk_bf16_f32 v184, v184, v185
    v_cvt_pk_bf16_f32 v185, v186, v187
    v_cvt_pk_bf16_f32 v186, v188, v189
    v_cvt_pk_bf16_f32 v187, v190, v191
    v_mfma_f32_16x16x32_bf16 v[164:167], v[192:195], v[200:203], 0
    v_sub_u32 v8, v8, v9
    v_add_u32 v4, 40960, v4
    v_mfma_f32_16x16x32_bf16 v[172:175], v[192:195], v[208:211], 0
    v_add_u32 v5, 40960, v5
    v_add_u32 v6, 40960, v6
    v_mfma_f32_16x16x32_bf16 v[180:183], v[192:195], v[216:219], 0
    v_add_u32 v7, 40960, v7
    v_add_u32 v8, 40960, v8
    v_mfma_f32_16x16x32_bf16 v[188:191], v[192:195], v[224:227], 0
    v_mfma_f32_16x16x32_bf16 v[196:199], v[192:195], v[12:15], 0
    v_mfma_f32_16x16x32_bf16 v[232:235], v[160:163], v[12:15], 0
    v_mfma_f32_16x16x32_bf16 v[236:239], v[168:171], v[12:15], 0
    s_nop 1
    v_cndmask_b32 v164, v164, v180, s[38:39]
    v_cndmask_b32 v165, v165, v181, s[38:39]
    v_mfma_f32_16x16x32_bf16 v[240:243], v[176:179], v[12:15], 0
    v_cndmask_b32 v166, v174, v190, s[38:39]
    v_cndmask_b32 v167, v175, v191, s[38:39]
    v_mfma_f32_16x16x32_bf16 v[244:247], v[184:187], v[12:15], 0
    v_permlane32_swap_b32 v164, v196
    v_permlane32_swap_b32 v165, v197
    v_mfma_f32_16x16x32_bf16 v[204:207], v[160:163], v[200:203], 0
    v_permlane32_swap_b32 v166, v198
    v_permlane32_swap_b32 v167, v199
    v_mfma_f32_16x16x32_bf16 v[212:215], v[168:171], v[208:211], 0
    v_cndmask_b32 v232, v232, v236, s[32:33]
    v_cndmask_b32 v233, v233, v237, s[32:33]
    v_mfma_f32_16x16x32_bf16 v[220:223], v[176:179], v[216:219], 0
    ds_write_b128 v10, v[164:167] offset:5120
    v_cndmask_b32 v234, v234, v238, s[32:33]
    v_mfma_f32_16x16x32_bf16 v[228:231], v[184:187], v[224:227], 0
    v_cndmask_b32 v235, v235, v239, s[32:33]
    v_cndmask_b32 v232, v232, v240, s[34:35]
    ds_write_b128 v10, v[204:207] offset:0
    v_cndmask_b32 v233, v233, v241, s[34:35]
    v_cndmask_b32 v234, v234, v242, s[34:35]
    v_cndmask_b32 v235, v235, v243, s[34:35]
    ds_write_b128 v10, v[212:215] offset:1024
    v_cndmask_b32 v232, v232, v244, s[36:37]
    v_cndmask_b32 v233, v233, v245, s[36:37]
    v_cndmask_b32 v234, v234, v246, s[36:37]
    ds_write_b128 v10, v[220:223] offset:2048
    v_cndmask_b32 v235, v235, v247, s[36:37]
    ds_write_b128 v10, v[228:231] offset:3072
    ds_write_b128 v10, v[232:235] offset:4096
    s_waitcnt lgkmcnt(0)
    s_barrier
    ds_read_b64_tr_b16 v[224:225], v8 offset:0
    ds_read_b64_tr_b16 v[226:227], v8 offset:768
    ds_read_b64_tr_b16 v[228:229], v8 offset:6144
    ds_read_b64_tr_b16 v[230:231], v8 offset:6912
    ds_read_b64_tr_b16 v[232:233], v8 offset:12288
    ds_read_b64_tr_b16 v[234:235], v8 offset:13056
    ds_read_b64_tr_b16 v[236:237], v8 offset:18432
    ds_read_b64_tr_b16 v[238:239], v8 offset:19200
    ds_read_b64_tr_b16 v[240:241], v8 offset:24576
    ds_read_b64_tr_b16 v[242:243], v8 offset:25344
    ds_read_b64_tr_b16 v[244:245], v8 offset:30720
    ds_read_b64_tr_b16 v[246:247], v8 offset:31488
    v_add_u32 v8, 40960, v8
    ds_read_b64_tr_b16 v[248:249], v8 offset:0
    ds_read_b64_tr_b16 v[250:251], v8 offset:768
    s_waitcnt lgkmcnt(10)
    v_mfma_f32_16x16x32_bf16 v[192:195], v[224:227], v[16:19], 0
    ds_read_b64_tr_b16 v[252:253], v8 offset:6144
    v_mfma_f32_16x16x32_bf16 v[196:199], v[224:227], v[20:23], 0
    ds_read_b64_tr_b16 v[254:255], v8 offset:6912
    v_mfma_f32_16x16x32_bf16 v[192:195], v[228:231], v[24:27], v[192:195]
    ds_read_b64_tr_b16 v[224:225], v8 offset:12288
    v_mfma_f32_16x16x32_bf16 v[196:199], v[228:231], v[28:31], v[196:199]
    ds_read_b64_tr_b16 v[226:227], v8 offset:13056
    s_mul_i32 s49, s55, 55296
    s_waitcnt lgkmcnt(10)
    v_mfma_f32_16x16x32_bf16 v[192:195], v[232:235], v[32:35], v[192:195]
    ds_read_b64_tr_b16 v[228:229], v8 offset:18432
    v_lshrrev_b32 v216, 2, v1
    v_mfma_f32_16x16x32_bf16 v[196:199], v[232:235], v[36:39], v[196:199]
    ds_read_b64_tr_b16 v[230:231], v8 offset:19200
    v_and_b32 v217, 3, v1
    v_mfma_f32_16x16x32_bf16 v[192:195], v[236:239], v[40:43], v[192:195]
    ds_read_b64_tr_b16 v[232:233], v8 offset:24576
    v_lshl_add_u32 v217, v217, 3, s49
    v_mfma_f32_16x16x32_bf16 v[196:199], v[236:239], v[44:47], v[196:199]
    ds_read_b64_tr_b16 v[234:235], v8 offset:25344
    v_mul_u32_u24 v216, 192, v216
    s_waitcnt lgkmcnt(10)
    v_mfma_f32_16x16x32_bf16 v[192:195], v[240:243], v[48:51], v[192:195]
    ds_read_b64_tr_b16 v[236:237], v8 offset:30720
    v_add_u32 v216, v216, v217
    v_mfma_f32_16x16x32_bf16 v[196:199], v[240:243], v[52:55], v[196:199]
    ds_read_b64_tr_b16 v[238:239], v8 offset:31488
    v_and_b32 v217, 16, v1
    v_mfma_f32_16x16x32_bf16 v[192:195], v[244:247], v[56:59], v[192:195]
    v_add_u32 v8, 40960, v8
    ds_read_b64_tr_b16 v[240:241], v8 offset:0
    v_lshl_add_u32 v203, v217, 1, v216
    v_mfma_f32_16x16x32_bf16 v[196:199], v[244:247], v[60:63], v[196:199]
    ds_read_b64_tr_b16 v[242:243], v8 offset:768
    v_xor_b32 v217, 16, v217
    s_waitcnt lgkmcnt(10)
    v_mfma_f32_16x16x32_bf16 v[192:195], v[248:251], v[64:67], v[192:195]
    ds_read_b64_tr_b16 v[244:245], v8 offset:6144
    v_lshl_add_u32 v204, v217, 1, v216
    v_mfma_f32_16x16x32_bf16 v[196:199], v[248:251], v[68:71], v[196:199]
    ds_read_b64_tr_b16 v[246:247], v8 offset:6912
    v_lshlrev_b32 v10, 4, v1
    v_mfma_f32_16x16x32_bf16 v[192:195], v[252:255], v[72:75], v[192:195]
    v_add_u32 v11, 20480, v10
    v_mfma_f32_16x16x32_bf16 v[196:199], v[252:255], v[76:79], v[196:199]
    v_lshlrev_b32 v12, 3, v1
    s_waitcnt lgkmcnt(8)
    v_mfma_f32_16x16x32_bf16 v[192:195], v[224:227], v[80:83], v[192:195]
    v_add_u32 v13, 20480, v12
    v_mfma_f32_16x16x32_bf16 v[196:199], v[224:227], v[84:87], v[196:199]
    v_add_u32 v14, 118784, v10
    v_mfma_f32_16x16x32_bf16 v[192:195], v[228:231], v[88:91], v[192:195]
    v_mov_b32 v15, 159856
    v_mfma_f32_16x16x32_bf16 v[196:199], v[228:231], v[92:95], v[196:199]
    s_barrier
    ds_read_b64_tr_b16 v[248:249], v8 offset:12288
    s_waitcnt lgkmcnt(5)
    v_mfma_f32_16x16x32_bf16 v[192:195], v[232:235], v[96:99], v[192:195]
    ds_read_b64_tr_b16 v[250:251], v8 offset:13056
    ds_read_b64_tr_b16 v[252:253], v8 offset:18432
    v_mfma_f32_16x16x32_bf16 v[196:199], v[232:235], v[100:103], v[196:199]
    ds_read_b64_tr_b16 v[254:255], v8 offset:19200
    ds_read_b64_tr_b16 v[224:225], v8 offset:24576
    v_mfma_f32_16x16x32_bf16 v[192:195], v[236:239], v[104:107], v[192:195]
    ds_read_b64_tr_b16 v[226:227], v8 offset:25344
    ds_read_b64_tr_b16 v[228:229], v8 offset:30720
    v_mfma_f32_16x16x32_bf16 v[196:199], v[236:239], v[108:111], v[196:199]
    ds_read_b64_tr_b16 v[230:231], v8 offset:31488
    s_waitcnt lgkmcnt(8)
    v_mfma_f32_16x16x32_bf16 v[192:195], v[240:243], v[112:115], v[192:195]
    ds_read_b64_tr_b16 v[232:233], v4 offset:0
    ds_read_b64_tr_b16 v[234:235], v4 offset:768
    v_mfma_f32_16x16x32_bf16 v[196:199], v[240:243], v[116:119], v[196:199]
    ds_read_b64_tr_b16 v[236:237], v4 offset:6144
    v_mfma_f32_16x16x32_bf16 v[192:195], v[244:247], v[120:123], v[192:195]
    ds_read_b64_tr_b16 v[238:239], v4 offset:6912
    v_mfma_f32_16x16x32_bf16 v[196:199], v[244:247], v[124:127], v[196:199]
    ds_read_b64_tr_b16 v[240:241], v4 offset:12288
    s_waitcnt lgkmcnt(9)
    v_mfma_f32_16x16x32_bf16 v[192:195], v[248:251], v[128:131], v[192:195]
    ds_read_b64_tr_b16 v[242:243], v4 offset:13056
    v_mfma_f32_16x16x32_bf16 v[196:199], v[248:251], v[132:135], v[196:199]
    ds_read_b64_tr_b16 v[244:245], v4 offset:18432
    v_mfma_f32_16x16x32_bf16 v[192:195], v[252:255], v[136:139], v[192:195]
    ds_read_b64_tr_b16 v[246:247], v4 offset:19200
    v_mfma_f32_16x16x32_bf16 v[196:199], v[252:255], v[140:143], v[196:199]
    ds_read_b64_tr_b16 v[248:249], v4 offset:24576
    s_waitcnt lgkmcnt(9)
    v_mfma_f32_16x16x32_bf16 v[192:195], v[224:227], v[144:147], v[192:195]
    ds_read_b64_tr_b16 v[250:251], v4 offset:25344
    v_mfma_f32_16x16x32_bf16 v[196:199], v[224:227], v[148:151], v[196:199]
    ds_read_b64_tr_b16 v[252:253], v4 offset:30720
    v_mfma_f32_16x16x32_bf16 v[192:195], v[228:231], v[152:155], v[192:195]
    ds_read_b64_tr_b16 v[254:255], v4 offset:31488
    v_mfma_f32_16x16x32_bf16 v[196:199], v[228:231], v[156:159], v[196:199]
    v_add_u32 v4, 40960, v4
    ds_read_b64_tr_b16 v[224:225], v4 offset:0
    s_waitcnt lgkmcnt(9)
    v_mfma_f32_16x16x32_bf16 v[160:163], v[232:235], v[16:19], 0
    ds_read_b64_tr_b16 v[226:227], v4 offset:768
    v_mfma_f32_16x16x32_bf16 v[164:167], v[232:235], v[20:23], 0
    ds_read_b64_tr_b16 v[228:229], v4 offset:6144
    v_mul_f32 v216, s22, v192
    v_mfma_f32_16x16x32_bf16 v[160:163], v[236:239], v[24:27], v[160:163]
    ds_read_b64_tr_b16 v[230:231], v4 offset:6912
    v_mul_f32 v217, s22, v193
    v_mfma_f32_16x16x32_bf16 v[164:167], v[236:239], v[28:31], v[164:167]
    ds_read_b64_tr_b16 v[232:233], v4 offset:12288
    v_mul_f32 v218, s22, v194
    s_waitcnt lgkmcnt(9)
    v_mfma_f32_16x16x32_bf16 v[160:163], v[240:243], v[32:35], v[160:163]
    ds_read_b64_tr_b16 v[234:235], v4 offset:13056
    v_mul_f32 v219, s22, v195
    v_mfma_f32_16x16x32_bf16 v[164:167], v[240:243], v[36:39], v[164:167]
    ds_read_b64_tr_b16 v[236:237], v4 offset:18432
    v_mul_f32 v220, s22, v196
    v_mfma_f32_16x16x32_bf16 v[160:163], v[244:247], v[40:43], v[160:163]
    ds_read_b64_tr_b16 v[238:239], v4 offset:19200
    v_mul_f32 v221, s22, v197
    v_mfma_f32_16x16x32_bf16 v[164:167], v[244:247], v[44:47], v[164:167]
    ds_read_b64_tr_b16 v[240:241], v4 offset:24576
    v_mul_f32 v222, s22, v198
    s_waitcnt lgkmcnt(9)
    v_mfma_f32_16x16x32_bf16 v[160:163], v[248:251], v[48:51], v[160:163]
    ds_read_b64_tr_b16 v[242:243], v4 offset:25344
    v_mul_f32 v223, s22, v199
    v_mfma_f32_16x16x32_bf16 v[164:167], v[248:251], v[52:55], v[164:167]
    ds_read_b64_tr_b16 v[244:245], v4 offset:30720
    v_exp_f32 v216, v216 clamp
    v_mfma_f32_16x16x32_bf16 v[160:163], v[252:255], v[56:59], v[160:163]
    ds_read_b64_tr_b16 v[246:247], v4 offset:31488
    v_max_f32 v192, 0x358637bd, v192
    v_mfma_f32_16x16x32_bf16 v[164:167], v[252:255], v[60:63], v[164:167]
    v_add_u32 v4, 40960, v4
    ds_read_b64_tr_b16 v[248:249], v4 offset:0
    v_exp_f32 v217, v217 clamp
    s_waitcnt lgkmcnt(9)
    v_mfma_f32_16x16x32_bf16 v[160:163], v[224:227], v[64:67], v[160:163]
    ds_read_b64_tr_b16 v[250:251], v4 offset:768
    v_max_f32 v193, 0x358637bd, v193
    v_mfma_f32_16x16x32_bf16 v[164:167], v[224:227], v[68:71], v[164:167]
    ds_read_b64_tr_b16 v[252:253], v4 offset:6144
    v_exp_f32 v218, v218 clamp
    v_mfma_f32_16x16x32_bf16 v[160:163], v[228:231], v[72:75], v[160:163]
    ds_read_b64_tr_b16 v[254:255], v4 offset:6912
    v_max_f32 v194, 0x358637bd, v194
    v_mfma_f32_16x16x32_bf16 v[164:167], v[228:231], v[76:79], v[164:167]
    ds_read_b64_tr_b16 v[224:225], v4 offset:12288
    v_exp_f32 v219, v219 clamp
    s_waitcnt lgkmcnt(9)
    v_mfma_f32_16x16x32_bf16 v[160:163], v[232:235], v[80:83], v[160:163]
    ds_read_b64_tr_b16 v[226:227], v4 offset:13056
    v_max_f32 v195, 0x358637bd, v195
    v_mfma_f32_16x16x32_bf16 v[164:167], v[232:235], v[84:87], v[164:167]
    ds_read_b64_tr_b16 v[228:229], v4 offset:18432
    v_exp_f32 v220, v220 clamp
    v_mfma_f32_16x16x32_bf16 v[160:163], v[236:239], v[88:91], v[160:163]
    ds_read_b64_tr_b16 v[230:231], v4 offset:19200
    v_max_f32 v196, 0x358637bd, v196
    v_mfma_f32_16x16x32_bf16 v[164:167], v[236:239], v[92:95], v[164:167]
    ds_read_b64_tr_b16 v[232:233], v4 offset:24576
    v_exp_f32 v221, v221 clamp
    s_waitcnt lgkmcnt(9)
    v_mfma_f32_16x16x32_bf16 v[160:163], v[240:243], v[96:99], v[160:163]
    ds_read_b64_tr_b16 v[234:235], v4 offset:25344
    v_max_f32 v197, 0x358637bd, v197
    v_mfma_f32_16x16x32_bf16 v[164:167], v[240:243], v[100:103], v[164:167]
    ds_read_b64_tr_b16 v[236:237], v4 offset:30720
    v_exp_f32 v222, v222 clamp
    v_mfma_f32_16x16x32_bf16 v[160:163], v[244:247], v[104:107], v[160:163]
    ds_read_b64_tr_b16 v[238:239], v4 offset:31488
    v_max_f32 v198, 0x358637bd, v198
    v_mfma_f32_16x16x32_bf16 v[164:167], v[244:247], v[108:111], v[164:167]
    ds_read_b64_tr_b16 v[240:241], v5 offset:0
    v_exp_f32 v223, v223 clamp
    s_waitcnt lgkmcnt(9)
    v_mfma_f32_16x16x32_bf16 v[160:163], v[248:251], v[112:115], v[160:163]
    ds_read_b64_tr_b16 v[242:243], v5 offset:768
    v_max_f32 v199, 0x358637bd, v199
    v_mfma_f32_16x16x32_bf16 v[164:167], v[248:251], v[116:119], v[164:167]
    ds_read_b64_tr_b16 v[244:245], v6 offset:0
    v_add_f32 v192, v192, v216
    v_mfma_f32_16x16x32_bf16 v[160:163], v[252:255], v[120:123], v[160:163]
    ds_read_b64_tr_b16 v[246:247], v6 offset:768
    v_add_f32 v193, v193, v217
    v_mfma_f32_16x16x32_bf16 v[164:167], v[252:255], v[124:127], v[164:167]
    ds_read_b64_tr_b16 v[248:249], v7 offset:0
    v_add_f32 v194, v194, v218
    s_waitcnt lgkmcnt(9)
    v_mfma_f32_16x16x32_bf16 v[160:163], v[224:227], v[128:131], v[160:163]
    ds_read_b64_tr_b16 v[250:251], v7 offset:768
    v_add_f32 v195, v195, v219
    v_mfma_f32_16x16x32_bf16 v[164:167], v[224:227], v[132:135], v[164:167]
    ds_read_b64_tr_b16 v[252:253], v5 offset:6144
    v_add_f32 v196, v196, v220
    v_mfma_f32_16x16x32_bf16 v[160:163], v[228:231], v[136:139], v[160:163]
    ds_read_b64_tr_b16 v[254:255], v5 offset:6912
    v_add_f32 v197, v197, v221
    v_mfma_f32_16x16x32_bf16 v[164:167], v[228:231], v[140:143], v[164:167]
    ds_read_b64_tr_b16 v[224:225], v6 offset:6144
    v_add_f32 v198, v198, v222
    s_waitcnt lgkmcnt(9)
    v_mfma_f32_16x16x32_bf16 v[160:163], v[232:235], v[144:147], v[160:163]
    ds_read_b64_tr_b16 v[226:227], v6 offset:6912
    v_add_f32 v199, v199, v223
    v_mfma_f32_16x16x32_bf16 v[164:167], v[232:235], v[148:151], v[164:167]
    ds_read_b64_tr_b16 v[228:229], v7 offset:6144
    v_cvt_pk_bf16_f32 v192, v192, v193
    v_mfma_f32_16x16x32_bf16 v[160:163], v[236:239], v[152:155], v[160:163]
    ds_read_b64_tr_b16 v[230:231], v7 offset:6912
    v_cvt_pk_bf16_f32 v193, v194, v195
    v_mfma_f32_16x16x32_bf16 v[164:167], v[236:239], v[156:159], v[164:167]
    ds_read_b64_tr_b16 v[232:233], v5 offset:12288
    v_cvt_pk_bf16_f32 v196, v196, v197
    s_waitcnt lgkmcnt(9)
    v_mfma_f32_16x16x32_bf16 v[168:171], v[240:243], v[16:19], 0
    ds_read_b64_tr_b16 v[234:235], v5 offset:13056
    v_cvt_pk_bf16_f32 v197, v198, v199
    v_mfma_f32_16x16x32_bf16 v[172:175], v[240:243], v[20:23], 0
    ds_read_b64_tr_b16 v[236:237], v6 offset:12288
    v_mul_f32 v216, s22, v160
    v_mfma_f32_16x16x32_bf16 v[176:179], v[244:247], v[16:19], 0
    ds_read_b64_tr_b16 v[238:239], v6 offset:13056
    v_mul_f32 v217, s22, v161
    v_mfma_f32_16x16x32_bf16 v[180:183], v[244:247], v[20:23], 0
    ds_read_b64_tr_b16 v[240:241], v7 offset:12288
    v_mul_f32 v218, s22, v162
    s_waitcnt lgkmcnt(9)
    v_mfma_f32_16x16x32_bf16 v[184:187], v[248:251], v[16:19], 0
    ds_read_b64_tr_b16 v[242:243], v7 offset:13056
    v_mul_f32 v219, s22, v163
    v_mfma_f32_16x16x32_bf16 v[188:191], v[248:251], v[20:23], 0
    ds_read_b64_tr_b16 v[244:245], v5 offset:18432
    v_mul_f32 v220, s22, v164
    v_mfma_f32_16x16x32_bf16 v[168:171], v[252:255], v[24:27], v[168:171]
    ds_read_b64_tr_b16 v[246:247], v5 offset:19200
    v_mul_f32 v221, s22, v165
    v_mfma_f32_16x16x32_bf16 v[172:175], v[252:255], v[28:31], v[172:175]
    ds_read_b64_tr_b16 v[248:249], v6 offset:18432
    v_mul_f32 v222, s22, v166
    s_waitcnt lgkmcnt(9)
    v_mfma_f32_16x16x32_bf16 v[176:179], v[224:227], v[24:27], v[176:179]
    ds_read_b64_tr_b16 v[250:251], v6 offset:19200
    v_mul_f32 v223, s22, v167
    v_mfma_f32_16x16x32_bf16 v[180:183], v[224:227], v[28:31], v[180:183]
    ds_read_b64_tr_b16 v[252:253], v7 offset:18432
    v_exp_f32 v216, v216 clamp
    v_mfma_f32_16x16x32_bf16 v[184:187], v[228:231], v[24:27], v[184:187]
    ds_read_b64_tr_b16 v[254:255], v7 offset:19200
    v_max_f32 v160, 0x358637bd, v160
    v_mfma_f32_16x16x32_bf16 v[188:191], v[228:231], v[28:31], v[188:191]
    ds_read_b64_tr_b16 v[224:225], v5 offset:24576
    v_exp_f32 v217, v217 clamp
    s_waitcnt lgkmcnt(9)
    v_mfma_f32_16x16x32_bf16 v[168:171], v[232:235], v[32:35], v[168:171]
    ds_read_b64_tr_b16 v[226:227], v5 offset:25344
    v_max_f32 v161, 0x358637bd, v161
    v_mfma_f32_16x16x32_bf16 v[172:175], v[232:235], v[36:39], v[172:175]
    ds_read_b64_tr_b16 v[228:229], v6 offset:24576
    v_exp_f32 v218, v218 clamp
    v_mfma_f32_16x16x32_bf16 v[176:179], v[236:239], v[32:35], v[176:179]
    ds_read_b64_tr_b16 v[230:231], v6 offset:25344
    v_max_f32 v162, 0x358637bd, v162
    v_mfma_f32_16x16x32_bf16 v[180:183], v[236:239], v[36:39], v[180:183]
    ds_read_b64_tr_b16 v[232:233], v7 offset:24576
    v_exp_f32 v219, v219 clamp
    s_waitcnt lgkmcnt(9)
    v_mfma_f32_16x16x32_bf16 v[184:187], v[240:243], v[32:35], v[184:187]
    ds_read_b64_tr_b16 v[234:235], v7 offset:25344
    v_max_f32 v163, 0x358637bd, v163
    v_mfma_f32_16x16x32_bf16 v[188:191], v[240:243], v[36:39], v[188:191]
    ds_read_b64_tr_b16 v[236:237], v5 offset:30720
    v_exp_f32 v220, v220 clamp
    v_mfma_f32_16x16x32_bf16 v[168:171], v[244:247], v[40:43], v[168:171]
    ds_read_b64_tr_b16 v[238:239], v5 offset:31488
    v_max_f32 v164, 0x358637bd, v164
    v_mfma_f32_16x16x32_bf16 v[172:175], v[244:247], v[44:47], v[172:175]
    ds_read_b64_tr_b16 v[240:241], v6 offset:30720
    v_exp_f32 v221, v221 clamp
    s_waitcnt lgkmcnt(9)
    v_mfma_f32_16x16x32_bf16 v[176:179], v[248:251], v[40:43], v[176:179]
    ds_read_b64_tr_b16 v[242:243], v6 offset:31488
    v_max_f32 v165, 0x358637bd, v165
    v_mfma_f32_16x16x32_bf16 v[180:183], v[248:251], v[44:47], v[180:183]
    ds_read_b64_tr_b16 v[244:245], v7 offset:30720
    v_exp_f32 v222, v222 clamp
    v_mfma_f32_16x16x32_bf16 v[184:187], v[252:255], v[40:43], v[184:187]
    ds_read_b64_tr_b16 v[246:247], v7 offset:31488
    v_max_f32 v166, 0x358637bd, v166
    v_mfma_f32_16x16x32_bf16 v[188:191], v[252:255], v[44:47], v[188:191]
    v_exp_f32 v223, v223 clamp
    s_waitcnt lgkmcnt(8)
    v_mfma_f32_16x16x32_bf16 v[168:171], v[224:227], v[48:51], v[168:171]
    v_max_f32 v167, 0x358637bd, v167
    v_mfma_f32_16x16x32_bf16 v[172:175], v[224:227], v[52:55], v[172:175]
    v_add_f32 v160, v160, v216
    v_mfma_f32_16x16x32_bf16 v[176:179], v[228:231], v[48:51], v[176:179]
    v_add_f32 v161, v161, v217
    v_mfma_f32_16x16x32_bf16 v[180:183], v[228:231], v[52:55], v[180:183]
    v_add_f32 v162, v162, v218
    s_barrier
    v_add_u32 v5, 40960, v5
    ds_read_b64_tr_b16 v[248:249], v5 offset:0
    s_waitcnt lgkmcnt(5)
    v_mfma_f32_16x16x32_bf16 v[184:187], v[232:235], v[48:51], v[184:187]
    ds_read_b64_tr_b16 v[250:251], v5 offset:768
    ds_read_b64_tr_b16 v[252:253], v5 offset:6144
    v_add_f32 v163, v163, v219
    v_mfma_f32_16x16x32_bf16 v[188:191], v[232:235], v[52:55], v[188:191]
    ds_read_b64_tr_b16 v[254:255], v5 offset:6912
    ds_read_b64_tr_b16 v[224:225], v5 offset:12288
    v_add_f32 v164, v164, v220
    v_mfma_f32_16x16x32_bf16 v[168:171], v[236:239], v[56:59], v[168:171]
    ds_read_b64_tr_b16 v[226:227], v5 offset:13056
    ds_read_b64_tr_b16 v[228:229], v5 offset:18432
    v_add_f32 v165, v165, v221
    v_mfma_f32_16x16x32_bf16 v[172:175], v[236:239], v[60:63], v[172:175]
    ds_read_b64_tr_b16 v[230:231], v5 offset:19200
    v_add_f32 v166, v166, v222
    s_waitcnt lgkmcnt(8)
    v_mfma_f32_16x16x32_bf16 v[176:179], v[240:243], v[56:59], v[176:179]
    ds_read_b64_tr_b16 v[232:233], v5 offset:24576
    ds_read_b64_tr_b16 v[234:235], v5 offset:25344
    v_add_f32 v167, v167, v223
    v_mfma_f32_16x16x32_bf16 v[180:183], v[240:243], v[60:63], v[180:183]
    ds_read_b64_tr_b16 v[236:237], v5 offset:30720
    v_cvt_pk_bf16_f32 v160, v160, v161
    v_mfma_f32_16x16x32_bf16 v[184:187], v[244:247], v[56:59], v[184:187]
    ds_read_b64_tr_b16 v[238:239], v5 offset:31488
    v_cvt_pk_bf16_f32 v161, v162, v163
    v_mfma_f32_16x16x32_bf16 v[188:191], v[244:247], v[60:63], v[188:191]
    v_add_u32 v5, 40960, v5
    ds_read_b64_tr_b16 v[240:241], v5 offset:0
    v_cvt_pk_bf16_f32 v164, v164, v165
    s_waitcnt lgkmcnt(9)
    v_mfma_f32_16x16x32_bf16 v[168:171], v[248:251], v[64:67], v[168:171]
    ds_read_b64_tr_b16 v[242:243], v5 offset:768
    v_cvt_pk_bf16_f32 v165, v166, v167
    v_mfma_f32_16x16x32_bf16 v[172:175], v[248:251], v[68:71], v[172:175]
    ds_read_b64_tr_b16 v[244:245], v5 offset:6144
    v_mov_b32 v162, v192
    v_mfma_f32_16x16x32_bf16 v[168:171], v[252:255], v[72:75], v[168:171]
    ds_read_b64_tr_b16 v[246:247], v5 offset:6912
    v_mov_b32 v163, v193
    v_mfma_f32_16x16x32_bf16 v[172:175], v[252:255], v[76:79], v[172:175]
    ds_read_b64_tr_b16 v[248:249], v5 offset:12288
    v_mov_b32 v166, v196
    s_waitcnt lgkmcnt(9)
    v_mfma_f32_16x16x32_bf16 v[168:171], v[224:227], v[80:83], v[168:171]
    ds_read_b64_tr_b16 v[250:251], v5 offset:13056
    v_mov_b32 v167, v197
    v_mfma_f32_16x16x32_bf16 v[172:175], v[224:227], v[84:87], v[172:175]
    ds_read_b64_tr_b16 v[252:253], v5 offset:18432
    v_mfma_f32_16x16x32_bf16 v[168:171], v[228:231], v[88:91], v[168:171]
    ds_read_b64_tr_b16 v[254:255], v5 offset:19200
    v_mfma_f32_16x16x32_bf16 v[172:175], v[228:231], v[92:95], v[172:175]
    ds_read_b64_tr_b16 v[224:225], v5 offset:24576
    s_waitcnt lgkmcnt(9)
    v_mfma_f32_16x16x32_bf16 v[168:171], v[232:235], v[96:99], v[168:171]
    ds_read_b64_tr_b16 v[226:227], v5 offset:25344
    v_mfma_f32_16x16x32_bf16 v[172:175], v[232:235], v[100:103], v[172:175]
    ds_read_b64_tr_b16 v[228:229], v5 offset:30720
    v_mfma_f32_16x16x32_bf16 v[168:171], v[236:239], v[104:107], v[168:171]
    ds_read_b64_tr_b16 v[230:231], v5 offset:31488
    v_mfma_f32_16x16x32_bf16 v[172:175], v[236:239], v[108:111], v[172:175]
    v_add_u32 v6, 40960, v6
    ds_read_b64_tr_b16 v[232:233], v6 offset:0
    s_waitcnt lgkmcnt(9)
    v_mfma_f32_16x16x32_bf16 v[168:171], v[240:243], v[112:115], v[168:171]
    ds_read_b64_tr_b16 v[234:235], v6 offset:768
    v_mfma_f32_16x16x32_bf16 v[172:175], v[240:243], v[116:119], v[172:175]
    ds_read_b64_tr_b16 v[236:237], v6 offset:6144
    v_mfma_f32_16x16x32_bf16 v[168:171], v[244:247], v[120:123], v[168:171]
    ds_read_b64_tr_b16 v[238:239], v6 offset:6912
    v_mfma_f32_16x16x32_bf16 v[172:175], v[244:247], v[124:127], v[172:175]
    ds_read_b64_tr_b16 v[240:241], v6 offset:12288
    s_waitcnt lgkmcnt(9)
    v_mfma_f32_16x16x32_bf16 v[168:171], v[248:251], v[128:131], v[168:171]
    ds_read_b64_tr_b16 v[242:243], v6 offset:13056
    v_mfma_f32_16x16x32_bf16 v[172:175], v[248:251], v[132:135], v[172:175]
    ds_read_b64_tr_b16 v[244:245], v6 offset:18432
    v_mfma_f32_16x16x32_bf16 v[168:171], v[252:255], v[136:139], v[168:171]
    ds_read_b64_tr_b16 v[246:247], v6 offset:19200
    v_mfma_f32_16x16x32_bf16 v[172:175], v[252:255], v[140:143], v[172:175]
    ds_read_b64_tr_b16 v[248:249], v6 offset:24576
    s_waitcnt lgkmcnt(9)
    v_mfma_f32_16x16x32_bf16 v[168:171], v[224:227], v[144:147], v[168:171]
    ds_read_b64_tr_b16 v[250:251], v6 offset:25344
    v_mfma_f32_16x16x32_bf16 v[172:175], v[224:227], v[148:151], v[172:175]
    ds_read_b64_tr_b16 v[252:253], v6 offset:30720
    v_mfma_f32_16x16x32_bf16 v[168:171], v[228:231], v[152:155], v[168:171]
    ds_read_b64_tr_b16 v[254:255], v6 offset:31488
    v_mfma_f32_16x16x32_bf16 v[172:175], v[228:231], v[156:159], v[172:175]
    v_add_u32 v6, 40960, v6
    ds_read_b64_tr_b16 v[224:225], v6 offset:0
    s_waitcnt lgkmcnt(9)
    v_mfma_f32_16x16x32_bf16 v[176:179], v[232:235], v[64:67], v[176:179]
    ds_read_b64_tr_b16 v[226:227], v6 offset:768
    v_mfma_f32_16x16x32_bf16 v[180:183], v[232:235], v[68:71], v[180:183]
    ds_read_b64_tr_b16 v[228:229], v6 offset:6144
    v_mul_f32 v216, s22, v168
    v_mul_f32 v217, s22, v169
    v_mfma_f32_16x16x32_bf16 v[176:179], v[236:239], v[72:75], v[176:179]
    ds_read_b64_tr_b16 v[230:231], v6 offset:6912
    v_mul_f32 v218, s22, v170
    v_mul_f32 v219, s22, v171
    v_mfma_f32_16x16x32_bf16 v[180:183], v[236:239], v[76:79], v[180:183]
    ds_read_b64_tr_b16 v[232:233], v6 offset:12288
    v_mul_f32 v220, s22, v172
    v_mul_f32 v221, s22, v173
    s_waitcnt lgkmcnt(9)
    v_mfma_f32_16x16x32_bf16 v[176:179], v[240:243], v[80:83], v[176:179]
    ds_read_b64_tr_b16 v[234:235], v6 offset:13056
    v_mul_f32 v222, s22, v174
    v_mul_f32 v223, s22, v175
    v_mfma_f32_16x16x32_bf16 v[180:183], v[240:243], v[84:87], v[180:183]
    ds_read_b64_tr_b16 v[236:237], v6 offset:18432
    v_exp_f32 v216, v216 clamp
    v_mfma_f32_16x16x32_bf16 v[176:179], v[244:247], v[88:91], v[176:179]
    ds_read_b64_tr_b16 v[238:239], v6 offset:19200
    v_max_f32 v168, 0x358637bd, v168
    v_exp_f32 v217, v217 clamp
    v_mfma_f32_16x16x32_bf16 v[180:183], v[244:247], v[92:95], v[180:183]
    ds_read_b64_tr_b16 v[240:241], v6 offset:24576
    v_max_f32 v169, 0x358637bd, v169
    v_exp_f32 v218, v218 clamp
    s_waitcnt lgkmcnt(9)
    v_mfma_f32_16x16x32_bf16 v[176:179], v[248:251], v[96:99], v[176:179]
    ds_read_b64_tr_b16 v[242:243], v6 offset:25344
    v_max_f32 v170, 0x358637bd, v170
    v_exp_f32 v219, v219 clamp
    v_mfma_f32_16x16x32_bf16 v[180:183], v[248:251], v[100:103], v[180:183]
    ds_read_b64_tr_b16 v[244:245], v6 offset:30720
    v_max_f32 v171, 0x358637bd, v171
    v_exp_f32 v220, v220 clamp
    v_mfma_f32_16x16x32_bf16 v[176:179], v[252:255], v[104:107], v[176:179]
    ds_read_b64_tr_b16 v[246:247], v6 offset:31488
    v_max_f32 v172, 0x358637bd, v172
    v_exp_f32 v221, v221 clamp
    v_mfma_f32_16x16x32_bf16 v[180:183], v[252:255], v[108:111], v[180:183]
    v_add_u32 v7, 40960, v7
    ds_read_b64_tr_b16 v[248:249], v7 offset:0
    v_max_f32 v173, 0x358637bd, v173
    v_exp_f32 v222, v222 clamp
    s_waitcnt lgkmcnt(9)
    v_mfma_f32_16x16x32_bf16 v[176:179], v[224:227], v[112:115], v[176:179]
    ds_read_b64_tr_b16 v[250:251], v7 offset:768
    v_max_f32 v174, 0x358637bd, v174
    v_exp_f32 v223, v223 clamp
    v_mfma_f32_16x16x32_bf16 v[180:183], v[224:227], v[116:119], v[180:183]
    ds_read_b64_tr_b16 v[252:253], v7 offset:6144
    v_max_f32 v175, 0x358637bd, v175
    v_add_f32 v168, v168, v216
    v_mfma_f32_16x16x32_bf16 v[176:179], v[228:231], v[120:123], v[176:179]
    ds_read_b64_tr_b16 v[254:255], v7 offset:6912
    v_add_f32 v169, v169, v217
    v_add_f32 v170, v170, v218
    v_mfma_f32_16x16x32_bf16 v[180:183], v[228:231], v[124:127], v[180:183]
    ds_read_b64_tr_b16 v[224:225], v7 offset:12288
    v_add_f32 v171, v171, v219
    v_add_f32 v172, v172, v220
    s_waitcnt lgkmcnt(9)
    v_mfma_f32_16x16x32_bf16 v[176:179], v[232:235], v[128:131], v[176:179]
    ds_read_b64_tr_b16 v[226:227], v7 offset:13056
    v_add_f32 v173, v173, v221
    v_add_f32 v174, v174, v222
    v_mfma_f32_16x16x32_bf16 v[180:183], v[232:235], v[132:135], v[180:183]
    ds_read_b64_tr_b16 v[228:229], v7 offset:18432
    v_add_f32 v175, v175, v223
    v_cvt_pk_bf16_f32 v168, v168, v169
    v_mfma_f32_16x16x32_bf16 v[176:179], v[236:239], v[136:139], v[176:179]
    ds_read_b64_tr_b16 v[230:231], v7 offset:19200
    v_cvt_pk_bf16_f32 v169, v170, v171
    v_cvt_pk_bf16_f32 v172, v172, v173
    v_mfma_f32_16x16x32_bf16 v[180:183], v[236:239], v[140:143], v[180:183]
    ds_read_b64_tr_b16 v[232:233], v7 offset:24576
    v_cvt_pk_bf16_f32 v173, v174, v175
    v_mov_b32 v170, v192
    s_waitcnt lgkmcnt(9)
    v_mfma_f32_16x16x32_bf16 v[176:179], v[240:243], v[144:147], v[176:179]
    ds_read_b64_tr_b16 v[234:235], v7 offset:25344
    v_mov_b32 v171, v193
    v_mov_b32 v174, v196
    v_mfma_f32_16x16x32_bf16 v[180:183], v[240:243], v[148:151], v[180:183]
    ds_read_b64_tr_b16 v[236:237], v7 offset:30720
    v_mov_b32 v175, v197
    v_mfma_f32_16x16x32_bf16 v[176:179], v[244:247], v[152:155], v[176:179]
    ds_read_b64_tr_b16 v[238:239], v7 offset:31488
    v_mfma_f32_16x16x32_bf16 v[180:183], v[244:247], v[156:159], v[180:183]
    v_add_u32 v7, 40960, v7
    ds_read_b64_tr_b16 v[240:241], v7 offset:0
    s_waitcnt lgkmcnt(9)
    v_mfma_f32_16x16x32_bf16 v[184:187], v[248:251], v[64:67], v[184:187]
    ds_read_b64_tr_b16 v[242:243], v7 offset:768
    v_mfma_f32_16x16x32_bf16 v[188:191], v[248:251], v[68:71], v[188:191]
    ds_read_b64_tr_b16 v[244:245], v7 offset:6144
    v_mul_f32 v216, s22, v176
    v_mul_f32 v217, s22, v177
    v_mfma_f32_16x16x32_bf16 v[184:187], v[252:255], v[72:75], v[184:187]
    ds_read_b64_tr_b16 v[246:247], v7 offset:6912
    v_mul_f32 v218, s22, v178
    v_mul_f32 v219, s22, v179
    v_mfma_f32_16x16x32_bf16 v[188:191], v[252:255], v[76:79], v[188:191]
    ds_read_b64_tr_b16 v[248:249], v7 offset:12288
    v_mul_f32 v220, s22, v180
    v_mul_f32 v221, s22, v181
    s_waitcnt lgkmcnt(9)
    v_mfma_f32_16x16x32_bf16 v[184:187], v[224:227], v[80:83], v[184:187]
    ds_read_b64_tr_b16 v[250:251], v7 offset:13056
    v_mul_f32 v222, s22, v182
    v_mul_f32 v223, s22, v183
    v_mfma_f32_16x16x32_bf16 v[188:191], v[224:227], v[84:87], v[188:191]
    ds_read_b64_tr_b16 v[252:253], v7 offset:18432
    v_exp_f32 v216, v216 clamp
    v_mfma_f32_16x16x32_bf16 v[184:187], v[228:231], v[88:91], v[184:187]
    ds_read_b64_tr_b16 v[254:255], v7 offset:19200
    v_max_f32 v176, 0x358637bd, v176
    v_exp_f32 v217, v217 clamp
    v_mfma_f32_16x16x32_bf16 v[188:191], v[228:231], v[92:95], v[188:191]
    ds_read_b64_tr_b16 v[224:225], v7 offset:24576
    v_max_f32 v177, 0x358637bd, v177
    v_exp_f32 v218, v218 clamp
    s_waitcnt lgkmcnt(9)
    v_mfma_f32_16x16x32_bf16 v[184:187], v[232:235], v[96:99], v[184:187]
    ds_read_b64_tr_b16 v[226:227], v7 offset:25344
    v_max_f32 v178, 0x358637bd, v178
    v_exp_f32 v219, v219 clamp
    v_mfma_f32_16x16x32_bf16 v[188:191], v[232:235], v[100:103], v[188:191]
    ds_read_b64_tr_b16 v[228:229], v7 offset:30720
    v_max_f32 v179, 0x358637bd, v179
    v_exp_f32 v220, v220 clamp
    v_mfma_f32_16x16x32_bf16 v[184:187], v[236:239], v[104:107], v[184:187]
    ds_read_b64_tr_b16 v[230:231], v7 offset:31488
    v_max_f32 v180, 0x358637bd, v180
    v_exp_f32 v221, v221 clamp
    v_mfma_f32_16x16x32_bf16 v[188:191], v[236:239], v[108:111], v[188:191]
    v_max_f32 v181, 0x358637bd, v181
    v_exp_f32 v222, v222 clamp
    s_waitcnt lgkmcnt(8)
    v_mfma_f32_16x16x32_bf16 v[184:187], v[240:243], v[112:115], v[184:187]
    v_max_f32 v182, 0x358637bd, v182
    v_exp_f32 v223, v223 clamp
    v_mfma_f32_16x16x32_bf16 v[188:191], v[240:243], v[116:119], v[188:191]
    v_max_f32 v183, 0x358637bd, v183
    v_add_f32 v176, v176, v216
    v_mfma_f32_16x16x32_bf16 v[184:187], v[244:247], v[120:123], v[184:187]
    v_add_f32 v177, v177, v217
    v_add_f32 v178, v178, v218
    v_mfma_f32_16x16x32_bf16 v[188:191], v[244:247], v[124:127], v[188:191]
    v_add_f32 v179, v179, v219
    v_add_f32 v180, v180, v220
    s_waitcnt lgkmcnt(4)
    v_mfma_f32_16x16x32_bf16 v[184:187], v[248:251], v[128:131], v[184:187]
    v_add_f32 v181, v181, v221
    v_add_f32 v182, v182, v222
    v_mfma_f32_16x16x32_bf16 v[188:191], v[248:251], v[132:135], v[188:191]
    v_add_f32 v183, v183, v223
    v_cvt_pk_bf16_f32 v176, v176, v177
    v_mfma_f32_16x16x32_bf16 v[184:187], v[252:255], v[136:139], v[184:187]
    v_cvt_pk_bf16_f32 v177, v178, v179
    v_cvt_pk_bf16_f32 v180, v180, v181
    v_mfma_f32_16x16x32_bf16 v[188:191], v[252:255], v[140:143], v[188:191]
    v_cvt_pk_bf16_f32 v181, v182, v183
    v_mov_b32 v178, v192
    s_waitcnt lgkmcnt(0)
    v_mfma_f32_16x16x32_bf16 v[184:187], v[224:227], v[144:147], v[184:187]
    v_mov_b32 v179, v193
    v_mov_b32 v182, v196
    v_mfma_f32_16x16x32_bf16 v[188:191], v[224:227], v[148:151], v[188:191]
    v_mov_b32 v183, v197
    v_mfma_f32_16x16x32_bf16 v[184:187], v[228:231], v[152:155], v[184:187]
    v_mfma_f32_16x16x32_bf16 v[188:191], v[228:231], v[156:159], v[188:191]
    s_nop 6
    v_pk_mul_f32 v[216:217], v[184:185], s[22:23]
    v_pk_mul_f32 v[218:219], v[186:187], s[22:23]
    v_pk_mul_f32 v[220:221], v[188:189], s[22:23]
    v_pk_mul_f32 v[222:223], v[190:191], s[22:23]
    v_exp_f32 v216, v216 clamp
    v_max_f32 v184, 0x358637bd, v184
    v_exp_f32 v217, v217 clamp
    v_max_f32 v185, 0x358637bd, v185
    v_exp_f32 v218, v218 clamp
    v_max_f32 v186, 0x358637bd, v186
    v_exp_f32 v219, v219 clamp
    v_max_f32 v187, 0x358637bd, v187
    v_exp_f32 v220, v220 clamp
    v_max_f32 v188, 0x358637bd, v188
    v_exp_f32 v221, v221 clamp
    v_max_f32 v189, 0x358637bd, v189
    v_exp_f32 v222, v222 clamp
    v_max_f32 v190, 0x358637bd, v190
    v_exp_f32 v223, v223 clamp
    v_max_f32 v191, 0x358637bd, v191
    v_pk_add_f32 v[184:185], v[184:185], v[216:217]
    v_pk_add_f32 v[186:187], v[186:187], v[218:219]
    v_pk_add_f32 v[188:189], v[188:189], v[220:221]
    v_pk_add_f32 v[190:191], v[190:191], v[222:223]
    v_cvt_pk_bf16_f32 v184, v184, v185
    v_cvt_pk_bf16_f32 v185, v186, v187
    v_cvt_pk_bf16_f32 v188, v188, v189
    v_cvt_pk_bf16_f32 v189, v190, v191
    v_mov_b32 v186, v192
    v_mov_b32 v187, v193
    v_mov_b32 v190, v196
    v_mov_b32 v191, v197
    s_barrier
    ds_read_b32 v28, v15
    ds_read_b128 v[48:51], v14 offset:40960
    ds_read_b128 v[52:55], v14 offset:41984
    ds_read_b128 v[56:59], v14 offset:43008
    ds_read_b128 v[60:63], v14 offset:44032
    ds_read_b128 v[32:35], v14 offset:0
    ds_read_b128 v[36:39], v14 offset:1024
    ds_read_b128 v[40:43], v14 offset:2048
    ds_read_b128 v[44:47], v14 offset:3072
    s_waitcnt lgkmcnt(7)
    v_mfma_f32_16x16x32_bf16 v[96:99], v[48:51], v[160:163], 0
    v_mfma_f32_16x16x32_bf16 v[100:103], v[48:51], v[164:167], 0
    s_waitcnt lgkmcnt(6)
    v_mfma_f32_16x16x32_bf16 v[96:99], v[52:55], v[168:171], v[96:99]
    v_mfma_f32_16x16x32_bf16 v[100:103], v[52:55], v[172:175], v[100:103]
    s_waitcnt lgkmcnt(5)
    v_mfma_f32_16x16x32_bf16 v[96:99], v[56:59], v[176:179], v[96:99]
    v_mfma_f32_16x16x32_bf16 v[100:103], v[56:59], v[180:183], v[100:103]
    s_waitcnt lgkmcnt(4)
    v_mfma_f32_16x16x32_bf16 v[96:99], v[60:63], v[184:187], v[96:99]
    v_mfma_f32_16x16x32_bf16 v[100:103], v[60:63], v[188:191], v[100:103]
    s_waitcnt lgkmcnt(3)
    v_mfma_f32_16x16x32_bf16 v[64:67], v[32:35], v[160:163], 0
    v_mfma_f32_16x16x32_bf16 v[68:71], v[32:35], v[164:167], 0
    s_nop 3
    v_cvt_pk_bf16_f32 v104, v98, v98
    v_cvt_pk_bf16_f32 v112, v102, v102
    v_lshlrev_b32 v104, 16, v104
    v_lshlrev_b32 v112, 16, v112
    s_waitcnt lgkmcnt(2)
    v_mfma_f32_16x16x32_bf16 v[72:75], v[36:39], v[168:171], 0
    v_add_f32 v104, 0x358637bd, v104
    v_add_f32 v112, 0x358637bd, v112
    v_cvt_pk_bf16_f32 v104, v104, v104
    v_cvt_pk_bf16_f32 v112, v112, v112
    v_mfma_f32_16x16x32_bf16 v[76:79], v[36:39], v[172:175], 0
    v_lshlrev_b32 v104, 16, v104
    v_lshlrev_b32 v112, 16, v112
    v_rcp_f32 v108, v104
    v_rcp_f32 v116, v112
    s_waitcnt lgkmcnt(1)
    v_mfma_f32_16x16x32_bf16 v[80:83], v[40:43], v[176:179], 0
    v_mov_b32 v104, v108
    v_mov_b32 v112, v116
    v_mov_b32 v105, v108
    v_mov_b32 v113, v116
    v_mfma_f32_16x16x32_bf16 v[84:87], v[40:43], v[180:183], 0
    v_permlane16_swap_b32 v104, v105
    v_permlane16_swap_b32 v112, v113
    v_mov_b32 v106, v104
    v_mov_b32 v114, v112
    s_waitcnt lgkmcnt(0)
    v_mfma_f32_16x16x32_bf16 v[88:91], v[44:47], v[184:187], 0
    v_mov_b32 v107, v105
    v_mov_b32 v115, v113
    v_permlane32_swap_b32 v104, v106
    v_permlane32_swap_b32 v112, v114
    v_mfma_f32_16x16x32_bf16 v[92:95], v[44:47], v[188:191], 0
    v_permlane32_swap_b32 v105, v107
    v_permlane32_swap_b32 v113, v115
    v_pk_mul_f32 v[64:65], v[64:65], v[104:105] op_sel:[0,0] op_sel_hi:[1,0]
    v_pk_mul_f32 v[66:67], v[66:67], v[104:105] op_sel:[0,0] op_sel_hi:[1,0]
    v_cvt_pk_bf16_f32 v120, v64, v65
    v_cvt_pk_bf16_f32 v121, v66, v67
    v_bitop3_b32 v129, v120, v121, v28 bitop3:0x96
    v_pk_mul_f32 v[72:73], v[72:73], v[104:105] op_sel:[0,1] op_sel_hi:[1,1]
    v_pk_mul_f32 v[74:75], v[74:75], v[104:105] op_sel:[0,1] op_sel_hi:[1,1]
    v_cvt_pk_bf16_f32 v122, v72, v73
    v_cvt_pk_bf16_f32 v123, v74, v75
    buffer_store_dwordx4 v[120:123], v10, s[40:43], s51 offen offset:0 sc1
    v_bitop3_b32 v129, v122, v123, v129 bitop3:0x96
    v_pk_mul_f32 v[80:81], v[80:81], v[106:107] op_sel:[0,0] op_sel_hi:[1,0]
    v_pk_mul_f32 v[82:83], v[82:83], v[106:107] op_sel:[0,0] op_sel_hi:[1,0]
    v_cvt_pk_bf16_f32 v124, v80, v81
    v_cvt_pk_bf16_f32 v125, v82, v83
    v_bitop3_b32 v129, v124, v125, v129 bitop3:0x96
    v_pk_mul_f32 v[88:89], v[88:89], v[106:107] op_sel:[0,1] op_sel_hi:[1,1]
    v_pk_mul_f32 v[90:91], v[90:91], v[106:107] op_sel:[0,1] op_sel_hi:[1,1]
    v_cvt_pk_bf16_f32 v126, v88, v89
    v_cvt_pk_bf16_f32 v127, v90, v91
    buffer_store_dwordx4 v[124:127], v10, s[40:43], s51 offen offset:1024 sc1
    v_bitop3_b32 v129, v126, v127, v129 bitop3:0x96
    v_pk_mul_f32 v[96:97], v[96:97], v[108:109] op_sel:[0,0] op_sel_hi:[1,0]
    v_cvt_pk_bf16_f32 v128, v96, v97
    v_xor_b32 v129, v129, v128
    buffer_store_dwordx2 v[128:129], v12, s[40:43], s52 offen sc1
    v_pk_mul_f32 v[68:69], v[68:69], v[112:113] op_sel:[0,0] op_sel_hi:[1,0]
    v_pk_mul_f32 v[70:71], v[70:71], v[112:113] op_sel:[0,0] op_sel_hi:[1,0]
    v_cvt_pk_bf16_f32 v132, v68, v69
    v_cvt_pk_bf16_f32 v133, v70, v71
    v_bitop3_b32 v141, v132, v133, v28 bitop3:0x96
    v_pk_mul_f32 v[76:77], v[76:77], v[112:113] op_sel:[0,1] op_sel_hi:[1,1]
    v_pk_mul_f32 v[78:79], v[78:79], v[112:113] op_sel:[0,1] op_sel_hi:[1,1]
    v_cvt_pk_bf16_f32 v134, v76, v77
    v_cvt_pk_bf16_f32 v135, v78, v79
    buffer_store_dwordx4 v[132:135], v11, s[40:43], s51 offen offset:0 sc1
    v_bitop3_b32 v141, v134, v135, v141 bitop3:0x96
    v_pk_mul_f32 v[84:85], v[84:85], v[114:115] op_sel:[0,0] op_sel_hi:[1,0]
    v_pk_mul_f32 v[86:87], v[86:87], v[114:115] op_sel:[0,0] op_sel_hi:[1,0]
    v_cvt_pk_bf16_f32 v136, v84, v85
    v_cvt_pk_bf16_f32 v137, v86, v87
    v_bitop3_b32 v141, v136, v137, v141 bitop3:0x96
    v_pk_mul_f32 v[92:93], v[92:93], v[114:115] op_sel:[0,1] op_sel_hi:[1,1]
    v_pk_mul_f32 v[94:95], v[94:95], v[114:115] op_sel:[0,1] op_sel_hi:[1,1]
    v_cvt_pk_bf16_f32 v138, v92, v93
    v_cvt_pk_bf16_f32 v139, v94, v95
    buffer_store_dwordx4 v[136:139], v11, s[40:43], s51 offen offset:1024 sc1
    v_bitop3_b32 v141, v138, v139, v141 bitop3:0x96
    v_pk_mul_f32 v[100:101], v[100:101], v[116:117] op_sel:[0,0] op_sel_hi:[1,0]
    v_cvt_pk_bf16_f32 v140, v100, v101
    v_xor_b32 v141, v141, v140
    buffer_store_dwordx2 v[140:141], v13, s[40:43], s52 offen sc1
    v_mov_b32 v29, v28
    s_mov_b64 exec, 0xffff
    buffer_store_dwordx2 v[28:29], v12, s[40:43], s53 offen sc1
    s_mov_b64 exec, -1
    s_branch o1
k_end:
    s_endpgm
.section .rodata,"a"
.p2align 6
.amdhsa_kernel gated_mix__linear_attn_block__ssm_conv_s4d__prompt_kernel
  .amdhsa_next_free_vgpr 256
  .amdhsa_next_free_sgpr 102
  .amdhsa_accum_offset 256
  .amdhsa_group_segment_fixed_size 0
  .amdhsa_kernarg_size 112
  .amdhsa_user_sgpr_count 2
  .amdhsa_user_sgpr_kernarg_segment_ptr 1
  .amdhsa_system_sgpr_workgroup_id_x 1
.end_amdhsa_kernel
```
